```python
import torch

def _softmax(x, axis=-1):
    return torch.softmax(x, dim=axis)

def _gelu(x):
    return torch.nn.functional.gelu(x, approximate='tanh')

def _silu(x):
    return torch.nn.functional.silu(x)

def _sigmoid(x):
    return torch.sigmoid(x)

def _layernorm(x, axis=-1, eps=1e-05):
    m = x.mean(dim=axis, keepdim=True)
    v = x.var(dim=axis, keepdim=True, unbiased=False)
    return (x - m) / torch.sqrt(v + eps)

def _scatter_add(tgt, idx, src, axis=0):
    return tgt.clone().index_add_(axis, idx, src)

def _segment_sum(src, seg, n):
    out = torch.zeros((n,) + src.shape[1:], dtype=src.dtype)
    return out.index_add_(0, seg, src)

def _pad(x, pw):
    flat = tuple((v for pair in reversed(pw) for v in pair))
    return torch.nn.functional.pad(x, flat)
kernel_name = 'adaLN_cond__memory_aug_recurrent_mem_tr__mixer_s_mlp__prompt'

def setup_inputs():

    _w = lambda a: (lambda t: t.to(torch.bfloat16) if t.is_floating_point() else t)(torch.as_tensor(a))

    def _A_setup():
        B, S, Dm = (1, 2048, 640)
        H, Dh = (32, 128)
        M, seg = (8, 32)
        seg = min(seg, S)
        S = S // seg * seg
        return {'x': _w((lambda *s: torch.randn(*s, dtype=torch.bfloat16) * 0.05)(B, S, Dm)), 'mem0': _w((lambda *s: torch.randn(*s, dtype=torch.bfloat16) * 0.4)(B, M, Dm)), 'Wq': _w((lambda *s: torch.randn(*s, dtype=torch.bfloat16) * 3.2)(Dm, H, Dh) * Dm ** (-0.5)), 'Wk': _w((lambda *s: torch.randn(*s, dtype=torch.bfloat16) * 3.2)(Dm, H, Dh) * Dm ** (-0.5)), 'Wv': _w((lambda *s: torch.randn(*s, dtype=torch.bfloat16) * 0.4)(Dm, H, Dh) * Dm ** (-0.5)), 'Wo': _w((lambda *s: torch.randn(*s, dtype=torch.bfloat16) * 0.4)(H, Dh, Dm) * (H * Dh) ** (-0.5)), 'seg_len': seg}
    _A_in = _A_setup()

    def _B_setup():
        B, S, D, F = (1, 2048, 640, 1728)
        return {'x': _w((lambda *s: torch.randn(*s, dtype=torch.bfloat16) * 0.05)(B, S, D)), 'w1': _w((lambda *s: torch.randn(*s, dtype=torch.bfloat16) * 3.2)(D, D) * D ** (-0.5)), 'w2': _w((lambda *s: torch.randn(*s, dtype=torch.bfloat16) * 3.2)(D, D) * D ** (-0.5)), 'w3': _w((lambda *s: torch.randn(*s, dtype=torch.bfloat16) * 3.2)(D, F) * D ** (-0.5)), 'w4': _w((lambda *s: torch.randn(*s, dtype=torch.bfloat16) * 3.2)(F, D) * F ** (-0.5))}
    _B_in = _B_setup()
    return {'A_x': _A_in['x'], 'A_mem0': _A_in['mem0'], 'A_Wq': _A_in['Wq'], 'A_Wk': _A_in['Wk'], 'A_Wv': _A_in['Wv'], 'A_Wo': _A_in['Wo'], 'A_seg_len': _A_in['seg_len'], 'B_x': _B_in['x'], 'B_w1': _B_in['w1'], 'B_w2': _B_in['w2'], 'B_w3': _B_in['w3'], 'B_w4': _B_in['w4'], 'c': _w((lambda *s: torch.randn(*s, dtype=torch.bfloat16) * 0.1)(1, 640) * 8.0), 'w_mod': _w((lambda *s: torch.randn(*s, dtype=torch.bfloat16) * 0.1)(640, 6 * 640) * 640 ** (-0.5) * 8.0)}

def reference(A_x, A_mem0, A_Wq, A_Wk, A_Wv, A_Wo, A_seg_len, B_x, B_w1, B_w2, B_w3, B_w4, c, w_mod):

    def _A_ref(x, mem0, Wq, Wk, Wv, Wo, seg_len):
        B, S, Dm = x.shape
        H, Dh = (Wq.shape[1], Wq.shape[2])
        M = mem0.shape[1]
        scale = Dh ** (-0.5)
        n_seg = S // seg_len
        L = M + seg_len
        idx = torch.arange(L)
        mask = (idx[:, None] < M) | (idx[:, None] >= idx[None, :])
        mem = mem0
        outs = []
        for s in range(n_seg):
            xs = x[:, s * seg_len:(s + 1) * seg_len, :].clone()
            h = torch.concatenate([mem, xs], axis=1)
            q = torch.einsum('btd,dhe->bhte', h, Wq)
            k = torch.einsum('btd,dhe->bhte', h, Wk)
            v = torch.einsum('btd,dhe->bhte', h, Wv)
            scores = torch.einsum('bhqe,bhke->bhqk', q, k) * scale
            scores = torch.where(mask[None, None], scores, -1000000000.0)
            p = _softmax(scores, axis=-1)
            o = torch.einsum('bhqk,bhke->bhqe', p, v)
            o = torch.einsum('bhte,hed->btd', o, Wo)
            mem = o[:, :M, :].clone()
            outs.append(o[:, M:, :])
        return torch.concatenate(outs, axis=1)

    def _B_ref(x, w1, w2, w3, w4):
        B, S, D = x.shape
        h = _gelu(_layernorm(x, axis=-1) @ w1)
        c = D // 4
        g0 = _pad(h[:, :, 0 * c:1 * c], ((0, 0), (1, 0), (0, 0)))[:, :S, :]
        g1 = _pad(h[:, :, 1 * c:2 * c], ((0, 0), (0, 1), (0, 0)))[:, 1:, :]
        g2 = _pad(h[:, :, 2 * c:3 * c], ((0, 0), (2, 0), (0, 0)))[:, :S, :]
        g3 = _pad(h[:, :, 3 * c:], ((0, 0), (0, 2), (0, 0)))[:, 2:, :]
        hs = torch.concatenate([g0, g1, g2, g3], axis=-1) @ w2
        x1 = x + hs
        h2 = _gelu(_layernorm(x1, axis=-1) @ w3) @ w4
        return x1 + h2
    x = A_x
    mod = (_silu(c) @ w_mod).reshape(c.shape[0], 6, 1, -1)
    sa, ca, ga, sb, cb, gb = (mod[:, 0].clone(), mod[:, 1].clone(), mod[:, 2].clone(), mod[:, 3].clone(), mod[:, 4].clone(), mod[:, 5].clone())
    h = _layernorm(x, axis=-1) * (1 + ca) + sa
    x = x + ga * _A_ref(h, A_mem0, A_Wq, A_Wk, A_Wv, A_Wo, A_seg_len)
    h = _layernorm(x, axis=-1) * (1 + cb) + sb
    x = x + gb * _B_ref(h, B_w1, B_w2, B_w3, B_w4)
    return x
```

```asm
; @launch grid=(256,1,1) block=(256,1,1) lds=163840
.amdgcn_target "amdgcn-amd-amdhsa--gfx950"
.text
.globl adaLN_cond__memory_aug_recurrent_mem_tr__mixer_s_mlp__prompt_kernel
.p2align 8
.type adaLN_cond__memory_aug_recurrent_mem_tr__mixer_s_mlp__prompt_kernel,@function
adaLN_cond__memory_aug_recurrent_mem_tr__mixer_s_mlp__prompt_kernel:
    s_cmp_ge_u32 s2, 256
    s_cbranch_scc1 L_end_1
    s_and_b32 s26, s2, 7
    s_cmp_ge_u32 s26, 2
    s_cbranch_scc1 L_worker_2
    s_lshr_b32 s27, s2, 3
    s_load_dwordx2 s[12:13], s[0:1], 8
    s_load_dwordx2 s[14:15], s[0:1], 16
    s_load_dwordx4 s[16:19], s[0:1], 24
    s_load_dwordx2 s[20:21], s[0:1], 40
    s_load_dwordx2 s[22:23], s[0:1], 120
    s_load_dwordx2 s[24:25], s[0:1], 128
    v_lshrrev_b32 v1, 6, v0
    s_nop 0
    v_readfirstlane_b32 s28, v1
    s_mov_b32 s31, 100000
    s_waitcnt lgkmcnt(0)
    s_mov_b32 s4, s24
    s_and_b32 s5, s25, 0xffff
    s_mov_b32 s6, 268435456
    s_mov_b32 s7, 0x20000
    v_and_b32 v2, 15, v0
    v_bfe_u32 v3, v0, 4, 2
    v_and_b32 v1, 63, v0
    s_lshr_b32 s46, s28, 1
    s_lshl_b32 s46, s46, 3
    s_lshl_b32 s47, s28, 4
    v_lshlrev_b32 v4, 1, v3
    v_or_b32 v4, s46, v4
    v_xor_b32 v4, v4, v2
    v_lshlrev_b32 v8, 4, v4
    v_add_u32 v10, s47, v3
    v_lshrrev_b32 v4, 3, v1
    v_add_u32 v11, s47, v4
    v_lshrrev_b32 v5, 1, v4
    v_xor_b32 v5, v5, v4
    v_and_b32 v5, 2, v5
    s_lshr_b32 s46, s46, 1
    v_or_b32 v5, s46, v5
    v_and_b32 v4, 7, v1
    v_xor_b32 v4, v4, v5
    v_lshlrev_b32 v9, 4, v4
    v_lshlrev_b32 v144, 13, v10
    v_lshlrev_b32 v145, 13, v11
    v_mul_u32_u24 v146, 1280, v10
    v_mul_u32_u24 v147, 1280, v11
    v_lshrrev_b32 v4, 2, v2
    v_and_b32 v6, 1, v3
    v_lshrrev_b32 v7, 1, v3
    v_lshl_add_u32 v5, v6, 5, v4
    v_lshl_add_u32 v5, v7, 2, v5
    v_lshrrev_b32 v6, 1, v5
    v_xor_b32 v6, v6, v5
    v_bfe_u32 v6, v6, 1, 1
    v_lshrrev_b32 v7, 2, v5
    v_xor_b32 v7, v7, v5
    v_bfe_u32 v7, v7, 3, 1
    v_lshl_add_u32 v6, v7, 1, v6
    v_bfe_u32 v4, v2, 1, 1
    v_lshl_add_u32 v13, v6, 1, v4
    v_lshlrev_b32 v13, 4, v13
    v_lshl_add_u32 v13, v5, 7, v13
    v_and_b32 v7, 1, v5
    v_lshl_add_u32 v6, v6, 1, v7
    v_lshl_add_u32 v12, v6, 1, v4
    v_lshlrev_b32 v12, 4, v12
    v_lshl_add_u32 v12, v5, 8, v12
    v_and_b32 v7, 1, v2
    v_lshl_add_u32 v12, v7, 3, v12
    v_lshl_add_u32 v13, v7, 3, v13
    v_lshrrev_b32 v4, 2, v2
    v_and_b32 v6, 1, v3
    v_lshrrev_b32 v7, 1, v3
    v_lshlrev_b32 v5, 4, v7
    v_lshl_add_u32 v5, v6, 2, v5
    v_lshrrev_b32 v6, 1, v4
    v_lshl_add_u32 v5, v6, 3, v5
    v_and_b32 v6, 1, v4
    v_add_u32 v5, v5, v6
    v_lshrrev_b32 v6, 1, v5
    v_xor_b32 v6, v6, v5
    v_bfe_u32 v6, v6, 1, 1
    v_lshrrev_b32 v7, 2, v5
    v_xor_b32 v7, v7, v5
    v_bfe_u32 v7, v7, 3, 1
    v_lshl_add_u32 v6, v7, 1, v6
    v_bfe_u32 v4, v2, 1, 1
    v_lshl_add_u32 v15, v6, 1, v4
    v_lshlrev_b32 v15, 4, v15
    v_lshl_add_u32 v15, v5, 7, v15
    v_and_b32 v7, 1, v5
    v_lshl_add_u32 v6, v6, 1, v7
    v_lshl_add_u32 v14, v6, 1, v4
    v_lshlrev_b32 v14, 4, v14
    v_lshl_add_u32 v14, v5, 8, v14
    v_and_b32 v7, 1, v2
    v_lshl_add_u32 v14, v7, 3, v14
    v_lshl_add_u32 v15, v7, 3, v15
    s_mov_b32 s64, s14
    s_and_b32 s65, s15, 0xffff
    s_mov_b32 s66, 5242880
    s_mov_b32 s67, 0x20000
    s_mov_b32 s68, s16
    s_and_b32 s69, s17, 0xffff
    s_mov_b32 s70, 5242880
    s_mov_b32 s71, 0x20000
    s_mov_b32 s72, s18
    s_and_b32 s73, s19, 0xffff
    s_mov_b32 s74, 5242880
    s_mov_b32 s75, 0x20000
    s_mov_b32 s8, s20
    s_and_b32 s9, s21, 0xffff
    s_mov_b32 s10, 5242880
    s_mov_b32 s11, 0x20000
    s_lshl_b32 s76, s27, 8
    s_lshl_b32 s46, s26, 7
    s_add_u32 s77, s76, s46
    s_lshl_b32 s78, s28, 12
    s_lshl_b32 s79, s28, 11
    s_mul_i32 s80, s26, 2621440
    s_mul_i32 s81, s27, 163840
    s_mul_i32 s46, s26, 640
    s_add_u32 s81, s81, s46
    s_lshl_b32 s52, s28, 6
    s_lshl_b32 s82, s26, 5
    s_xor_b32 s82, s82, s52
    s_lshl_b32 s53, s28, 5
    s_and_b32 s62, s28, 1
    s_lshl_b32 s62, s62, 7
    s_lshr_b32 s63, s28, 1
    s_lshl_b32 s63, s63, 14
    s_add_u32 s47, s80, 0
    s_add_u32 s48, s47, s77
    s_add_u32 s47, s47, s76
    v_xor_b32 v4, 0, v8
    v_add_u32 v4, v4, v144
    s_add_u32 m0, s78, 0
    s_add_u32 s46, s47, 0
    buffer_load_dwordx4 v4, s[64:67], s46 offen lds
    s_add_u32 m0, s78, 16384
    s_add_u32 s46, s47, 0
    buffer_load_dwordx4 v4, s[68:71], s46 offen lds
    v_xor_b32 v4, 64, v8
    v_add_u32 v4, v4, v144
    s_add_u32 m0, s78, 1024
    s_add_u32 s46, s47, 32768
    buffer_load_dwordx4 v4, s[64:67], s46 offen lds
    s_add_u32 m0, s78, 17408
    s_add_u32 s46, s47, 32768
    buffer_load_dwordx4 v4, s[68:71], s46 offen lds
    v_xor_b32 v4, 128, v8
    v_add_u32 v4, v4, v144
    s_add_u32 m0, s78, 2048
    s_add_u32 s46, s47, 65536
    buffer_load_dwordx4 v4, s[64:67], s46 offen lds
    s_add_u32 m0, s78, 18432
    s_add_u32 s46, s47, 65536
    buffer_load_dwordx4 v4, s[68:71], s46 offen lds
    v_xor_b32 v4, 192, v8
    v_add_u32 v4, v4, v144
    s_add_u32 m0, s78, 3072
    s_add_u32 s46, s47, 98304
    buffer_load_dwordx4 v4, s[64:67], s46 offen lds
    s_add_u32 m0, s78, 19456
    s_add_u32 s46, s47, 98304
    buffer_load_dwordx4 v4, s[68:71], s46 offen lds
    v_xor_b32 v4, 0, v9
    v_add_u32 v4, v4, v145
    s_add_u32 m0, s79, 32768
    s_add_u32 s46, s48, 0
    buffer_load_dwordx4 v4, s[72:75], s46 offen lds
    v_xor_b32 v4, 64, v9
    v_add_u32 v4, v4, v145
    s_add_u32 m0, s79, 33792
    s_add_u32 s46, s48, 65536
    buffer_load_dwordx4 v4, s[72:75], s46 offen lds
    s_add_u32 s47, s80, 524288
    s_add_u32 s48, s47, s77
    s_add_u32 s47, s47, s76
    v_xor_b32 v4, 0, v8
    v_add_u32 v4, v4, v144
    s_add_u32 m0, s78, 40960
    s_add_u32 s46, s47, 0
    buffer_load_dwordx4 v4, s[64:67], s46 offen lds
    s_add_u32 m0, s78, 57344
    s_add_u32 s46, s47, 0
    buffer_load_dwordx4 v4, s[68:71], s46 offen lds
    v_xor_b32 v4, 64, v8
    v_add_u32 v4, v4, v144
    s_add_u32 m0, s78, 41984
    s_add_u32 s46, s47, 32768
    buffer_load_dwordx4 v4, s[64:67], s46 offen lds
    s_add_u32 m0, s78, 58368
    s_add_u32 s46, s47, 32768
    buffer_load_dwordx4 v4, s[68:71], s46 offen lds
    v_xor_b32 v4, 128, v8
    v_add_u32 v4, v4, v144
    s_add_u32 m0, s78, 43008
    s_add_u32 s46, s47, 65536
    buffer_load_dwordx4 v4, s[64:67], s46 offen lds
    s_add_u32 m0, s78, 59392
    s_add_u32 s46, s47, 65536
    buffer_load_dwordx4 v4, s[68:71], s46 offen lds
    v_xor_b32 v4, 192, v8
    v_add_u32 v4, v4, v144
    s_add_u32 m0, s78, 44032
    s_add_u32 s46, s47, 98304
    buffer_load_dwordx4 v4, s[64:67], s46 offen lds
    s_add_u32 m0, s78, 60416
    s_add_u32 s46, s47, 98304
    buffer_load_dwordx4 v4, s[68:71], s46 offen lds
    v_xor_b32 v4, 0, v9
    v_add_u32 v4, v4, v145
    s_add_u32 m0, s79, 73728
    s_add_u32 s46, s48, 0
    buffer_load_dwordx4 v4, s[72:75], s46 offen lds
    v_xor_b32 v4, 64, v9
    v_add_u32 v4, v4, v145
    s_add_u32 m0, s79, 74752
    s_add_u32 s46, s48, 65536
    buffer_load_dwordx4 v4, s[72:75], s46 offen lds
    s_add_u32 s47, s80, 1048576
    s_add_u32 s48, s47, s77
    s_add_u32 s47, s47, s76
    v_xor_b32 v4, 0, v8
    v_add_u32 v4, v4, v144
    s_add_u32 m0, s78, 81920
    s_add_u32 s46, s47, 0
    buffer_load_dwordx4 v4, s[64:67], s46 offen lds
    s_add_u32 m0, s78, 98304
    s_add_u32 s46, s47, 0
    buffer_load_dwordx4 v4, s[68:71], s46 offen lds
    v_xor_b32 v4, 64, v8
    v_add_u32 v4, v4, v144
    s_add_u32 m0, s78, 82944
    s_add_u32 s46, s47, 32768
    buffer_load_dwordx4 v4, s[64:67], s46 offen lds
    s_add_u32 m0, s78, 99328
    s_add_u32 s46, s47, 32768
    buffer_load_dwordx4 v4, s[68:71], s46 offen lds
    v_xor_b32 v4, 128, v8
    v_add_u32 v4, v4, v144
    s_add_u32 m0, s78, 83968
    s_add_u32 s46, s47, 65536
    buffer_load_dwordx4 v4, s[64:67], s46 offen lds
    s_add_u32 m0, s78, 100352
    s_add_u32 s46, s47, 65536
    buffer_load_dwordx4 v4, s[68:71], s46 offen lds
    v_xor_b32 v4, 192, v8
    v_add_u32 v4, v4, v144
    s_add_u32 m0, s78, 84992
    s_add_u32 s46, s47, 98304
    buffer_load_dwordx4 v4, s[64:67], s46 offen lds
    s_add_u32 m0, s78, 101376
    s_add_u32 s46, s47, 98304
    buffer_load_dwordx4 v4, s[68:71], s46 offen lds
    v_xor_b32 v4, 0, v9
    v_add_u32 v4, v4, v145
    s_add_u32 m0, s79, 114688
    s_add_u32 s46, s48, 0
    buffer_load_dwordx4 v4, s[72:75], s46 offen lds
    v_xor_b32 v4, 64, v9
    v_add_u32 v4, v4, v145
    s_add_u32 m0, s79, 115712
    s_add_u32 s46, s48, 65536
    buffer_load_dwordx4 v4, s[72:75], s46 offen lds
    s_waitcnt vmcnt(20) lgkmcnt(0)
    s_barrier
    s_add_u32 s47, s80, 1572864
    s_add_u32 s48, s47, s77
    s_add_u32 s47, s47, s76
    v_xor_b32 v4, 0, v8
    v_add_u32 v4, v4, v144
    s_add_u32 m0, s78, 122880
    s_add_u32 s46, s47, 0
    buffer_load_dwordx4 v4, s[64:67], s46 offen lds
    s_add_u32 m0, s78, 139264
    s_add_u32 s46, s47, 0
    buffer_load_dwordx4 v4, s[68:71], s46 offen lds
    v_xor_b32 v4, 64, v8
    v_add_u32 v4, v4, v144
    s_add_u32 m0, s78, 123904
    s_add_u32 s46, s47, 32768
    buffer_load_dwordx4 v4, s[64:67], s46 offen lds
    s_add_u32 m0, s78, 140288
    s_add_u32 s46, s47, 32768
    buffer_load_dwordx4 v4, s[68:71], s46 offen lds
    v_xor_b32 v4, 128, v8
    v_add_u32 v4, v4, v144
    s_add_u32 m0, s78, 124928
    s_add_u32 s46, s47, 65536
    buffer_load_dwordx4 v4, s[64:67], s46 offen lds
    s_add_u32 m0, s78, 141312
    s_add_u32 s46, s47, 65536
    buffer_load_dwordx4 v4, s[68:71], s46 offen lds
    v_xor_b32 v4, 192, v8
    v_add_u32 v4, v4, v144
    s_add_u32 m0, s78, 125952
    s_add_u32 s46, s47, 98304
    buffer_load_dwordx4 v4, s[64:67], s46 offen lds
    s_add_u32 m0, s78, 142336
    s_add_u32 s46, s47, 98304
    buffer_load_dwordx4 v4, s[68:71], s46 offen lds
    v_xor_b32 v4, 0, v9
    v_add_u32 v4, v4, v145
    s_add_u32 m0, s79, 155648
    s_add_u32 s46, s48, 0
    buffer_load_dwordx4 v4, s[72:75], s46 offen lds
    v_xor_b32 v4, 64, v9
    v_add_u32 v4, v4, v145
    s_add_u32 m0, s79, 156672
    s_add_u32 s46, s48, 65536
    buffer_load_dwordx4 v4, s[72:75], s46 offen lds
    v_xor_b32 v5, s82, v12
    v_xor_b32 v4, s52, v12
    ds_read_b64_tr_b16 v[16:17], v4 offset:0
    ds_read_b64_tr_b16 v[96:97], v5 offset:16384
    v_xor_b32 v5, s82, v12
    v_xor_b32 v5, 32, v5
    v_xor_b32 v4, s52, v12
    v_xor_b32 v4, 32, v4
    ds_read_b64_tr_b16 v[24:25], v4 offset:0
    ds_read_b64_tr_b16 a[112:113], v5 offset:16384
    v_xor_b32 v4, s53, v13
    ds_read_b64_tr_b16 a[192:193], v4 offset:32768
    v_xor_b32 v5, s82, v12
    v_xor_b32 v4, s52, v12
    ds_read_b64_tr_b16 v[18:19], v4 offset:4096
    ds_read_b64_tr_b16 v[98:99], v5 offset:20480
    v_xor_b32 v5, s82, v12
    v_xor_b32 v5, 32, v5
    v_xor_b32 v4, s52, v12
    v_xor_b32 v4, 32, v4
    ds_read_b64_tr_b16 v[26:27], v4 offset:4096
    ds_read_b64_tr_b16 a[114:115], v5 offset:20480
    v_xor_b32 v4, s53, v13
    ds_read_b64_tr_b16 a[194:195], v4 offset:34816
    v_xor_b32 v5, s82, v12
    v_xor_b32 v5, 128, v5
    v_xor_b32 v4, s52, v12
    v_xor_b32 v4, 128, v4
    ds_read_b64_tr_b16 v[20:21], v4 offset:2048
    ds_read_b64_tr_b16 v[100:101], v5 offset:18432
    v_xor_b32 v5, s82, v12
    v_xor_b32 v5, 160, v5
    v_xor_b32 v4, s52, v12
    v_xor_b32 v4, 160, v4
    ds_read_b64_tr_b16 v[28:29], v4 offset:2048
    ds_read_b64_tr_b16 a[116:117], v5 offset:18432
    v_xor_b32 v4, s53, v13
    v_xor_b32 v4, 64, v4
    ds_read_b64_tr_b16 a[196:197], v4 offset:33792
    v_xor_b32 v5, s82, v12
    v_xor_b32 v5, 128, v5
    v_xor_b32 v4, s52, v12
    v_xor_b32 v4, 128, v4
    ds_read_b64_tr_b16 v[22:23], v4 offset:6144
    ds_read_b64_tr_b16 v[102:103], v5 offset:22528
    v_xor_b32 v5, s82, v12
    v_xor_b32 v5, 160, v5
    v_xor_b32 v4, s52, v12
    v_xor_b32 v4, 160, v4
    ds_read_b64_tr_b16 v[30:31], v4 offset:6144
    ds_read_b64_tr_b16 a[118:119], v5 offset:22528
    v_xor_b32 v4, s53, v13
    v_xor_b32 v4, 64, v4
    ds_read_b64_tr_b16 a[198:199], v4 offset:35840
    s_waitcnt vmcnt(20) lgkmcnt(0)
    s_barrier
    s_add_u32 s47, s80, 2097152
    s_add_u32 s48, s47, s77
    s_add_u32 s47, s47, s76
    v_xor_b32 v4, 0, v8
    v_add_u32 v4, v4, v144
    s_add_u32 m0, s78, 0
    s_add_u32 s46, s47, 0
    buffer_load_dwordx4 v4, s[64:67], s46 offen lds
    s_add_u32 m0, s78, 16384
    s_add_u32 s46, s47, 0
    buffer_load_dwordx4 v4, s[68:71], s46 offen lds
    v_xor_b32 v4, 64, v8
    v_add_u32 v4, v4, v144
    s_add_u32 m0, s78, 1024
    s_add_u32 s46, s47, 32768
    buffer_load_dwordx4 v4, s[64:67], s46 offen lds
    s_add_u32 m0, s78, 17408
    s_add_u32 s46, s47, 32768
    buffer_load_dwordx4 v4, s[68:71], s46 offen lds
    v_xor_b32 v4, 128, v8
    v_add_u32 v4, v4, v144
    s_add_u32 m0, s78, 2048
    s_add_u32 s46, s47, 65536
    buffer_load_dwordx4 v4, s[64:67], s46 offen lds
    s_add_u32 m0, s78, 18432
    s_add_u32 s46, s47, 65536
    buffer_load_dwordx4 v4, s[68:71], s46 offen lds
    v_xor_b32 v4, 192, v8
    v_add_u32 v4, v4, v144
    s_add_u32 m0, s78, 3072
    s_add_u32 s46, s47, 98304
    buffer_load_dwordx4 v4, s[64:67], s46 offen lds
    s_add_u32 m0, s78, 19456
    s_add_u32 s46, s47, 98304
    buffer_load_dwordx4 v4, s[68:71], s46 offen lds
    v_xor_b32 v4, 0, v9
    v_add_u32 v4, v4, v145
    s_add_u32 m0, s79, 32768
    s_add_u32 s46, s48, 0
    buffer_load_dwordx4 v4, s[72:75], s46 offen lds
    v_xor_b32 v4, 64, v9
    v_add_u32 v4, v4, v145
    s_add_u32 m0, s79, 33792
    s_add_u32 s46, s48, 65536
    buffer_load_dwordx4 v4, s[72:75], s46 offen lds
    v_xor_b32 v5, s82, v12
    v_add_u32 v5, 40960, v5
    v_xor_b32 v4, s52, v12
    v_add_u32 v4, 40960, v4
    ds_read_b64_tr_b16 v[32:33], v4 offset:0
    ds_read_b64_tr_b16 a[48:49], v5 offset:16384
    v_xor_b32 v5, s82, v12
    v_xor_b32 v5, 32, v5
    v_add_u32 v5, 40960, v5
    v_xor_b32 v4, s52, v12
    v_xor_b32 v4, 32, v4
    v_add_u32 v4, 40960, v4
    ds_read_b64_tr_b16 v[40:41], v4 offset:0
    ds_read_b64_tr_b16 a[120:121], v5 offset:16384
    v_xor_b32 v4, s53, v13
    v_add_u32 v4, 40960, v4
    ds_read_b64_tr_b16 a[200:201], v4 offset:32768
    v_xor_b32 v5, s82, v12
    v_add_u32 v5, 40960, v5
    v_xor_b32 v4, s52, v12
    v_add_u32 v4, 40960, v4
    ds_read_b64_tr_b16 v[34:35], v4 offset:4096
    ds_read_b64_tr_b16 a[50:51], v5 offset:20480
    v_xor_b32 v5, s82, v12
    v_xor_b32 v5, 32, v5
    v_add_u32 v5, 40960, v5
    v_xor_b32 v4, s52, v12
    v_xor_b32 v4, 32, v4
    v_add_u32 v4, 40960, v4
    ds_read_b64_tr_b16 v[42:43], v4 offset:4096
    ds_read_b64_tr_b16 a[122:123], v5 offset:20480
    v_xor_b32 v4, s53, v13
    v_add_u32 v4, 40960, v4
    ds_read_b64_tr_b16 a[202:203], v4 offset:34816
    v_xor_b32 v5, s82, v12
    v_xor_b32 v5, 128, v5
    v_add_u32 v5, 40960, v5
    v_xor_b32 v4, s52, v12
    v_xor_b32 v4, 128, v4
    v_add_u32 v4, 40960, v4
    ds_read_b64_tr_b16 v[36:37], v4 offset:2048
    ds_read_b64_tr_b16 a[52:53], v5 offset:18432
    v_xor_b32 v5, s82, v12
    v_xor_b32 v5, 160, v5
    v_add_u32 v5, 40960, v5
    v_xor_b32 v4, s52, v12
    v_xor_b32 v4, 160, v4
    v_add_u32 v4, 40960, v4
    ds_read_b64_tr_b16 v[44:45], v4 offset:2048
    ds_read_b64_tr_b16 a[124:125], v5 offset:18432
    v_xor_b32 v4, s53, v13
    v_xor_b32 v4, 64, v4
    v_add_u32 v4, 40960, v4
    ds_read_b64_tr_b16 a[204:205], v4 offset:33792
    v_xor_b32 v5, s82, v12
    v_xor_b32 v5, 128, v5
    v_add_u32 v5, 40960, v5
    v_xor_b32 v4, s52, v12
    v_xor_b32 v4, 128, v4
    v_add_u32 v4, 40960, v4
    ds_read_b64_tr_b16 v[38:39], v4 offset:6144
    ds_read_b64_tr_b16 a[54:55], v5 offset:22528
    v_xor_b32 v5, s82, v12
    v_xor_b32 v5, 160, v5
    v_add_u32 v5, 40960, v5
    v_xor_b32 v4, s52, v12
    v_xor_b32 v4, 160, v4
    v_add_u32 v4, 40960, v4
    ds_read_b64_tr_b16 v[46:47], v4 offset:6144
    ds_read_b64_tr_b16 a[126:127], v5 offset:22528
    v_xor_b32 v4, s53, v13
    v_xor_b32 v4, 64, v4
    v_add_u32 v4, 40960, v4
    ds_read_b64_tr_b16 a[206:207], v4 offset:35840
    s_waitcnt vmcnt(20) lgkmcnt(0)
    s_barrier
    s_sub_u32 s47, 2621440, s80
    s_add_u32 s48, s47, s77
    s_add_u32 s47, s47, s76
    v_xor_b32 v4, 0, v8
    v_add_u32 v4, v4, v144
    s_add_u32 m0, s78, 40960
    s_add_u32 s46, s47, 0
    buffer_load_dwordx4 v4, s[64:67], s46 offen lds
    s_add_u32 m0, s78, 57344
    s_add_u32 s46, s47, 0
    buffer_load_dwordx4 v4, s[68:71], s46 offen lds
    v_xor_b32 v4, 64, v8
    v_add_u32 v4, v4, v144
    s_add_u32 m0, s78, 41984
    s_add_u32 s46, s47, 32768
    buffer_load_dwordx4 v4, s[64:67], s46 offen lds
    s_add_u32 m0, s78, 58368
    s_add_u32 s46, s47, 32768
    buffer_load_dwordx4 v4, s[68:71], s46 offen lds
    v_xor_b32 v4, 128, v8
    v_add_u32 v4, v4, v144
    s_add_u32 m0, s78, 43008
    s_add_u32 s46, s47, 65536
    buffer_load_dwordx4 v4, s[64:67], s46 offen lds
    s_add_u32 m0, s78, 59392
    s_add_u32 s46, s47, 65536
    buffer_load_dwordx4 v4, s[68:71], s46 offen lds
    v_xor_b32 v4, 192, v8
    v_add_u32 v4, v4, v144
    s_add_u32 m0, s78, 44032
    s_add_u32 s46, s47, 98304
    buffer_load_dwordx4 v4, s[64:67], s46 offen lds
    s_add_u32 m0, s78, 60416
    s_add_u32 s46, s47, 98304
    buffer_load_dwordx4 v4, s[68:71], s46 offen lds
    v_xor_b32 v4, 0, v9
    v_add_u32 v4, v4, v145
    s_add_u32 m0, s79, 73728
    s_add_u32 s46, s48, 0
    buffer_load_dwordx4 v4, s[72:75], s46 offen lds
    v_xor_b32 v4, 64, v9
    v_add_u32 v4, v4, v145
    s_add_u32 m0, s79, 74752
    s_add_u32 s46, s48, 65536
    buffer_load_dwordx4 v4, s[72:75], s46 offen lds
    v_xor_b32 v5, s82, v12
    v_add_u32 v5, 81920, v5
    v_xor_b32 v4, s52, v12
    v_add_u32 v4, 81920, v4
    ds_read_b64_tr_b16 v[48:49], v4 offset:0
    ds_read_b64_tr_b16 v[104:105], v5 offset:16384
    v_xor_b32 v5, s82, v12
    v_xor_b32 v5, 32, v5
    v_add_u32 v5, 81920, v5
    v_xor_b32 v4, s52, v12
    v_xor_b32 v4, 32, v4
    v_add_u32 v4, 81920, v4
    ds_read_b64_tr_b16 v[56:57], v4 offset:0
    ds_read_b64_tr_b16 a[128:129], v5 offset:16384
    v_xor_b32 v4, s53, v13
    v_add_u32 v4, 81920, v4
    ds_read_b64_tr_b16 a[208:209], v4 offset:32768
    v_xor_b32 v5, s82, v12
    v_add_u32 v5, 81920, v5
    v_xor_b32 v4, s52, v12
    v_add_u32 v4, 81920, v4
    ds_read_b64_tr_b16 v[50:51], v4 offset:4096
    ds_read_b64_tr_b16 v[106:107], v5 offset:20480
    v_xor_b32 v5, s82, v12
    v_xor_b32 v5, 32, v5
    v_add_u32 v5, 81920, v5
    v_xor_b32 v4, s52, v12
    v_xor_b32 v4, 32, v4
    v_add_u32 v4, 81920, v4
    ds_read_b64_tr_b16 v[58:59], v4 offset:4096
    ds_read_b64_tr_b16 a[130:131], v5 offset:20480
    v_xor_b32 v4, s53, v13
    v_add_u32 v4, 81920, v4
    ds_read_b64_tr_b16 a[210:211], v4 offset:34816
    v_xor_b32 v5, s82, v12
    v_xor_b32 v5, 128, v5
    v_add_u32 v5, 81920, v5
    v_xor_b32 v4, s52, v12
    v_xor_b32 v4, 128, v4
    v_add_u32 v4, 81920, v4
    ds_read_b64_tr_b16 v[52:53], v4 offset:2048
    ds_read_b64_tr_b16 v[108:109], v5 offset:18432
    v_xor_b32 v5, s82, v12
    v_xor_b32 v5, 160, v5
    v_add_u32 v5, 81920, v5
    v_xor_b32 v4, s52, v12
    v_xor_b32 v4, 160, v4
    v_add_u32 v4, 81920, v4
    ds_read_b64_tr_b16 v[60:61], v4 offset:2048
    ds_read_b64_tr_b16 a[132:133], v5 offset:18432
    v_xor_b32 v4, s53, v13
    v_xor_b32 v4, 64, v4
    v_add_u32 v4, 81920, v4
    ds_read_b64_tr_b16 a[212:213], v4 offset:33792
    v_xor_b32 v5, s82, v12
    v_xor_b32 v5, 128, v5
    v_add_u32 v5, 81920, v5
    v_xor_b32 v4, s52, v12
    v_xor_b32 v4, 128, v4
    v_add_u32 v4, 81920, v4
    ds_read_b64_tr_b16 v[54:55], v4 offset:6144
    ds_read_b64_tr_b16 v[110:111], v5 offset:22528
    v_xor_b32 v5, s82, v12
    v_xor_b32 v5, 160, v5
    v_add_u32 v5, 81920, v5
    v_xor_b32 v4, s52, v12
    v_xor_b32 v4, 160, v4
    v_add_u32 v4, 81920, v4
    ds_read_b64_tr_b16 v[62:63], v4 offset:6144
    ds_read_b64_tr_b16 a[134:135], v5 offset:22528
    v_xor_b32 v4, s53, v13
    v_xor_b32 v4, 64, v4
    v_add_u32 v4, 81920, v4
    ds_read_b64_tr_b16 a[214:215], v4 offset:35840
    s_waitcnt vmcnt(20) lgkmcnt(0)
    s_barrier
    s_sub_u32 s47, 3145728, s80
    s_add_u32 s48, s47, s77
    s_add_u32 s47, s47, s76
    v_xor_b32 v4, 0, v8
    v_add_u32 v4, v4, v144
    s_add_u32 m0, s78, 81920
    s_add_u32 s46, s47, 0
    buffer_load_dwordx4 v4, s[64:67], s46 offen lds
    s_add_u32 m0, s78, 98304
    s_add_u32 s46, s47, 0
    buffer_load_dwordx4 v4, s[68:71], s46 offen lds
    v_xor_b32 v4, 64, v8
    v_add_u32 v4, v4, v144
    s_add_u32 m0, s78, 82944
    s_add_u32 s46, s47, 32768
    buffer_load_dwordx4 v4, s[64:67], s46 offen lds
    s_add_u32 m0, s78, 99328
    s_add_u32 s46, s47, 32768
    buffer_load_dwordx4 v4, s[68:71], s46 offen lds
    v_xor_b32 v4, 128, v8
    v_add_u32 v4, v4, v144
    s_add_u32 m0, s78, 83968
    s_add_u32 s46, s47, 65536
    buffer_load_dwordx4 v4, s[64:67], s46 offen lds
    s_add_u32 m0, s78, 100352
    s_add_u32 s46, s47, 65536
    buffer_load_dwordx4 v4, s[68:71], s46 offen lds
    v_xor_b32 v4, 192, v8
    v_add_u32 v4, v4, v144
    s_add_u32 m0, s78, 84992
    s_add_u32 s46, s47, 98304
    buffer_load_dwordx4 v4, s[64:67], s46 offen lds
    s_add_u32 m0, s78, 101376
    s_add_u32 s46, s47, 98304
    buffer_load_dwordx4 v4, s[68:71], s46 offen lds
    v_xor_b32 v4, 0, v9
    v_add_u32 v4, v4, v145
    s_add_u32 m0, s79, 114688
    s_add_u32 s46, s48, 0
    buffer_load_dwordx4 v4, s[72:75], s46 offen lds
    v_xor_b32 v4, 64, v9
    v_add_u32 v4, v4, v145
    s_add_u32 m0, s79, 115712
    s_add_u32 s46, s48, 65536
    buffer_load_dwordx4 v4, s[72:75], s46 offen lds
    v_xor_b32 v5, s82, v12
    v_add_u32 v5, 122880, v5
    v_xor_b32 v4, s52, v12
    v_add_u32 v4, 122880, v4
    ds_read_b64_tr_b16 v[64:65], v4 offset:0
    ds_read_b64_tr_b16 a[56:57], v5 offset:16384
    v_xor_b32 v5, s82, v12
    v_xor_b32 v5, 32, v5
    v_add_u32 v5, 122880, v5
    v_xor_b32 v4, s52, v12
    v_xor_b32 v4, 32, v4
    v_add_u32 v4, 122880, v4
    ds_read_b64_tr_b16 v[72:73], v4 offset:0
    ds_read_b64_tr_b16 a[136:137], v5 offset:16384
    v_xor_b32 v4, s53, v13
    v_add_u32 v4, 122880, v4
    ds_read_b64_tr_b16 a[216:217], v4 offset:32768
    v_xor_b32 v5, s82, v12
    v_add_u32 v5, 122880, v5
    v_xor_b32 v4, s52, v12
    v_add_u32 v4, 122880, v4
    ds_read_b64_tr_b16 v[66:67], v4 offset:4096
    ds_read_b64_tr_b16 a[58:59], v5 offset:20480
    v_xor_b32 v5, s82, v12
    v_xor_b32 v5, 32, v5
    v_add_u32 v5, 122880, v5
    v_xor_b32 v4, s52, v12
    v_xor_b32 v4, 32, v4
    v_add_u32 v4, 122880, v4
    ds_read_b64_tr_b16 v[74:75], v4 offset:4096
    ds_read_b64_tr_b16 a[138:139], v5 offset:20480
    v_xor_b32 v4, s53, v13
    v_add_u32 v4, 122880, v4
    ds_read_b64_tr_b16 a[218:219], v4 offset:34816
    v_xor_b32 v5, s82, v12
    v_xor_b32 v5, 128, v5
    v_add_u32 v5, 122880, v5
    v_xor_b32 v4, s52, v12
    v_xor_b32 v4, 128, v4
    v_add_u32 v4, 122880, v4
    ds_read_b64_tr_b16 v[68:69], v4 offset:2048
    ds_read_b64_tr_b16 a[60:61], v5 offset:18432
    v_xor_b32 v5, s82, v12
    v_xor_b32 v5, 160, v5
    v_add_u32 v5, 122880, v5
    v_xor_b32 v4, s52, v12
    v_xor_b32 v4, 160, v4
    v_add_u32 v4, 122880, v4
    ds_read_b64_tr_b16 v[76:77], v4 offset:2048
    ds_read_b64_tr_b16 a[140:141], v5 offset:18432
    v_xor_b32 v4, s53, v13
    v_xor_b32 v4, 64, v4
    v_add_u32 v4, 122880, v4
    ds_read_b64_tr_b16 a[220:221], v4 offset:33792
    v_xor_b32 v5, s82, v12
    v_xor_b32 v5, 128, v5
    v_add_u32 v5, 122880, v5
    v_xor_b32 v4, s52, v12
    v_xor_b32 v4, 128, v4
    v_add_u32 v4, 122880, v4
    ds_read_b64_tr_b16 v[70:71], v4 offset:6144
    ds_read_b64_tr_b16 a[62:63], v5 offset:22528
    v_xor_b32 v5, s82, v12
    v_xor_b32 v5, 160, v5
    v_add_u32 v5, 122880, v5
    v_xor_b32 v4, s52, v12
    v_xor_b32 v4, 160, v4
    v_add_u32 v4, 122880, v4
    ds_read_b64_tr_b16 v[78:79], v4 offset:6144
    ds_read_b64_tr_b16 a[142:143], v5 offset:22528
    v_xor_b32 v4, s53, v13
    v_xor_b32 v4, 64, v4
    v_add_u32 v4, 122880, v4
    ds_read_b64_tr_b16 a[222:223], v4 offset:35840
    s_waitcnt vmcnt(20) lgkmcnt(0)
    s_barrier
    v_mov_b32 v154, 0
    global_load_dwordx4 v[156:159], v154, s[22:23] offset:128 sc1
    s_sub_u32 s47, 3670016, s80
    s_add_u32 s48, s47, s77
    s_add_u32 s47, s47, s76
    v_xor_b32 v4, 0, v8
    v_add_u32 v4, v4, v144
    s_add_u32 m0, s78, 122880
    s_add_u32 s46, s47, 0
    buffer_load_dwordx4 v4, s[64:67], s46 offen lds
    s_add_u32 m0, s78, 139264
    s_add_u32 s46, s47, 0
    buffer_load_dwordx4 v4, s[68:71], s46 offen lds
    v_xor_b32 v4, 64, v8
    v_add_u32 v4, v4, v144
    s_add_u32 m0, s78, 123904
    s_add_u32 s46, s47, 32768
    buffer_load_dwordx4 v4, s[64:67], s46 offen lds
    s_add_u32 m0, s78, 140288
    s_add_u32 s46, s47, 32768
    buffer_load_dwordx4 v4, s[68:71], s46 offen lds
    v_xor_b32 v4, 128, v8
    v_add_u32 v4, v4, v144
    s_add_u32 m0, s78, 124928
    s_add_u32 s46, s47, 65536
    buffer_load_dwordx4 v4, s[64:67], s46 offen lds
    s_add_u32 m0, s78, 141312
    s_add_u32 s46, s47, 65536
    buffer_load_dwordx4 v4, s[68:71], s46 offen lds
    v_xor_b32 v4, 192, v8
    v_add_u32 v4, v4, v144
    s_add_u32 m0, s78, 125952
    s_add_u32 s46, s47, 98304
    buffer_load_dwordx4 v4, s[64:67], s46 offen lds
    s_add_u32 m0, s78, 142336
    s_add_u32 s46, s47, 98304
    buffer_load_dwordx4 v4, s[68:71], s46 offen lds
    v_xor_b32 v4, 0, v9
    v_add_u32 v4, v4, v145
    s_add_u32 m0, s79, 155648
    s_add_u32 s46, s48, 0
    buffer_load_dwordx4 v4, s[72:75], s46 offen lds
    v_xor_b32 v4, 64, v9
    v_add_u32 v4, v4, v145
    s_add_u32 m0, s79, 156672
    s_add_u32 s46, s48, 65536
    buffer_load_dwordx4 v4, s[72:75], s46 offen lds
    v_xor_b32 v5, s82, v14
    v_xor_b32 v4, s52, v14
    ds_read_b64_tr_b16 v[80:81], v4 offset:0
    ds_read_b64_tr_b16 a[64:65], v5 offset:16384
    v_xor_b32 v5, s82, v14
    v_xor_b32 v5, 32, v5
    v_xor_b32 v4, s52, v14
    v_xor_b32 v4, 32, v4
    ds_read_b64_tr_b16 v[88:89], v4 offset:0
    ds_read_b64_tr_b16 a[144:145], v5 offset:16384
    v_xor_b32 v4, s53, v15
    ds_read_b64_tr_b16 a[224:225], v4 offset:32768
    v_xor_b32 v5, s82, v14
    v_xor_b32 v5, 64, v5
    v_xor_b32 v4, s52, v14
    v_xor_b32 v4, 64, v4
    ds_read_b64_tr_b16 v[82:83], v4 offset:512
    ds_read_b64_tr_b16 a[66:67], v5 offset:16896
    v_xor_b32 v5, s82, v14
    v_xor_b32 v5, 96, v5
    v_xor_b32 v4, s52, v14
    v_xor_b32 v4, 96, v4
    ds_read_b64_tr_b16 v[90:91], v4 offset:512
    ds_read_b64_tr_b16 a[146:147], v5 offset:16896
    v_xor_b32 v4, s53, v15
    v_xor_b32 v4, 32, v4
    ds_read_b64_tr_b16 a[226:227], v4 offset:33024
    v_xor_b32 v5, s82, v14
    v_xor_b32 v5, 128, v5
    v_xor_b32 v4, s52, v14
    v_xor_b32 v4, 128, v4
    ds_read_b64_tr_b16 v[84:85], v4 offset:8192
    ds_read_b64_tr_b16 a[68:69], v5 offset:24576
    v_xor_b32 v5, s82, v14
    v_xor_b32 v5, 160, v5
    v_xor_b32 v4, s52, v14
    v_xor_b32 v4, 160, v4
    ds_read_b64_tr_b16 v[92:93], v4 offset:8192
    ds_read_b64_tr_b16 a[148:149], v5 offset:24576
    v_xor_b32 v4, s53, v15
    v_xor_b32 v4, 64, v4
    ds_read_b64_tr_b16 a[228:229], v4 offset:36864
    v_xor_b32 v5, s82, v14
    v_xor_b32 v5, 192, v5
    v_xor_b32 v4, s52, v14
    v_xor_b32 v4, 192, v4
    ds_read_b64_tr_b16 v[86:87], v4 offset:8704
    ds_read_b64_tr_b16 a[70:71], v5 offset:25088
    v_xor_b32 v5, s82, v14
    v_xor_b32 v5, 224, v5
    v_xor_b32 v4, s52, v14
    v_xor_b32 v4, 224, v4
    ds_read_b64_tr_b16 v[94:95], v4 offset:8704
    ds_read_b64_tr_b16 a[150:151], v5 offset:25088
    v_xor_b32 v4, s53, v15
    v_xor_b32 v4, 96, v4
    ds_read_b64_tr_b16 a[230:231], v4 offset:37120
    s_waitcnt vmcnt(20) lgkmcnt(0)
    s_barrier
    s_sub_u32 s47, 4194304, s80
    s_add_u32 s48, s47, s77
    s_add_u32 s47, s47, s76
    v_xor_b32 v4, 0, v8
    v_add_u32 v4, v4, v144
    s_add_u32 m0, s78, 0
    s_add_u32 s46, s47, 0
    buffer_load_dwordx4 v4, s[64:67], s46 offen lds
    s_add_u32 m0, s78, 16384
    s_add_u32 s46, s47, 0
    buffer_load_dwordx4 v4, s[68:71], s46 offen lds
    v_xor_b32 v4, 64, v8
    v_add_u32 v4, v4, v144
    s_add_u32 m0, s78, 1024
    s_add_u32 s46, s47, 32768
    buffer_load_dwordx4 v4, s[64:67], s46 offen lds
    s_add_u32 m0, s78, 17408
    s_add_u32 s46, s47, 32768
    buffer_load_dwordx4 v4, s[68:71], s46 offen lds
    v_xor_b32 v4, 128, v8
    v_add_u32 v4, v4, v144
    s_add_u32 m0, s78, 2048
    s_add_u32 s46, s47, 65536
    buffer_load_dwordx4 v4, s[64:67], s46 offen lds
    s_add_u32 m0, s78, 18432
    s_add_u32 s46, s47, 65536
    buffer_load_dwordx4 v4, s[68:71], s46 offen lds
    v_xor_b32 v4, 192, v8
    v_add_u32 v4, v4, v144
    s_add_u32 m0, s78, 3072
    s_add_u32 s46, s47, 98304
    buffer_load_dwordx4 v4, s[64:67], s46 offen lds
    s_add_u32 m0, s78, 19456
    s_add_u32 s46, s47, 98304
    buffer_load_dwordx4 v4, s[68:71], s46 offen lds
    v_xor_b32 v4, 0, v9
    v_add_u32 v4, v4, v145
    s_add_u32 m0, s79, 32768
    s_add_u32 s46, s48, 0
    buffer_load_dwordx4 v4, s[72:75], s46 offen lds
    v_xor_b32 v4, 64, v9
    v_add_u32 v4, v4, v145
    s_add_u32 m0, s79, 33792
    s_add_u32 s46, s48, 65536
    buffer_load_dwordx4 v4, s[72:75], s46 offen lds
    v_xor_b32 v5, s82, v12
    v_add_u32 v5, 40960, v5
    v_xor_b32 v4, s52, v12
    v_add_u32 v4, 40960, v4
    ds_read_b64_tr_b16 a[0:1], v4 offset:0
    ds_read_b64_tr_b16 a[72:73], v5 offset:16384
    v_xor_b32 v5, s82, v12
    v_xor_b32 v5, 32, v5
    v_add_u32 v5, 40960, v5
    v_xor_b32 v4, s52, v12
    v_xor_b32 v4, 32, v4
    v_add_u32 v4, 40960, v4
    ds_read_b64_tr_b16 v[112:113], v4 offset:0
    ds_read_b64_tr_b16 a[152:153], v5 offset:16384
    v_xor_b32 v4, s53, v13
    v_add_u32 v4, 40960, v4
    ds_read_b64_tr_b16 a[232:233], v4 offset:32768
    v_xor_b32 v5, s82, v12
    v_add_u32 v5, 40960, v5
    v_xor_b32 v4, s52, v12
    v_add_u32 v4, 40960, v4
    ds_read_b64_tr_b16 a[2:3], v4 offset:4096
    ds_read_b64_tr_b16 a[74:75], v5 offset:20480
    v_xor_b32 v5, s82, v12
    v_xor_b32 v5, 32, v5
    v_add_u32 v5, 40960, v5
    v_xor_b32 v4, s52, v12
    v_xor_b32 v4, 32, v4
    v_add_u32 v4, 40960, v4
    ds_read_b64_tr_b16 v[114:115], v4 offset:4096
    ds_read_b64_tr_b16 a[154:155], v5 offset:20480
    v_xor_b32 v4, s53, v13
    v_add_u32 v4, 40960, v4
    ds_read_b64_tr_b16 a[234:235], v4 offset:34816
    v_xor_b32 v5, s82, v12
    v_xor_b32 v5, 128, v5
    v_add_u32 v5, 40960, v5
    v_xor_b32 v4, s52, v12
    v_xor_b32 v4, 128, v4
    v_add_u32 v4, 40960, v4
    ds_read_b64_tr_b16 a[4:5], v4 offset:2048
    ds_read_b64_tr_b16 a[76:77], v5 offset:18432
    v_xor_b32 v5, s82, v12
    v_xor_b32 v5, 160, v5
    v_add_u32 v5, 40960, v5
    v_xor_b32 v4, s52, v12
    v_xor_b32 v4, 160, v4
    v_add_u32 v4, 40960, v4
    ds_read_b64_tr_b16 v[116:117], v4 offset:2048
    ds_read_b64_tr_b16 a[156:157], v5 offset:18432
    v_xor_b32 v4, s53, v13
    v_xor_b32 v4, 64, v4
    v_add_u32 v4, 40960, v4
    ds_read_b64_tr_b16 a[236:237], v4 offset:33792
    v_xor_b32 v5, s82, v12
    v_xor_b32 v5, 128, v5
    v_add_u32 v5, 40960, v5
    v_xor_b32 v4, s52, v12
    v_xor_b32 v4, 128, v4
    v_add_u32 v4, 40960, v4
    ds_read_b64_tr_b16 a[6:7], v4 offset:6144
    ds_read_b64_tr_b16 a[78:79], v5 offset:22528
    v_xor_b32 v5, s82, v12
    v_xor_b32 v5, 160, v5
    v_add_u32 v5, 40960, v5
    v_xor_b32 v4, s52, v12
    v_xor_b32 v4, 160, v4
    v_add_u32 v4, 40960, v4
    ds_read_b64_tr_b16 v[118:119], v4 offset:6144
    ds_read_b64_tr_b16 a[158:159], v5 offset:22528
    v_xor_b32 v4, s53, v13
    v_xor_b32 v4, 64, v4
    v_add_u32 v4, 40960, v4
    ds_read_b64_tr_b16 a[238:239], v4 offset:35840
    s_waitcnt vmcnt(20) lgkmcnt(0)
    s_barrier
    v_cmp_eq_u32 vcc, 0, v158
    s_cbranch_vccz L_gotpar_4
L_par_3:
    global_load_dwordx4 v[156:159], v154, s[22:23] offset:128 sc1
    s_waitcnt vmcnt(0)
    v_cmp_eq_u32 vcc, 0, v158
    s_cbranch_vccz L_ok_5
    s_sub_u32 s31, s31, 1
    s_cbranch_scc0 L_par_3
    s_mov_b32 s31, 0
L_ok_5:
L_gotpar_4:
    v_readfirstlane_b32 s96, v156
    v_readfirstlane_b32 s97, v157
    v_readfirstlane_b32 s51, v158
    s_nop 0
    s_and_b32 s51, s51, 8192
    v_mov_b32 v148, -1
    v_mov_b32 v149, -1
    v_mov_b32 v150, -1
    v_mov_b32 v151, -1
    s_lshl_b32 s46, s28, 15
    s_lshl_b32 s47, s27, 7
    s_add_u32 s46, s46, s47
    v_and_b32 v5, 1, v2
    v_lshl_add_u32 v5, v3, 1, v5
    v_lshlrev_b32 v5, 4, v5
    v_lshrrev_b32 v4, 1, v2
    v_lshl_add_u32 v152, v4, 12, v5
    v_add_u32 v152, s46, v152
    s_lshl_b32 s46, s28, 13
    s_add_u32 s46, s46, s47
    s_add_u32 s46, s46, 131072
    v_and_b32 v4, 3, v4
    v_lshl_add_u32 v153, v4, 2, v5
    v_lshrrev_b32 v4, 3, v2
    v_lshl_add_u32 v153, v4, 12, v153
    v_add_u32 v153, s46, v153
    s_mul_i32 s46, s26, 163840
    s_add_u32 s41, s46, 1048576
    s_lshl_b32 s46, s26, 20
    s_add_u32 s46, s46, 4194304
    s_add_u32 s33, s46, s51
    s_xor_b32 s32, s33, 8192
    s_xor_b32 s34, s33, 1048576
    s_mov_b32 s45, s32
    s_lshl_b32 s46, s26, 20
    s_lshl_b32 s47, s27, 15
    s_add_u32 s46, s46, s47
    s_xor_b32 s47, s51, 8192
    s_add_u32 s46, s46, s47
    s_add_u32 s42, s46, 6291456
    s_xor_b32 s43, s42, 1048576
    buffer_store_dwordx4 v[148:151], v152, s[4:7], s41 offen sc1
    buffer_store_dword v148, v153, s[4:7], s41 offen sc1
    v_lshlrev_b32 v4, 2, v0
    v_lshlrev_b32 v5, 4, v0
    s_add_u32 s46, s42, 0
    buffer_store_dwordx4 v[148:151], v5, s[4:7], s46 offen sc1
    s_add_u32 s46, s46, 117440512
    buffer_store_dwordx4 v[148:151], v5, s[4:7], s46 offen sc1
    s_add_u32 s46, s42, 4096
    buffer_store_dwordx4 v[148:151], v5, s[4:7], s46 offen sc1
    s_add_u32 s46, s46, 117440512
    buffer_store_dwordx4 v[148:151], v5, s[4:7], s46 offen sc1
    s_add_u32 s46, s42, 16384
    buffer_store_dwordx4 v[148:151], v5, s[4:7], s46 offen sc1
    s_add_u32 s46, s46, 117440512
    buffer_store_dwordx4 v[148:151], v5, s[4:7], s46 offen sc1
    s_add_u32 s46, s42, 20480
    buffer_store_dwordx4 v[148:151], v5, s[4:7], s46 offen sc1
    s_add_u32 s46, s46, 117440512
    buffer_store_dwordx4 v[148:151], v5, s[4:7], s46 offen sc1
    s_lshl_b32 s47, s27, 15
    s_add_u32 s46, s32, s47
    buffer_store_dwordx4 v[148:151], v5, s[4:7], s46 offen sc1
    s_add_u32 s46, s46, 4096
    buffer_store_dword v148, v4, s[4:7], s46 offen sc1
    s_add_u32 s46, s33, s47
    buffer_store_dwordx4 v[148:151], v5, s[4:7], s46 offen sc1
    s_add_u32 s46, s46, 4096
    buffer_store_dword v148, v4, s[4:7], s46 offen sc1
    s_add_u32 s46, s33, s47
    s_add_u32 s46, s46, 117440512
    buffer_store_dwordx4 v[148:151], v5, s[4:7], s46 offen sc1
    s_add_u32 s46, s46, 4096
    buffer_store_dword v148, v4, s[4:7], s46 offen sc1
    s_add_u32 s47, s47, 16384
    s_add_u32 s46, s32, s47
    buffer_store_dwordx4 v[148:151], v5, s[4:7], s46 offen sc1
    s_add_u32 s46, s46, 4096
    buffer_store_dword v148, v4, s[4:7], s46 offen sc1
    s_add_u32 s46, s33, s47
    buffer_store_dwordx4 v[148:151], v5, s[4:7], s46 offen sc1
    s_add_u32 s46, s46, 4096
    buffer_store_dword v148, v4, s[4:7], s46 offen sc1
    s_add_u32 s46, s33, s47
    s_add_u32 s46, s46, 117440512
    buffer_store_dwordx4 v[148:151], v5, s[4:7], s46 offen sc1
    s_add_u32 s46, s46, 4096
    buffer_store_dword v148, v4, s[4:7], s46 offen sc1
    s_add_u32 s47, s47, 16384
    s_sub_u32 s47, 4718592, s80
    s_add_u32 s48, s47, s77
    s_add_u32 s47, s47, s76
    v_xor_b32 v4, 0, v8
    v_add_u32 v4, v4, v144
    s_add_u32 m0, s78, 40960
    s_add_u32 s46, s47, 0
    buffer_load_dwordx4 v4, s[64:67], s46 offen lds
    s_add_u32 m0, s78, 57344
    s_add_u32 s46, s47, 0
    buffer_load_dwordx4 v4, s[68:71], s46 offen lds
    v_xor_b32 v4, 64, v8
    v_add_u32 v4, v4, v144
    s_add_u32 m0, s78, 41984
    s_add_u32 s46, s47, 32768
    buffer_load_dwordx4 v4, s[64:67], s46 offen lds
    s_add_u32 m0, s78, 58368
    s_add_u32 s46, s47, 32768
    buffer_load_dwordx4 v4, s[68:71], s46 offen lds
    v_xor_b32 v4, 128, v8
    v_add_u32 v4, v4, v144
    s_add_u32 m0, s78, 43008
    s_add_u32 s46, s47, 65536
    buffer_load_dwordx4 v4, s[64:67], s46 offen lds
    s_add_u32 m0, s78, 59392
    s_add_u32 s46, s47, 65536
    buffer_load_dwordx4 v4, s[68:71], s46 offen lds
    v_xor_b32 v4, 192, v8
    v_add_u32 v4, v4, v144
    s_add_u32 m0, s78, 44032
    s_add_u32 s46, s47, 98304
    buffer_load_dwordx4 v4, s[64:67], s46 offen lds
    s_add_u32 m0, s78, 60416
    s_add_u32 s46, s47, 98304
    buffer_load_dwordx4 v4, s[68:71], s46 offen lds
    v_xor_b32 v4, 0, v9
    v_add_u32 v4, v4, v145
    s_add_u32 m0, s79, 73728
    s_add_u32 s46, s48, 0
    buffer_load_dwordx4 v4, s[72:75], s46 offen lds
    v_xor_b32 v4, 64, v9
    v_add_u32 v4, v4, v145
    s_add_u32 m0, s79, 74752
    s_add_u32 s46, s48, 65536
    buffer_load_dwordx4 v4, s[72:75], s46 offen lds
    v_xor_b32 v5, s82, v12
    v_add_u32 v5, 81920, v5
    v_xor_b32 v4, s52, v12
    v_add_u32 v4, 81920, v4
    ds_read_b64_tr_b16 a[8:9], v4 offset:0
    ds_read_b64_tr_b16 a[80:81], v5 offset:16384
    v_xor_b32 v5, s82, v12
    v_xor_b32 v5, 32, v5
    v_add_u32 v5, 81920, v5
    v_xor_b32 v4, s52, v12
    v_xor_b32 v4, 32, v4
    v_add_u32 v4, 81920, v4
    ds_read_b64_tr_b16 v[120:121], v4 offset:0
    ds_read_b64_tr_b16 a[160:161], v5 offset:16384
    v_xor_b32 v4, s53, v13
    v_add_u32 v4, 81920, v4
    ds_read_b64_tr_b16 a[240:241], v4 offset:32768
    v_xor_b32 v5, s82, v12
    v_add_u32 v5, 81920, v5
    v_xor_b32 v4, s52, v12
    v_add_u32 v4, 81920, v4
    ds_read_b64_tr_b16 a[10:11], v4 offset:4096
    ds_read_b64_tr_b16 a[82:83], v5 offset:20480
    v_xor_b32 v5, s82, v12
    v_xor_b32 v5, 32, v5
    v_add_u32 v5, 81920, v5
    v_xor_b32 v4, s52, v12
    v_xor_b32 v4, 32, v4
    v_add_u32 v4, 81920, v4
    ds_read_b64_tr_b16 v[122:123], v4 offset:4096
    ds_read_b64_tr_b16 a[162:163], v5 offset:20480
    v_xor_b32 v4, s53, v13
    v_add_u32 v4, 81920, v4
    ds_read_b64_tr_b16 a[242:243], v4 offset:34816
    v_xor_b32 v5, s82, v12
    v_xor_b32 v5, 128, v5
    v_add_u32 v5, 81920, v5
    v_xor_b32 v4, s52, v12
    v_xor_b32 v4, 128, v4
    v_add_u32 v4, 81920, v4
    ds_read_b64_tr_b16 a[12:13], v4 offset:2048
    ds_read_b64_tr_b16 a[84:85], v5 offset:18432
    v_xor_b32 v5, s82, v12
    v_xor_b32 v5, 160, v5
    v_add_u32 v5, 81920, v5
    v_xor_b32 v4, s52, v12
    v_xor_b32 v4, 160, v4
    v_add_u32 v4, 81920, v4
    ds_read_b64_tr_b16 v[124:125], v4 offset:2048
    ds_read_b64_tr_b16 a[164:165], v5 offset:18432
    v_xor_b32 v4, s53, v13
    v_xor_b32 v4, 64, v4
    v_add_u32 v4, 81920, v4
    ds_read_b64_tr_b16 a[244:245], v4 offset:33792
    v_xor_b32 v5, s82, v12
    v_xor_b32 v5, 128, v5
    v_add_u32 v5, 81920, v5
    v_xor_b32 v4, s52, v12
    v_xor_b32 v4, 128, v4
    v_add_u32 v4, 81920, v4
    ds_read_b64_tr_b16 a[14:15], v4 offset:6144
    ds_read_b64_tr_b16 a[86:87], v5 offset:22528
    v_xor_b32 v5, s82, v12
    v_xor_b32 v5, 160, v5
    v_add_u32 v5, 81920, v5
    v_xor_b32 v4, s52, v12
    v_xor_b32 v4, 160, v4
    v_add_u32 v4, 81920, v4
    ds_read_b64_tr_b16 v[126:127], v4 offset:6144
    ds_read_b64_tr_b16 a[166:167], v5 offset:22528
    v_xor_b32 v4, s53, v13
    v_xor_b32 v4, 64, v4
    v_add_u32 v4, 81920, v4
    ds_read_b64_tr_b16 a[246:247], v4 offset:35840
    s_waitcnt vmcnt(42) lgkmcnt(0)
    s_barrier
    s_xor_b32 s47, s26, 0
    s_mul_i32 s47, s47, 81920
    s_add_u32 s47, s47, s81
    v_xor_b32 v4, 0, v8
    v_add_u32 v4, v4, v146
    s_add_u32 m0, s78, 81920
    s_add_u32 s46, s47, 0
    buffer_load_dwordx4 v4, s[8:11], s46 offen lds
    s_add_u32 m0, s78, 98304
    s_add_u32 s46, s47, 256
    buffer_load_dwordx4 v4, s[8:11], s46 offen lds
    v_xor_b32 v4, 64, v8
    v_add_u32 v4, v4, v146
    s_add_u32 m0, s78, 82944
    s_add_u32 s46, s47, 5120
    buffer_load_dwordx4 v4, s[8:11], s46 offen lds
    s_add_u32 m0, s78, 99328
    s_add_u32 s46, s47, 5376
    buffer_load_dwordx4 v4, s[8:11], s46 offen lds
    v_xor_b32 v4, 128, v8
    v_add_u32 v4, v4, v146
    s_add_u32 m0, s78, 83968
    s_add_u32 s46, s47, 10240
    buffer_load_dwordx4 v4, s[8:11], s46 offen lds
    s_add_u32 m0, s78, 100352
    s_add_u32 s46, s47, 10496
    buffer_load_dwordx4 v4, s[8:11], s46 offen lds
    v_xor_b32 v4, 192, v8
    v_add_u32 v4, v4, v146
    s_add_u32 m0, s78, 84992
    s_add_u32 s46, s47, 15360
    buffer_load_dwordx4 v4, s[8:11], s46 offen lds
    s_add_u32 m0, s78, 101376
    s_add_u32 s46, s47, 15616
    buffer_load_dwordx4 v4, s[8:11], s46 offen lds
    v_xor_b32 v4, 0, v9
    v_add_u32 v4, v4, v147
    s_add_u32 m0, s79, 114688
    s_add_u32 s46, s47, 512
    buffer_load_dwordx4 v4, s[8:11], s46 offen lds
    v_xor_b32 v4, 64, v9
    v_add_u32 v4, v4, v147
    s_add_u32 m0, s79, 115712
    s_add_u32 s46, s47, 10752
    buffer_load_dwordx4 v4, s[8:11], s46 offen lds
    v_xor_b32 v5, s82, v12
    v_add_u32 v5, 122880, v5
    v_xor_b32 v4, s52, v12
    v_add_u32 v4, 122880, v4
    ds_read_b64_tr_b16 a[16:17], v4 offset:0
    ds_read_b64_tr_b16 a[88:89], v5 offset:16384
    v_xor_b32 v5, s82, v12
    v_xor_b32 v5, 32, v5
    v_add_u32 v5, 122880, v5
    v_xor_b32 v4, s52, v12
    v_xor_b32 v4, 32, v4
    v_add_u32 v4, 122880, v4
    ds_read_b64_tr_b16 v[128:129], v4 offset:0
    ds_read_b64_tr_b16 a[168:169], v5 offset:16384
    v_xor_b32 v4, s53, v13
    v_add_u32 v4, 122880, v4
    ds_read_b64_tr_b16 a[248:249], v4 offset:32768
    v_xor_b32 v5, s82, v12
    v_add_u32 v5, 122880, v5
    v_xor_b32 v4, s52, v12
    v_add_u32 v4, 122880, v4
    ds_read_b64_tr_b16 a[18:19], v4 offset:4096
    ds_read_b64_tr_b16 a[90:91], v5 offset:20480
    v_xor_b32 v5, s82, v12
    v_xor_b32 v5, 32, v5
    v_add_u32 v5, 122880, v5
    v_xor_b32 v4, s52, v12
    v_xor_b32 v4, 32, v4
    v_add_u32 v4, 122880, v4
    ds_read_b64_tr_b16 v[130:131], v4 offset:4096
    ds_read_b64_tr_b16 a[170:171], v5 offset:20480
    v_xor_b32 v4, s53, v13
    v_add_u32 v4, 122880, v4
    ds_read_b64_tr_b16 a[250:251], v4 offset:34816
    v_xor_b32 v5, s82, v12
    v_xor_b32 v5, 128, v5
    v_add_u32 v5, 122880, v5
    v_xor_b32 v4, s52, v12
    v_xor_b32 v4, 128, v4
    v_add_u32 v4, 122880, v4
    ds_read_b64_tr_b16 a[20:21], v4 offset:2048
    ds_read_b64_tr_b16 a[92:93], v5 offset:18432
    v_xor_b32 v5, s82, v12
    v_xor_b32 v5, 160, v5
    v_add_u32 v5, 122880, v5
    v_xor_b32 v4, s52, v12
    v_xor_b32 v4, 160, v4
    v_add_u32 v4, 122880, v4
    ds_read_b64_tr_b16 v[132:133], v4 offset:2048
    ds_read_b64_tr_b16 a[172:173], v5 offset:18432
    v_xor_b32 v4, s53, v13
    v_xor_b32 v4, 64, v4
    v_add_u32 v4, 122880, v4
    ds_read_b64_tr_b16 a[252:253], v4 offset:33792
    v_xor_b32 v5, s82, v12
    v_xor_b32 v5, 128, v5
    v_add_u32 v5, 122880, v5
    v_xor_b32 v4, s52, v12
    v_xor_b32 v4, 128, v4
    v_add_u32 v4, 122880, v4
    ds_read_b64_tr_b16 a[22:23], v4 offset:6144
    ds_read_b64_tr_b16 a[94:95], v5 offset:22528
    v_xor_b32 v5, s82, v12
    v_xor_b32 v5, 160, v5
    v_add_u32 v5, 122880, v5
    v_xor_b32 v4, s52, v12
    v_xor_b32 v4, 160, v4
    v_add_u32 v4, 122880, v4
    ds_read_b64_tr_b16 v[134:135], v4 offset:6144
    ds_read_b64_tr_b16 a[174:175], v5 offset:22528
    v_xor_b32 v4, s53, v13
    v_xor_b32 v4, 64, v4
    v_add_u32 v4, 122880, v4
    ds_read_b64_tr_b16 a[254:255], v4 offset:35840
    s_waitcnt vmcnt(42) lgkmcnt(0)
    s_barrier
    s_xor_b32 s47, s26, 1
    s_mul_i32 s47, s47, 81920
    s_add_u32 s47, s47, s81
    v_xor_b32 v4, 0, v8
    v_add_u32 v4, v4, v146
    s_add_u32 m0, s78, 122880
    s_add_u32 s46, s47, 0
    buffer_load_dwordx4 v4, s[8:11], s46 offen lds
    s_add_u32 m0, s78, 139264
    s_add_u32 s46, s47, 256
    buffer_load_dwordx4 v4, s[8:11], s46 offen lds
    v_xor_b32 v4, 64, v8
    v_add_u32 v4, v4, v146
    s_add_u32 m0, s78, 123904
    s_add_u32 s46, s47, 5120
    buffer_load_dwordx4 v4, s[8:11], s46 offen lds
    s_add_u32 m0, s78, 140288
    s_add_u32 s46, s47, 5376
    buffer_load_dwordx4 v4, s[8:11], s46 offen lds
    v_xor_b32 v4, 128, v8
    v_add_u32 v4, v4, v146
    s_add_u32 m0, s78, 124928
    s_add_u32 s46, s47, 10240
    buffer_load_dwordx4 v4, s[8:11], s46 offen lds
    s_add_u32 m0, s78, 141312
    s_add_u32 s46, s47, 10496
    buffer_load_dwordx4 v4, s[8:11], s46 offen lds
    v_xor_b32 v4, 192, v8
    v_add_u32 v4, v4, v146
    s_add_u32 m0, s78, 125952
    s_add_u32 s46, s47, 15360
    buffer_load_dwordx4 v4, s[8:11], s46 offen lds
    s_add_u32 m0, s78, 142336
    s_add_u32 s46, s47, 15616
    buffer_load_dwordx4 v4, s[8:11], s46 offen lds
    v_xor_b32 v4, 0, v9
    v_add_u32 v4, v4, v147
    s_add_u32 m0, s79, 155648
    s_add_u32 s46, s47, 512
    buffer_load_dwordx4 v4, s[8:11], s46 offen lds
    v_xor_b32 v4, 64, v9
    v_add_u32 v4, v4, v147
    s_add_u32 m0, s79, 156672
    s_add_u32 s46, s47, 10752
    buffer_load_dwordx4 v4, s[8:11], s46 offen lds
    v_xor_b32 v5, s82, v12
    v_xor_b32 v4, s52, v12
    ds_read_b64_tr_b16 a[24:25], v4 offset:0
    ds_read_b64_tr_b16 a[96:97], v5 offset:16384
    v_xor_b32 v5, s82, v12
    v_xor_b32 v5, 32, v5
    v_xor_b32 v4, s52, v12
    v_xor_b32 v4, 32, v4
    ds_read_b64_tr_b16 v[136:137], v4 offset:0
    ds_read_b64_tr_b16 a[176:177], v5 offset:16384
    v_xor_b32 v4, s53, v13
    ds_read_b64_tr_b16 v[160:161], v4 offset:32768
    v_xor_b32 v5, s82, v12
    v_xor_b32 v4, s52, v12
    ds_read_b64_tr_b16 a[26:27], v4 offset:4096
    ds_read_b64_tr_b16 a[98:99], v5 offset:20480
    v_xor_b32 v5, s82, v12
    v_xor_b32 v5, 32, v5
    v_xor_b32 v4, s52, v12
    v_xor_b32 v4, 32, v4
    ds_read_b64_tr_b16 v[138:139], v4 offset:4096
    ds_read_b64_tr_b16 a[178:179], v5 offset:20480
    v_xor_b32 v4, s53, v13
    ds_read_b64_tr_b16 v[162:163], v4 offset:34816
    v_xor_b32 v5, s82, v12
    v_xor_b32 v5, 128, v5
    v_xor_b32 v4, s52, v12
    v_xor_b32 v4, 128, v4
    ds_read_b64_tr_b16 a[28:29], v4 offset:2048
    ds_read_b64_tr_b16 a[100:101], v5 offset:18432
    v_xor_b32 v5, s82, v12
    v_xor_b32 v5, 160, v5
    v_xor_b32 v4, s52, v12
    v_xor_b32 v4, 160, v4
    ds_read_b64_tr_b16 v[140:141], v4 offset:2048
    ds_read_b64_tr_b16 a[180:181], v5 offset:18432
    v_xor_b32 v4, s53, v13
    v_xor_b32 v4, 64, v4
    ds_read_b64_tr_b16 v[164:165], v4 offset:33792
    v_xor_b32 v5, s82, v12
    v_xor_b32 v5, 128, v5
    v_xor_b32 v4, s52, v12
    v_xor_b32 v4, 128, v4
    ds_read_b64_tr_b16 a[30:31], v4 offset:6144
    ds_read_b64_tr_b16 a[102:103], v5 offset:22528
    v_xor_b32 v5, s82, v12
    v_xor_b32 v5, 160, v5
    v_xor_b32 v4, s52, v12
    v_xor_b32 v4, 160, v4
    ds_read_b64_tr_b16 v[142:143], v4 offset:6144
    ds_read_b64_tr_b16 a[182:183], v5 offset:22528
    v_xor_b32 v4, s53, v13
    v_xor_b32 v4, 64, v4
    ds_read_b64_tr_b16 v[166:167], v4 offset:35840
    s_waitcnt vmcnt(20) lgkmcnt(0)
    s_barrier
    s_cmp_lg_u32 s28, 0
    s_cbranch_scc1 L_arr_6
    s_mov_b64 s[60:61], exec
    s_mov_b64 exec, 1
    s_getreg_b32 s46, hwreg(HW_REG_XCC_ID, 0, 3)
    s_lshl_b32 s46, s46, 3
    s_lshl_b64 s[48:49], 1, s46
    s_lshl_b32 s46, s26, 3
    v_mov_b32 v5, s46
    v_mov_b32 v6, s48
    v_mov_b32 v7, s49
    global_atomic_add_x2 v5, v[6:7], s[22:23] offset:0 sc1
    s_mov_b64 exec, s[60:61]
L_arr_6:
    v_xor_b32 v5, s82, v14
    v_add_u32 v5, 40960, v5
    v_xor_b32 v4, s52, v14
    v_add_u32 v4, 40960, v4
    ds_read_b64_tr_b16 a[32:33], v4 offset:0
    ds_read_b64_tr_b16 a[104:105], v5 offset:16384
    v_xor_b32 v5, s82, v14
    v_xor_b32 v5, 32, v5
    v_add_u32 v5, 40960, v5
    v_xor_b32 v4, s52, v14
    v_xor_b32 v4, 32, v4
    v_add_u32 v4, 40960, v4
    ds_read_b64_tr_b16 a[40:41], v4 offset:0
    ds_read_b64_tr_b16 a[184:185], v5 offset:16384
    v_xor_b32 v4, s53, v15
    v_add_u32 v4, 40960, v4
    ds_read_b64_tr_b16 v[168:169], v4 offset:32768
    v_xor_b32 v5, s82, v14
    v_xor_b32 v5, 64, v5
    v_add_u32 v5, 40960, v5
    v_xor_b32 v4, s52, v14
    v_xor_b32 v4, 64, v4
    v_add_u32 v4, 40960, v4
    ds_read_b64_tr_b16 a[34:35], v4 offset:512
    ds_read_b64_tr_b16 a[106:107], v5 offset:16896
    v_xor_b32 v5, s82, v14
    v_xor_b32 v5, 96, v5
    v_add_u32 v5, 40960, v5
    v_xor_b32 v4, s52, v14
    v_xor_b32 v4, 96, v4
    v_add_u32 v4, 40960, v4
    ds_read_b64_tr_b16 a[42:43], v4 offset:512
    ds_read_b64_tr_b16 a[186:187], v5 offset:16896
    v_xor_b32 v4, s53, v15
    v_xor_b32 v4, 32, v4
    v_add_u32 v4, 40960, v4
    ds_read_b64_tr_b16 v[170:171], v4 offset:33024
    v_xor_b32 v5, s82, v14
    v_xor_b32 v5, 128, v5
    v_add_u32 v5, 40960, v5
    v_xor_b32 v4, s52, v14
    v_xor_b32 v4, 128, v4
    v_add_u32 v4, 40960, v4
    ds_read_b64_tr_b16 a[36:37], v4 offset:8192
    ds_read_b64_tr_b16 a[108:109], v5 offset:24576
    v_xor_b32 v5, s82, v14
    v_xor_b32 v5, 160, v5
    v_add_u32 v5, 40960, v5
    v_xor_b32 v4, s52, v14
    v_xor_b32 v4, 160, v4
    v_add_u32 v4, 40960, v4
    ds_read_b64_tr_b16 a[44:45], v4 offset:8192
    ds_read_b64_tr_b16 a[188:189], v5 offset:24576
    v_xor_b32 v4, s53, v15
    v_xor_b32 v4, 64, v4
    v_add_u32 v4, 40960, v4
    ds_read_b64_tr_b16 v[172:173], v4 offset:36864
    v_xor_b32 v5, s82, v14
    v_xor_b32 v5, 192, v5
    v_add_u32 v5, 40960, v5
    v_xor_b32 v4, s52, v14
    v_xor_b32 v4, 192, v4
    v_add_u32 v4, 40960, v4
    ds_read_b64_tr_b16 a[38:39], v4 offset:8704
    ds_read_b64_tr_b16 a[110:111], v5 offset:25088
    v_xor_b32 v5, s82, v14
    v_xor_b32 v5, 224, v5
    v_add_u32 v5, 40960, v5
    v_xor_b32 v4, s52, v14
    v_xor_b32 v4, 224, v4
    v_add_u32 v4, 40960, v4
    ds_read_b64_tr_b16 a[46:47], v4 offset:8704
    ds_read_b64_tr_b16 a[190:191], v5 offset:25088
    v_xor_b32 v4, s53, v15
    v_xor_b32 v4, 96, v4
    v_add_u32 v4, 40960, v4
    ds_read_b64_tr_b16 v[174:175], v4 offset:37120
    s_waitcnt vmcnt(10) lgkmcnt(0)
    s_barrier
    v_xor_b32 v4, s62, v14
    v_add_u32 v4, s63, v4
    v_add_u32 v4, 81920, v4
    ds_read_b64_tr_b16 v[176:177], v4 offset:0
    v_xor_b32 v4, s62, v14
    v_xor_b32 v4, 32, v4
    v_add_u32 v4, s63, v4
    v_add_u32 v4, 81920, v4
    ds_read_b64_tr_b16 v[192:193], v4 offset:0
    v_xor_b32 v4, s62, v14
    v_xor_b32 v4, 64, v4
    v_add_u32 v4, s63, v4
    v_add_u32 v4, 81920, v4
    ds_read_b64_tr_b16 v[208:209], v4 offset:0
    v_xor_b32 v4, s62, v14
    v_xor_b32 v4, 96, v4
    v_add_u32 v4, s63, v4
    v_add_u32 v4, 81920, v4
    ds_read_b64_tr_b16 v[224:225], v4 offset:0
    v_xor_b32 v4, s53, v15
    v_add_u32 v4, 81920, v4
    ds_read_b64_tr_b16 v[240:241], v4 offset:32768
    v_xor_b32 v4, s62, v14
    v_xor_b32 v4, 64, v4
    v_add_u32 v4, s63, v4
    v_add_u32 v4, 81920, v4
    ds_read_b64_tr_b16 v[178:179], v4 offset:512
    v_xor_b32 v4, s62, v14
    v_xor_b32 v4, 96, v4
    v_add_u32 v4, s63, v4
    v_add_u32 v4, 81920, v4
    ds_read_b64_tr_b16 v[194:195], v4 offset:512
    v_xor_b32 v4, s62, v14
    v_add_u32 v4, s63, v4
    v_add_u32 v4, 81920, v4
    ds_read_b64_tr_b16 v[210:211], v4 offset:512
    v_xor_b32 v4, s62, v14
    v_xor_b32 v4, 32, v4
    v_add_u32 v4, s63, v4
    v_add_u32 v4, 81920, v4
    ds_read_b64_tr_b16 v[226:227], v4 offset:512
    v_xor_b32 v4, s53, v15
    v_xor_b32 v4, 32, v4
    v_add_u32 v4, 81920, v4
    ds_read_b64_tr_b16 v[242:243], v4 offset:33024
    v_xor_b32 v4, s62, v14
    v_xor_b32 v4, 128, v4
    v_add_u32 v4, s63, v4
    v_add_u32 v4, 81920, v4
    ds_read_b64_tr_b16 v[180:181], v4 offset:8192
    v_xor_b32 v4, s62, v14
    v_xor_b32 v4, 160, v4
    v_add_u32 v4, s63, v4
    v_add_u32 v4, 81920, v4
    ds_read_b64_tr_b16 v[196:197], v4 offset:8192
    v_xor_b32 v4, s62, v14
    v_xor_b32 v4, 192, v4
    v_add_u32 v4, s63, v4
    v_add_u32 v4, 81920, v4
    ds_read_b64_tr_b16 v[212:213], v4 offset:8192
    v_xor_b32 v4, s62, v14
    v_xor_b32 v4, 224, v4
    v_add_u32 v4, s63, v4
    v_add_u32 v4, 81920, v4
    ds_read_b64_tr_b16 v[228:229], v4 offset:8192
    v_xor_b32 v4, s53, v15
    v_xor_b32 v4, 64, v4
    v_add_u32 v4, 81920, v4
    ds_read_b64_tr_b16 v[244:245], v4 offset:36864
    v_xor_b32 v4, s62, v14
    v_xor_b32 v4, 192, v4
    v_add_u32 v4, s63, v4
    v_add_u32 v4, 81920, v4
    ds_read_b64_tr_b16 v[182:183], v4 offset:8704
    v_xor_b32 v4, s62, v14
    v_xor_b32 v4, 224, v4
    v_add_u32 v4, s63, v4
    v_add_u32 v4, 81920, v4
    ds_read_b64_tr_b16 v[198:199], v4 offset:8704
    v_xor_b32 v4, s62, v14
    v_xor_b32 v4, 128, v4
    v_add_u32 v4, s63, v4
    v_add_u32 v4, 81920, v4
    ds_read_b64_tr_b16 v[214:215], v4 offset:8704
    v_xor_b32 v4, s62, v14
    v_xor_b32 v4, 160, v4
    v_add_u32 v4, s63, v4
    v_add_u32 v4, 81920, v4
    ds_read_b64_tr_b16 v[230:231], v4 offset:8704
    v_xor_b32 v4, s53, v15
    v_xor_b32 v4, 96, v4
    v_add_u32 v4, 81920, v4
    ds_read_b64_tr_b16 v[246:247], v4 offset:37120
    s_waitcnt vmcnt(0) lgkmcnt(0)
    s_barrier
    v_xor_b32 v4, s62, v14
    v_add_u32 v4, s63, v4
    v_add_u32 v4, 122880, v4
    ds_read_b64_tr_b16 v[184:185], v4 offset:0
    v_xor_b32 v4, s62, v14
    v_xor_b32 v4, 32, v4
    v_add_u32 v4, s63, v4
    v_add_u32 v4, 122880, v4
    ds_read_b64_tr_b16 v[200:201], v4 offset:0
    v_xor_b32 v4, s62, v14
    v_xor_b32 v4, 64, v4
    v_add_u32 v4, s63, v4
    v_add_u32 v4, 122880, v4
    ds_read_b64_tr_b16 v[216:217], v4 offset:0
    v_xor_b32 v4, s62, v14
    v_xor_b32 v4, 96, v4
    v_add_u32 v4, s63, v4
    v_add_u32 v4, 122880, v4
    ds_read_b64_tr_b16 v[232:233], v4 offset:0
    v_xor_b32 v4, s53, v15
    v_add_u32 v4, 122880, v4
    ds_read_b64_tr_b16 v[248:249], v4 offset:32768
    v_xor_b32 v4, s62, v14
    v_xor_b32 v4, 64, v4
    v_add_u32 v4, s63, v4
    v_add_u32 v4, 122880, v4
    ds_read_b64_tr_b16 v[186:187], v4 offset:512
    v_xor_b32 v4, s62, v14
    v_xor_b32 v4, 96, v4
    v_add_u32 v4, s63, v4
    v_add_u32 v4, 122880, v4
    ds_read_b64_tr_b16 v[202:203], v4 offset:512
    v_xor_b32 v4, s62, v14
    v_add_u32 v4, s63, v4
    v_add_u32 v4, 122880, v4
    ds_read_b64_tr_b16 v[218:219], v4 offset:512
    v_xor_b32 v4, s62, v14
    v_xor_b32 v4, 32, v4
    v_add_u32 v4, s63, v4
    v_add_u32 v4, 122880, v4
    ds_read_b64_tr_b16 v[234:235], v4 offset:512
    v_xor_b32 v4, s53, v15
    v_xor_b32 v4, 32, v4
    v_add_u32 v4, 122880, v4
    ds_read_b64_tr_b16 v[250:251], v4 offset:33024
    v_xor_b32 v4, s62, v14
    v_xor_b32 v4, 128, v4
    v_add_u32 v4, s63, v4
    v_add_u32 v4, 122880, v4
    ds_read_b64_tr_b16 v[188:189], v4 offset:8192
    v_xor_b32 v4, s62, v14
    v_xor_b32 v4, 160, v4
    v_add_u32 v4, s63, v4
    v_add_u32 v4, 122880, v4
    ds_read_b64_tr_b16 v[204:205], v4 offset:8192
    v_xor_b32 v4, s62, v14
    v_xor_b32 v4, 192, v4
    v_add_u32 v4, s63, v4
    v_add_u32 v4, 122880, v4
    ds_read_b64_tr_b16 v[220:221], v4 offset:8192
    v_xor_b32 v4, s62, v14
    v_xor_b32 v4, 224, v4
    v_add_u32 v4, s63, v4
    v_add_u32 v4, 122880, v4
    ds_read_b64_tr_b16 v[236:237], v4 offset:8192
    v_xor_b32 v4, s53, v15
    v_xor_b32 v4, 64, v4
    v_add_u32 v4, 122880, v4
    ds_read_b64_tr_b16 v[252:253], v4 offset:36864
    v_xor_b32 v4, s62, v14
    v_xor_b32 v4, 192, v4
    v_add_u32 v4, s63, v4
    v_add_u32 v4, 122880, v4
    ds_read_b64_tr_b16 v[190:191], v4 offset:8704
    v_xor_b32 v4, s62, v14
    v_xor_b32 v4, 224, v4
    v_add_u32 v4, s63, v4
    v_add_u32 v4, 122880, v4
    ds_read_b64_tr_b16 v[206:207], v4 offset:8704
    v_xor_b32 v4, s62, v14
    v_xor_b32 v4, 128, v4
    v_add_u32 v4, s63, v4
    v_add_u32 v4, 122880, v4
    ds_read_b64_tr_b16 v[222:223], v4 offset:8704
    v_xor_b32 v4, s62, v14
    v_xor_b32 v4, 160, v4
    v_add_u32 v4, s63, v4
    v_add_u32 v4, 122880, v4
    ds_read_b64_tr_b16 v[238:239], v4 offset:8704
    v_xor_b32 v4, s53, v15
    v_xor_b32 v4, 96, v4
    v_add_u32 v4, 122880, v4
    ds_read_b64_tr_b16 v[254:255], v4 offset:37120
    s_waitcnt lgkmcnt(0)
    s_barrier
    s_lshl_b32 s46, s28, 15
    s_add_u32 s46, s46, 32768
    v_lshlrev_b32 v4, 4, v1
    v_add_u32 v4, s46, v4
    ds_write_b128 v4, v[16:19] offset:0
    ds_write_b128 v4, v[20:23] offset:1024
    ds_write_b128 v4, v[24:27] offset:2048
    ds_write_b128 v4, v[28:31] offset:3072
    ds_write_b128 v4, v[32:35] offset:4096
    ds_write_b128 v4, v[36:39] offset:5120
    ds_write_b128 v4, v[40:43] offset:6144
    ds_write_b128 v4, v[44:47] offset:7168
    ds_write_b128 v4, v[48:51] offset:8192
    ds_write_b128 v4, v[52:55] offset:9216
    ds_write_b128 v4, v[56:59] offset:10240
    ds_write_b128 v4, v[60:63] offset:11264
    ds_write_b128 v4, v[64:67] offset:12288
    ds_write_b128 v4, v[68:71] offset:13312
    ds_write_b128 v4, v[72:75] offset:14336
    ds_write_b128 v4, v[76:79] offset:15360
    ds_write_b128 v4, v[80:83] offset:16384
    ds_write_b128 v4, v[84:87] offset:17408
    ds_write_b128 v4, v[88:91] offset:18432
    ds_write_b128 v4, v[92:95] offset:19456
    ds_write_b128 v4, v[96:99] offset:20480
    ds_write_b128 v4, v[100:103] offset:21504
    ds_write_b128 v4, v[104:107] offset:22528
    ds_write_b128 v4, v[108:111] offset:23552
    ds_write_b128 v4, v[112:115] offset:24576
    ds_write_b128 v4, v[116:119] offset:25600
    ds_write_b128 v4, v[120:123] offset:26624
    ds_write_b128 v4, v[124:127] offset:27648
    ds_write_b128 v4, v[128:131] offset:28672
    ds_write_b128 v4, v[132:135] offset:29696
    ds_write_b128 v4, v[136:139] offset:30720
    ds_write_b128 v4, v[140:143] offset:31744
    s_waitcnt lgkmcnt(0)
    v_and_b32 v44, 15, v0
    v_bfe_u32 v45, v0, 4, 2
    v_and_b32 v50, 63, v0
    v_lshrrev_b32 v48, 2, v44
    v_and_b32 v49, 1, v44
    v_lshl_add_u32 v46, v48, 1, v49
    v_bfe_u32 v47, v44, 1, 1
    v_lshl_add_u32 v51, v45, 1, v47
    v_mul_u32_u24 v1, 0xaaaa, v47
    v_add_u32 v1, 0x4444, v1
    v_mov_b32 v2, 0x3f803f80
    v_mov_b32 v3, 0x3f803f80
    v_mov_b32 v4, 0x3f803f80
    v_mov_b32 v5, 0x3f803f80
    v_lshlrev_b32 v48, 4, v49
    v_mov_b32 v49, 0x3f80
    v_lshlrev_b32 v48, v48, v49
    v_bfe_u32 v49, v44, 1, 2
    v_cmp_eq_u32 vcc, 0, v49
    s_nop 1
    v_cndmask_b32 v6, 0, v48, vcc
    v_cmp_eq_u32 vcc, 1, v49
    s_nop 1
    v_cndmask_b32 v7, 0, v48, vcc
    v_cmp_eq_u32 vcc, 2, v49
    s_nop 1
    v_cndmask_b32 v8, 0, v48, vcc
    v_cmp_eq_u32 vcc, 3, v49
    s_nop 1
    v_cndmask_b32 v9, 0, v48, vcc
    v_mov_b32 v11, 0
    v_mov_b32 v13, 0
    v_mov_b32 v15, 0
    v_lshlrev_b32 v16, 4, v50
    s_lshl_b32 s46, s28, 15
    s_add_u32 s46, s46, 32768
    v_add_u32 v17, s46, v16
    v_lshlrev_b32 v20, 4, v0
    v_lshlrev_b32 v21, 2, v0
    v_lshlrev_b32 v48, 7, v51
    v_lshl_add_u32 v48, v46, 4, v48
    s_mov_b32 s44, 0
    s_cmp_ge_u32 s28, 2
    s_cbranch_scc1 L_roleB_7
    s_lshl_b32 s46, s28, 5
    s_add_u32 s46, s46, s27
    s_cmp_lt_u32 s46, 40
    s_cselect_b32 s44, 1, 0
    s_cselect_b32 s46, s46, 0
    s_lshl_b32 s47, s46, 12
    v_add_u32 v18, s47, v48
    s_lshl_b32 s47, s46, 7
    v_and_b32 v48, 1, v44
    v_lshl_add_u32 v48, v45, 1, v48
    v_lshlrev_b32 v48, 4, v48
    v_bfe_u32 v49, v44, 1, 2
    v_lshl_add_u32 v48, v49, 2, v48
    v_add_u32 v19, s47, v48
    s_lshl_b32 s46, s28, 12
    v_add_u32 v31, s46, v16
    v_mov_b32 v32, 0
    s_branch L_roleE_8
L_roleB_7:
    s_and_b32 s48, s28, 1
    s_lshl_b32 s46, s48, 11
    v_add_u32 v18, s46, v48
    v_add_u32 v31, s46, v16
    s_lshl_b32 s46, s48, 9
    s_add_u32 s46, s46, 4096
    v_lshlrev_b32 v48, 3, v50
    v_add_u32 v32, s46, v48
    v_lshrrev_b32 v48, 5, v50
    v_lshlrev_b32 v19, 8, v48
    v_bfe_u32 v48, v50, 2, 1
    v_lshl_add_u32 v19, v48, 7, v19
    v_bfe_u32 v48, v50, 3, 2
    v_lshl_add_u32 v19, v48, 5, v19
    v_and_b32 v48, 3, v50
    v_lshl_add_u32 v19, v48, 3, v19
    v_add_u32 v19, s46, v19
L_roleE_8:
    s_lshl_b32 s46, s28, 8
    v_lshlrev_b32 v48, 2, v45
    v_lshl_add_u32 v48, v44, 4, v48
    v_add_u32 v33, s46, v48
    s_lshl_b32 s46, s28, 9
    v_add_u32 v48, s46, v48
    v_add_u32 v23, 18432, v48
    v_lshlrev_b32 v48, 1, v48
    v_add_u32 v24, 20480, v48
    v_lshrrev_b32 v48, 1, v45
    v_lshlrev_b32 v48, 4, v48
    v_and_b32 v49, 1, v45
    v_lshl_add_u32 v48, v49, 2, v48
    v_lshrrev_b32 v49, 2, v44
    v_add_u32 v48, v48, v49
    v_and_b32 v49, 1, v44
    v_lshlrev_b32 v49, 3, v49
    v_lshl_add_u32 v25, v48, 4, v49
    v_add_u32 v25, 18432, v25
    v_and_b32 v49, 3, v44
    v_lshlrev_b32 v49, 3, v49
    v_lshl_add_u32 v26, v48, 5, v49
    s_lshl_b32 s46, s26, 9
    v_xor_b32 v26, s46, v26
    v_add_u32 v26, 20480, v26
    v_and_b32 v48, 7, v44
    v_mul_u32_u24 v48, 272, v48
    v_lshl_add_u32 v48, v45, 3, v48
    s_lshl_b32 s46, s28, 5
    s_add_u32 s46, s46, 24576
    v_add_u32 v27, s46, v48
    v_mul_u32_u24 v48, 272, v46
    v_lshl_add_u32 v48, v51, 4, v48
    v_add_u32 v28, 24576, v48
    s_lshl_b32 s46, s28, 15
    s_lshl_b32 s47, s27, 7
    s_add_u32 s46, s46, s47
    v_and_b32 v49, 1, v44
    v_lshl_add_u32 v49, v45, 1, v49
    v_lshlrev_b32 v49, 4, v49
    v_lshrrev_b32 v48, 1, v44
    v_lshl_add_u32 v29, v48, 12, v49
    v_add_u32 v29, s46, v29
    s_lshl_b32 s46, s28, 13
    s_add_u32 s46, s46, s47
    s_add_u32 s46, s46, 131072
    v_and_b32 v48, 3, v48
    v_lshl_add_u32 v30, v48, 2, v49
    v_lshrrev_b32 v48, 3, v44
    v_lshl_add_u32 v30, v48, 12, v30
    v_add_u32 v30, s46, v30
    s_mov_b32 s8, s12
    s_and_b32 s9, s13, 0xffff
    s_mov_b32 s10, 10240
    s_mov_b32 s11, 0x20000
    v_mul_u32_u24 v48, 1280, v46
    v_lshl_add_u32 v49, v51, 2, v48
    v_lshl_add_u32 v48, v51, 4, v48
    s_mul_i32 s46, s26, 640
    s_sub_u32 s47, 640, s46
    s_lshl_b32 s48, s28, 7
    s_add_u32 s49, s46, s48
    buffer_load_dword v52, v49, s[8:11], s49 offen offset:0
    buffer_load_dword v53, v49, s[8:11], s49 offen offset:32
    buffer_load_dword v54, v49, s[8:11], s49 offen offset:64
    buffer_load_dword v55, v49, s[8:11], s49 offen offset:96
    buffer_load_dwordx4 v[56:59], v48, s[8:11], s46 offen offset:512
    s_add_u32 s49, s47, s48
    buffer_load_dword v60, v49, s[8:11], s49 offen offset:0
    buffer_load_dword v61, v49, s[8:11], s49 offen offset:32
    buffer_load_dword v62, v49, s[8:11], s49 offen offset:64
    buffer_load_dword v63, v49, s[8:11], s49 offen offset:96
    buffer_load_dwordx4 v[64:67], v48, s[8:11], s47 offen offset:512
    s_waitcnt vmcnt(0)
    ds_write_b128 v20, v[52:55] offset:0
    ds_write_b128 v16, v[56:59] offset:4096
    ds_write_b128 v20, v[60:63] offset:5120
    ds_write_b128 v16, v[64:67] offset:9216
    s_lshl_b32 s46, s27, 13
    s_add_u32 s35, s46, 37748736
    s_add_u32 s67, s35, 4096
    s_lshl_b32 s72, s28, 10
    s_lshl_b32 s47, s26, 12
    s_add_u32 s46, s46, s47
    s_add_u32 s37, s46, 54525952
    s_xor_b32 s38, s37, 4096
    s_lshl_b32 s46, s27, 11
    s_lshl_b32 s47, s26, 8
    s_add_u32 s39, s46, s47
    s_add_u32 s39, s39, 12564480
    s_lshl_b32 s47, s26, 10
    s_add_u32 s46, s46, s47
    s_add_u32 s40, s46, 16777216
    s_mov_b32 s29, 0
    s_mov_b32 s30, 0
    s_mov_b32 s36, 0
    s_mov_b32 s64, s42
    s_mov_b32 s65, s43
    s_add_u32 s68, s4, 117440512
    s_addc_u32 s69, s5, 0
    s_mov_b32 s70, 150994944
    s_mov_b32 s71, 0x20000
    s_cmp_ge_u32 s28, 2
    s_cselect_b64 s[60:61], -1, 0
    s_mov_b32 s50, 0x3e0293ee
    s_lshl_b32 s76, s27, 1
    s_add_u32 s76, s76, s26
    s_lshl_b32 s76, s76, 3
    s_add_u32 s76, s76, 10240
    s_cmp_eq_u32 s28, 0
    s_cselect_b64 s[74:75], 1, 0
    s_mov_b32 s73, 0
    s_add_u32 s46, s29, 0
    s_cmp_le_u32 s73, s46
    s_cbranch_scc1 L_kvw_309
L_kvok_10:
    s_branch L_kv0_9
L_kvw_309:
    v_bfe_u32 v86, v16, 4, 1
    v_lshlrev_b32 v86, 3, v86
    v_bfe_u32 v87, v16, 5, 1
    v_lshl_add_u32 v86, v87, 9, v86
    s_lshl_b32 s47, s27, 4
    s_add_u32 s47, s47, 8704
L_kvp_310:
    buffer_load_dwordx2 v[84:85], v86, s[4:7], s47 offen sc1
    s_waitcnt vmcnt(0)
    v_subrev_u32 v84, s96, v84
    v_xor_b32 v85, s97, v85
    v_lshrrev_b32 v87, 8, v84
    v_or_b32 v85, v85, v87
    v_cmp_eq_u32 vcc, 0, v85
    s_nop 1
    v_cndmask_b32 v84, 0, v84, vcc
    v_cmp_ge_u32 vcc, s46, v84
    s_cbranch_vccz L_ok_311
    s_sub_u32 s31, s31, 1
    s_cbranch_scc0 L_kvp_310
    s_mov_b32 s31, 0
L_ok_311:
    v_readlane_b32 s73, v84, 0
    v_readlane_b32 s47, v84, 1
    s_nop 0
    s_min_u32 s73, s73, s47
    v_readlane_b32 s47, v84, 2
    s_nop 0
    s_min_u32 s73, s73, s47
    v_readlane_b32 s47, v84, 3
    s_nop 0
    s_min_u32 s73, s73, s47
    s_branch L_kvok_10
L_kv0_9:
    s_waitcnt lgkmcnt(0)
    s_add_u32 m0, s72, 10240
    s_nop 0
    buffer_load_dwordx4 v20, s[4:7], s35 offen sc1 lds
    s_add_u32 m0, s72, 14336
    s_nop 0
    buffer_load_dwordx4 v20, s[4:7], s67 offen sc1 lds
    buffer_load_dwordx4 v[36:39], v20, s[4:7], s37 offen sc1
    buffer_load_dwordx4 v[40:43], v20, s[4:7], s38 offen sc1
    s_add_u32 s35, s35, 262144
    s_add_u32 s67, s67, 262144
    s_add_u32 s37, s37, 262144
    s_add_u32 s38, s38, 262144
    s_barrier
    ds_read_b128 v[74:77], v31 offset:5120
    ds_read_b128 v[78:81], v31 offset:6144
    ds_read_b64 v[82:83], v32 offset:5120
    s_waitcnt vmcnt(0)
    v_mov_b32 v132, 0
    v_mov_b32 v133, 0
    v_mov_b32 v134, 0
    v_mov_b32 v135, 0
    v_mov_b32 v136, 0
    v_mov_b32 v137, 0
    v_mov_b32 v138, 0
    v_mov_b32 v139, 0
    v_mov_b32 v140, 0
    v_mov_b32 v141, 0
    v_mov_b32 v142, 0
    v_mov_b32 v143, 0
    v_mov_b32 v144, 0
    v_mov_b32 v145, 0
    v_mov_b32 v146, 0
    v_mov_b32 v147, 0
    v_mov_b32 v148, 0
    v_mov_b32 v149, 0
    v_mov_b32 v150, 0
    v_mov_b32 v151, 0
    ds_read_b128 v[84:87], v17 offset:0
    ds_read_b128 v[88:91], v17 offset:1024
    ds_read_b128 v[92:95], v17 offset:2048
    ds_read_b128 v[96:99], v17 offset:3072
    ds_read_b128 v[100:103], v17 offset:4096
    ds_read_b128 v[104:107], v17 offset:5120
    ds_read_b128 v[108:111], v17 offset:6144
    ds_read_b128 v[112:115], v17 offset:7168
    ds_read_b128 v[116:119], v17 offset:8192
    ds_read_b128 v[120:123], v17 offset:9216
    ds_read_b128 v[124:127], v17 offset:10240
    ds_read_b128 v[128:131], v17 offset:11264
    v_mov_b32 v34, 0
L_allinp_11:
    global_load_dwordx4 v[44:47], v34, s[22:23] offset:0 sc1
    s_waitcnt vmcnt(0)
    v_sad_u8 v0, v44, 0, 0
    v_sad_u8 v0, v45, 0, v0
    v_sad_u8 v0, v46, 0, v0
    v_sad_u8 v0, v47, 0, v0
    v_cmp_gt_u32 vcc, 64, v0
    s_cbranch_vccz L_ok_12
    s_sub_u32 s31, s31, 1
    s_cbranch_scc0 L_allinp_11
    s_mov_b32 s31, 0
L_ok_12:
    v_and_b32 v44, 0x20202020, v44
    v_and_b32 v45, 0x20202020, v45
    v_and_b32 v46, 0x20202020, v46
    v_and_b32 v47, 0x20202020, v47
    v_or_b32 v44, v44, v45
    v_or_b32 v46, v46, v47
    v_min_u32 v44, v44, v46
    s_nop 0
    v_readfirstlane_b32 s52, v44
    s_nop 0
    s_cmp_eq_u32 s52, 0
    s_cbranch_scc1 L_spread_13
    s_branch L_entry_16
L_step_15:
    s_nop 15
    s_nop 15
    s_nop 15
    s_nop 7
    buffer_load_dwordx4 v[64:67], v18, s[4:7], s32 offen offset:0 sc1
    buffer_load_dwordx4 v[68:71], v18, s[4:7], s32 offen offset:1024 sc1
    buffer_load_dwordx2 v[72:73], v19, s[4:7], s32 offen sc1
    s_nop 15
    s_nop 7
    buffer_load_dwordx4 v[74:77], v18, s[4:7], s32 offen offset:0 sc1
    buffer_load_dwordx4 v[78:81], v18, s[4:7], s32 offen offset:1024 sc1
    buffer_load_dwordx2 v[82:83], v19, s[4:7], s32 offen sc1
    s_waitcnt vmcnt(5)
    ds_write_b128 v31, v[64:67] offset:0
    s_waitcnt vmcnt(4)
    ds_write_b128 v31, v[68:71] offset:1024
    s_waitcnt vmcnt(3)
    ds_write_b64 v32, v[72:73] offset:0
    v_max3_u32 v0, v64, v65, v66
    v_max3_u32 v0, v0, v67, v68
    v_max3_u32 v0, v0, v69, v70
    v_max3_u32 v0, v0, v71, v72
    v_max_u32 v0, v0, v73
    v_cmp_eq_u32 vcc, -1, v0
    s_cbranch_vccnz L_h2l_518
L_lok_18:
    buffer_load_dwordx4 v[74:77], v18, s[4:7], s34 offen offset:0 sc1
    buffer_load_dwordx4 v[78:81], v18, s[4:7], s34 offen offset:1024 sc1
    buffer_load_dwordx2 v[82:83], v19, s[4:7], s34 offen sc1
L_entry_16:
    s_waitcnt lgkmcnt(0)
    s_barrier
    ds_read_b128 v[44:47], v16 offset:0
    ds_read_b128 v[48:51], v16 offset:1024
    ds_read_b128 v[52:55], v16 offset:2048
    ds_read_b128 v[56:59], v16 offset:3072
    ds_read_b128 v[60:63], v16 offset:4096
    s_waitcnt lgkmcnt(4)
    v_smfmac_f32_16x16x64_bf16 v[132:135], v[44:47], v[84:91], v1
    v_smfmac_f32_16x16x64_bf16 v[136:139], v[44:47], v[92:99], v1
    ds_read_b128 v[84:87], v17 offset:12288
    v_smfmac_f32_16x16x64_bf16 v[148:151], v[44:47], a[192:199], v1
    ds_read_b128 v[88:91], v17 offset:13312
    s_waitcnt lgkmcnt(5)
    v_smfmac_f32_16x16x64_bf16 v[132:135], v[48:51], v[100:107], v1
    ds_read_b128 v[92:95], v17 offset:14336
    v_smfmac_f32_16x16x64_bf16 v[136:139], v[48:51], v[108:115], v1
    ds_read_b128 v[96:99], v17 offset:15360
    v_smfmac_f32_16x16x64_bf16 v[148:151], v[48:51], a[200:207], v1
    ds_read_b128 v[100:103], v17 offset:16384
    s_waitcnt lgkmcnt(7)
    v_smfmac_f32_16x16x64_bf16 v[132:135], v[52:55], v[116:123], v1
    ds_read_b128 v[104:107], v17 offset:17408
    v_smfmac_f32_16x16x64_bf16 v[136:139], v[52:55], v[124:131], v1
    ds_read_b128 v[108:111], v17 offset:18432
    v_smfmac_f32_16x16x64_bf16 v[148:151], v[52:55], a[208:215], v1
    ds_read_b128 v[112:115], v17 offset:19456
    s_waitcnt lgkmcnt(9)
    s_waitcnt lgkmcnt(6)
    v_smfmac_f32_16x16x64_bf16 v[132:135], v[56:59], v[84:91], v1
    ds_read_b128 v[116:119], v17 offset:20480
    s_waitcnt lgkmcnt(5)
    v_smfmac_f32_16x16x64_bf16 v[136:139], v[56:59], v[92:99], v1
    ds_read_b128 v[120:123], v17 offset:21504
    v_smfmac_f32_16x16x64_bf16 v[148:151], v[56:59], a[216:223], v1
    ds_read_b128 v[124:127], v17 offset:22528
    s_waitcnt lgkmcnt(5)
    v_smfmac_f32_16x16x64_bf16 v[132:135], v[60:63], v[100:107], v1
    ds_read_b128 v[128:131], v17 offset:23552
    s_waitcnt lgkmcnt(4)
    v_smfmac_f32_16x16x64_bf16 v[136:139], v[60:63], v[108:115], v1
    v_smfmac_f32_16x16x64_bf16 v[148:151], v[60:63], a[224:231], v1
    s_waitcnt lgkmcnt(0)
    v_smfmac_f32_16x16x64_bf16 v[140:143], v[44:47], v[116:123], v1
    s_cmp_ge_u32 s28, 2
    s_cbranch_scc1 L_stB_19
    v_smfmac_f32_16x16x64_bf16 v[140:143], v[48:51], a[48:55], v1
    v_smfmac_f32_16x16x64_bf16 v[140:143], v[52:55], v[124:131], v1
    v_smfmac_f32_16x16x64_bf16 v[140:143], v[56:59], a[56:63], v1
    v_smfmac_f32_16x16x64_bf16 v[140:143], v[60:63], a[64:71], v1
    v_smfmac_f32_16x16x64_bf16 v[144:147], v[44:47], a[112:119], v1
    s_branch L_join_20
L_stB_19:
    s_waitcnt vmcnt(0)
    v_smfmac_f32_16x16x64_bf16 v[140:143], v[48:51], a[48:55], v1
    ds_write_b128 v31, v[74:77] offset:5120
    v_max3_u32 v0, v74, v75, v76
    v_smfmac_f32_16x16x64_bf16 v[140:143], v[52:55], v[124:131], v1
    ds_write_b128 v31, v[78:81] offset:6144
    v_max3_u32 v0, v0, v77, v78
    v_smfmac_f32_16x16x64_bf16 v[140:143], v[56:59], a[56:63], v1
    ds_write_b64 v32, v[82:83] offset:5120
    v_max3_u32 v0, v0, v79, v80
    v_smfmac_f32_16x16x64_bf16 v[140:143], v[60:63], a[64:71], v1
    v_max3_u32 v0, v0, v81, v82
    v_smfmac_f32_16x16x64_bf16 v[144:147], v[44:47], a[112:119], v1
    v_max_u32 v0, v0, v83
    v_cmp_eq_u32 vcc, -1, v0
    s_cbranch_vccnz L_h2r_521
L_join_20:
    s_waitcnt lgkmcnt(0)
    s_barrier
    ds_read_b128 v[64:67], v16 offset:5120
    v_smfmac_f32_16x16x64_bf16 v[144:147], v[48:51], a[120:127], v1
    ds_read_b128 v[68:71], v16 offset:6144
    v_smfmac_f32_16x16x64_bf16 v[144:147], v[52:55], a[128:135], v1
    ds_read_b128 v[72:75], v16 offset:7168
    v_smfmac_f32_16x16x64_bf16 v[144:147], v[56:59], a[136:143], v1
    ds_read_b128 v[76:79], v16 offset:8192
    v_smfmac_f32_16x16x64_bf16 v[144:147], v[60:63], a[144:151], v1
    ds_read_b128 v[80:83], v16 offset:9216
    s_waitcnt lgkmcnt(4)
    v_smfmac_f32_16x16x64_bf16 v[148:151], v[64:67], a[232:239], v1
    s_waitcnt lgkmcnt(3)
    v_smfmac_f32_16x16x64_bf16 v[148:151], v[68:71], a[240:247], v1
    ds_read_b128 v[84:87], v17 offset:24576
    s_waitcnt lgkmcnt(3)
    v_smfmac_f32_16x16x64_bf16 v[148:151], v[72:75], a[248:255], v1
    ds_read_b128 v[88:91], v17 offset:25600
    s_waitcnt lgkmcnt(3)
    v_smfmac_f32_16x16x64_bf16 v[148:151], v[76:79], v[160:167], v1
    ds_read_b128 v[92:95], v17 offset:26624
    s_waitcnt lgkmcnt(3)
    v_smfmac_f32_16x16x64_bf16 v[148:151], v[80:83], v[168:175], v1
    ds_read_b128 v[96:99], v17 offset:27648
    v_smfmac_f32_16x16x64_bf16 v[132:135], v[64:67], a[0:7], v1
    ds_read_b128 v[100:103], v17 offset:28672
    s_nop 1
    v_smfmac_f32_16x16x64_bf16 v[132:135], v[68:71], a[8:15], v1
    ds_read_b128 v[104:107], v17 offset:29696
    s_nop 0
    v_add_f32 v148, v148, v150
    v_add_f32 v149, v149, v151
    v_smfmac_f32_16x16x64_bf16 v[132:135], v[72:75], a[16:23], v1
    ds_read_b128 v[108:111], v17 offset:30720
    v_cvt_pk_bf16_f32 v12, v148, v149
    v_and_or_b32 v0, v12, -2, s36
    v_smfmac_f32_16x16x64_bf16 v[132:135], v[76:79], a[24:31], v1
    buffer_store_dword v0, v21, s[4:7], s42 offen sc1
    v_smfmac_f32_16x16x64_bf16 v[132:135], v[80:83], a[32:39], v1
    ds_read_b128 v[112:115], v17 offset:31744
    buffer_store_dword v0, v21, s[68:71], s42 offen sc1
    s_waitcnt lgkmcnt(6)
    v_smfmac_f32_16x16x64_bf16 v[136:139], v[64:67], v[84:91], v1
    s_nop 1
    s_waitcnt lgkmcnt(4)
    v_smfmac_f32_16x16x64_bf16 v[136:139], v[68:71], v[92:99], v1
    s_nop 1
    s_waitcnt lgkmcnt(2)
    v_smfmac_f32_16x16x64_bf16 v[136:139], v[72:75], v[100:107], v1
    ds_read_b128 v[84:87], v16 offset:10240
    v_add_f32 v132, v132, v134
    s_waitcnt lgkmcnt(1)
    v_smfmac_f32_16x16x64_bf16 v[136:139], v[76:79], v[108:115], v1
    ds_read_b128 v[88:91], v16 offset:11264
    v_add_f32 v133, v133, v135
    v_smfmac_f32_16x16x64_bf16 v[136:139], v[80:83], a[40:47], v1
    ds_read_b128 v[92:95], v16 offset:12288
    v_cvt_pk_bf16_f32 v132, v132, v133
    v_smfmac_f32_16x16x64_bf16 v[140:143], v[64:67], a[72:79], v1
    ds_write_b32 v23, v132
    s_nop 1
    v_smfmac_f32_16x16x64_bf16 v[140:143], v[68:71], a[80:87], v1
    ds_read_b128 v[96:99], v16 offset:13312
    s_nop 0
    v_smfmac_f32_16x16x64_bf16 v[140:143], v[72:75], a[88:95], v1
    ds_read_b128 v[100:103], v16 offset:14336
    v_add_f32 v136, v136, v138
    v_smfmac_f32_16x16x64_bf16 v[140:143], v[76:79], a[96:103], v1
    ds_read_b128 v[104:107], v16 offset:15360
    v_add_f32 v137, v137, v139
    v_smfmac_f32_16x16x64_bf16 v[140:143], v[80:83], a[104:111], v1
    ds_read_b128 v[108:111], v16 offset:16384
    v_cvt_pk_bf16_f32 v136, v136, v137
    v_smfmac_f32_16x16x64_bf16 v[144:147], v[64:67], a[152:159], v1
    ds_write_b32 v23, v136 offset:256
    s_nop 1
    v_smfmac_f32_16x16x64_bf16 v[144:147], v[68:71], a[160:167], v1
    ds_read_b128 v[112:115], v16 offset:17408
    s_nop 0
    v_smfmac_f32_16x16x64_bf16 v[144:147], v[72:75], a[168:175], v1
    v_add_f32 v140, v140, v142
    v_smfmac_f32_16x16x64_bf16 v[144:147], v[76:79], a[176:183], v1
    v_add_f32 v141, v141, v143
    s_waitcnt lgkmcnt(0)
    s_barrier
    v_smfmac_f32_16x16x64_bf16 v[144:147], v[80:83], a[184:191], v1
    ds_read_b64_tr_b16 v[116:117], v25 offset:0
    ds_read_b64_tr_b16 v[118:119], v25 offset:128
    ds_read_b64_tr_b16 v[120:121], v25 offset:512
    ds_read_b64_tr_b16 v[122:123], v25 offset:640
    ds_read_b64_tr_b16 v[124:125], v25 offset:1024
    ds_read_b64_tr_b16 v[126:127], v25 offset:1152
    ds_read_b64_tr_b16 v[128:129], v25 offset:1536
    ds_read_b64_tr_b16 v[130:131], v25 offset:1664
    v_cvt_pk_bf16_f32 v140, v140, v141
    v_add_f32 v144, v144, v146
    v_add_f32 v145, v145, v147
    v_cvt_pk_bf16_f32 v141, v144, v145
    ds_write2_b32 v24, v140, v141 offset0:0 offset1:128
    s_waitcnt lgkmcnt(7)
    v_mfma_f32_16x16x32_bf16 v[132:135], v[84:87], v[116:119], 0
    v_mfma_f32_16x16x32_bf16 v[136:139], v[88:91], v[116:119], 0
    s_waitcnt lgkmcnt(5)
    v_mfma_f32_16x16x32_bf16 v[132:135], v[92:95], v[120:123], v[132:135]
    buffer_load_dword v14, v21, s[4:7], s43 offen sc1
    v_mfma_f32_16x16x32_bf16 v[136:139], v[96:99], v[120:123], v[136:139]
    s_cmp_eq_u32 s29, 63
    s_cbranch_scc1 L_done_17
    s_add_u32 s46, s29, 1
    s_cmp_le_u32 s73, s46
    s_cbranch_scc1 L_kvw_523
L_kvok_21:
    s_waitcnt lgkmcnt(0)
    s_barrier
    ds_read_b64_tr_b16 v[84:85], v26 offset:0
    ds_read_b64_tr_b16 v[86:87], v26 offset:256
    s_add_u32 m0, s72, 10240
    v_mfma_f32_16x16x32_bf16 v[132:135], v[100:103], v[124:127], v[132:135]
    ds_read_b64_tr_b16 v[88:89], v26 offset:1024
    ds_read_b64_tr_b16 v[90:91], v26 offset:1280
    v_mfma_f32_16x16x32_bf16 v[136:139], v[104:107], v[124:127], v[136:139]
    ds_read_b64_tr_b16 v[92:93], v26 offset:2048
    ds_read_b64_tr_b16 v[94:95], v26 offset:2304
    v_mfma_f32_16x16x32_bf16 v[132:135], v[108:111], v[128:131], v[132:135]
    ds_read_b64_tr_b16 v[96:97], v26 offset:3072
    ds_read_b64_tr_b16 v[98:99], v26 offset:3328
    v_mfma_f32_16x16x32_bf16 v[136:139], v[112:115], v[128:131], v[136:139]
    buffer_load_dword v35, v21, s[68:71], s43 offen sc1
    buffer_load_dwordx4 v20, s[4:7], s35 offen sc1 lds
    s_add_u32 s35, s35, 262144
    s_waitcnt lgkmcnt(6)
    v_mfma_f32_16x16x32_bf16 v[156:159], v[84:87], v[116:119], 0
    s_add_u32 m0, s72, 14336
    v_max3_f32 v0, v132, v133, v134
    s_add_u32 s46, s96, s29
    v_mov_b32 v44, s46
    v_mov_b32 v45, s97
    s_waitcnt lgkmcnt(4)
    v_mfma_f32_16x16x32_bf16 v[156:159], v[88:91], v[120:123], v[156:159]
    buffer_store_dword v12, v33, s[4:7], s40 offen sc1
    v_max3_f32 v0, v0, v135, v136
    s_waitcnt lgkmcnt(2)
    v_mfma_f32_16x16x32_bf16 v[156:159], v[92:95], v[124:127], v[156:159]
    buffer_store_dword v140, v23, s[4:7], s39 offen sc1
    v_max3_f32 v0, v0, v137, v138
    s_waitcnt lgkmcnt(0)
    v_mfma_f32_16x16x32_bf16 v[156:159], v[96:99], v[128:131], v[156:159]
    buffer_load_dwordx4 v20, s[4:7], s67 offen sc1 lds
    s_add_u32 s67, s67, 262144
    s_mov_b64 exec, s[74:75]
    buffer_store_dwordx2 v[44:45], off, s[4:7], s76 sc1
    s_mov_b64 exec, -1
    s_add_u32 m0, s72, 0
    v_mov_b32 v64, 0
    v_mov_b32 v65, 0
    v_mov_b32 v66, 0
    v_mov_b32 v67, 0
    v_mov_b32 v68, 0
    v_max3_f32 v34, v139, v156, v157
    v_max_f32 v0, v0, v34
    v_mov_b32 v34, v0
    s_nop 1
    v_permlane32_swap_b32 v0, v34
    v_max_f32 v0, v0, v34
    v_mov_b32 v34, v0
    s_nop 1
    v_permlane16_swap_b32 v0, v34
    v_max_f32 v0, v0, v34
    v_mul_f32 v0, s50, v0
    v_fma_f32 v132, v132, s50, -v0
    v_fma_f32 v133, v133, s50, -v0
    v_exp_f32 v132, v132
    buffer_load_dwordx4 v20, s[4:7], s37 offen sc1 lds
    s_add_u32 s37, s37, 262144
    s_add_u32 m0, s72, 4096
    v_fma_f32 v134, v134, s50, -v0
    v_exp_f32 v133, v133
    v_fma_f32 v135, v135, s50, -v0
    v_exp_f32 v134, v134
    v_fma_f32 v136, v136, s50, -v0
    v_exp_f32 v135, v135
    v_fma_f32 v137, v137, s50, -v0
    v_exp_f32 v136, v136
    v_fma_f32 v138, v138, s50, -v0
    v_exp_f32 v137, v137
    v_fma_f32 v139, v139, s50, -v0
    v_exp_f32 v138, v138
    buffer_load_dwordx4 v20, s[4:7], s38 offen sc1 lds
    s_add_u32 s38, s38, 262144
    v_fma_f32 v156, v156, s50, -v0
    v_exp_f32 v139, v139
    v_fma_f32 v157, v157, s50, -v0
    v_exp_f32 v156, v156
    v_exp_f32 v157, v157
    v_cvt_pk_bf16_f32 v132, v132, v133
    v_cvt_pk_bf16_f32 v133, v134, v135
    v_cvt_pk_bf16_f32 v134, v136, v137
    v_cvt_pk_bf16_f32 v135, v138, v139
    v_cvt_pk_bf16_f32 v10, v156, v157
    s_nop 0
    v_mfma_f32_16x16x32_bf16 v[152:155], v[2:5], v[132:135], 0
    s_waitcnt vmcnt(8)
    v_bitop3_b32 v34, v14, 1, s36 bitop3:0x48
    v_mfma_f32_16x16x32_bf16 v[140:143], v[36:39], v[132:135], 0
    v_cmp_ne_u32 vcc, 0, v34
    v_mov_b32 v69, 0
    v_mfma_f32_16x16x32_bf16 v[144:147], v[40:43], v[132:135], 0
    v_mov_b32 v70, 0
    v_mfma_f32_16x16x16_bf16 v[152:155], v[2:3], v[10:11], v[152:155]
    v_mov_b32 v71, 0
    v_mov_b32 v72, 0
    v_mfma_f32_16x16x16_bf16 v[140:143], v[12:13], v[10:11], v[140:143]
    s_cbranch_vccnz L_vx_526
L_vok_22:
    v_mfma_f32_16x16x16_bf16 v[144:147], v[14:15], v[10:11], v[144:147]
    s_nop 2
    v_rcp_f32 v0, v152
    s_nop 1
    v_mul_f32 v140, v140, v0
    v_mul_f32 v141, v141, v0
    v_mul_f32 v142, v142, v0
    v_mul_f32 v143, v143, v0
    v_cvt_pk_bf16_f32 v140, v140, v141
    v_cvt_pk_bf16_f32 v141, v142, v143
    v_mul_f32 v144, v144, v0
    v_mul_f32 v145, v145, v0
    v_mul_f32 v146, v146, v0
    v_mul_f32 v147, v147, v0
    v_cvt_pk_bf16_f32 v144, v144, v145
    v_cvt_pk_bf16_f32 v145, v146, v147
    ds_write2_b64 v27, v[140:141], v[144:145] offset0:0 offset1:16
    v_mov_b32 v73, 0
    v_mov_b32 v74, 0
    v_mov_b32 v75, 0
    v_mov_b32 v76, 0
    v_mov_b32 v77, 0
    v_mov_b32 v78, 0
    v_mov_b32 v79, 0
    v_mov_b32 v80, 0
    v_mov_b32 v81, 0
    v_mov_b32 v82, 0
    v_mov_b32 v83, 0
    s_waitcnt lgkmcnt(0)
    s_barrier
    ds_read_b128 v[36:39], v28
    ds_read_b128 v[40:43], v28 offset:128
    s_waitcnt lgkmcnt(1)
    v_smfmac_f32_16x16x64_bf16 v[64:67], v[36:39], v[176:183], v1
    s_waitcnt lgkmcnt(0)
    v_smfmac_f32_16x16x64_bf16 v[64:67], v[40:43], v[184:191], v1
    v_smfmac_f32_16x16x64_bf16 v[68:71], v[36:39], v[192:199], v1
    s_nop 1
    v_smfmac_f32_16x16x64_bf16 v[68:71], v[40:43], v[200:207], v1
    s_nop 2
    v_smfmac_f32_16x16x64_bf16 v[72:75], v[36:39], v[208:215], v1
    v_add_f32 v64, v64, v66
    v_smfmac_f32_16x16x64_bf16 v[72:75], v[40:43], v[216:223], v1
    v_add_f32 v65, v65, v67
    v_smfmac_f32_16x16x64_bf16 v[76:79], v[36:39], v[224:231], v1
    v_cvt_pk_bf16_f32 v44, v64, v65
    v_smfmac_f32_16x16x64_bf16 v[76:79], v[40:43], v[232:239], v1
    v_add_f32 v68, v68, v70
    v_smfmac_f32_16x16x64_bf16 v[80:83], v[36:39], v[240:247], v1
    v_add_f32 v69, v69, v71
    v_smfmac_f32_16x16x64_bf16 v[80:83], v[40:43], v[248:255], v1
    v_cvt_pk_bf16_f32 v45, v68, v69
    v_add_f32 v72, v72, v74
    v_add_f32 v73, v73, v75
    v_and_or_b32 v44, v44, -2, s30
    v_cvt_pk_bf16_f32 v46, v72, v73
    v_add_f32 v76, v76, v78
    v_add_f32 v77, v77, v79
    v_and_or_b32 v46, v46, -2, s30
    v_cvt_pk_bf16_f32 v47, v76, v77
    buffer_store_dwordx4 v[44:47], v29, s[4:7], s41 offen
    v_add_f32 v80, v80, v82
    v_add_f32 v81, v81, v83
    v_cvt_pk_bf16_f32 v48, v80, v81
    v_and_or_b32 v48, v48, -2, s30
    buffer_store_dword v48, v30, s[4:7], s41 offen
    s_cmp_eq_u32 s44, 0
    s_cbranch_scc1 L_noown_23
    s_add_u32 s39, s39, 65536
    s_add_u32 s40, s40, 65536
    s_add_u32 s33, s33, 16384
    s_add_u32 s34, s34, 16384
    s_add_u32 s29, s29, 1
    s_and_b32 s47, s29, 3
    s_lshl_b32 s47, s47, 14
    s_add_u32 s32, s45, s47
    s_xor_b32 s47, s47, 32768
    s_add_u32 s66, s45, s47
    s_bfe_u32 s36, s29, 0x10004
    s_and_b32 s47, s29, 7
    s_lshl_b32 s47, s47, 10
    s_and_b32 s46, s29, 8
    s_lshl_b32 s46, s46, 11
    s_or_b32 s46, s46, s47
    s_add_u32 s42, s64, s46
    s_add_u32 s43, s65, s46
    s_nop 11
    buffer_load_dwordx4 v[56:59], v18, s[4:7], s41 offen offset:0 sc1
    buffer_load_dwordx4 v[60:63], v18, s[4:7], s41 offen offset:1024 sc1
    buffer_load_dwordx4 v[64:67], v18, s[4:7], s41 offen offset:2048 sc1
    buffer_load_dwordx4 v[68:71], v18, s[4:7], s41 offen offset:3072 sc1
    s_waitcnt vmcnt(6)
    ds_read_b128 v[36:39], v20 offset:0
    ds_read_b128 v[40:43], v20 offset:4096
    ds_read_b128 v[84:87], v17 offset:0
    ds_read_b128 v[88:91], v17 offset:1024
    ds_read_b128 v[92:95], v17 offset:2048
    ds_read_b128 v[96:99], v17 offset:3072
    ds_read_b128 v[100:103], v17 offset:4096
    ds_read_b128 v[104:107], v17 offset:5120
    ds_read_b128 v[108:111], v17 offset:6144
    ds_read_b128 v[112:115], v17 offset:7168
    ds_read_b128 v[116:119], v17 offset:8192
    ds_read_b128 v[120:123], v17 offset:9216
    ds_read_b128 v[124:127], v17 offset:10240
    ds_read_b128 v[128:131], v17 offset:11264
    s_nop 3
    buffer_load_dwordx4 v[56:59], v18, s[4:7], s41 offen offset:0 sc1
    buffer_load_dwordx4 v[60:63], v18, s[4:7], s41 offen offset:1024 sc1
    buffer_load_dwordx4 v[64:67], v18, s[4:7], s41 offen offset:2048 sc1
    buffer_load_dwordx4 v[68:71], v18, s[4:7], s41 offen offset:3072 sc1
    v_mov_b32 v132, 0
    v_mov_b32 v133, 0
    v_mov_b32 v134, 0
    v_mov_b32 v135, 0
    v_mov_b32 v136, 0
    v_mov_b32 v137, 0
    v_mov_b32 v138, 0
    v_mov_b32 v139, 0
    v_mov_b32 v140, 0
    v_mov_b32 v141, 0
    v_mov_b32 v142, 0
    v_mov_b32 v143, 0
    v_mov_b32 v144, 0
    v_mov_b32 v145, 0
    v_mov_b32 v146, 0
    v_mov_b32 v147, 0
    v_mov_b32 v148, 0
    v_mov_b32 v149, 0
    v_mov_b32 v150, 0
    v_mov_b32 v151, 0
    v_mov_b32 v54, -1
    s_waitcnt vmcnt(7)
    v_bitop3_b32 v0, v56, v58, s30 bitop3:0x7e
    v_mfma_f32_16x16x32_bf16 v[156:159], v[56:59], v[6:9], 0
    s_waitcnt vmcnt(6)
    v_bitop3_b32 v34, v60, v62, s30 bitop3:0x7e
    v_mfma_f32_16x16x32_bf16 v[156:159], v[60:63], v[6:9], v[156:159]
    s_waitcnt vmcnt(5)
    v_bitop3_b32 v52, v64, v66, s30 bitop3:0x7e
    v_mfma_f32_16x16x32_bf16 v[156:159], v[64:67], v[6:9], v[156:159]
    s_waitcnt vmcnt(4)
    v_bitop3_b32 v53, v68, v70, s30 bitop3:0x7e
    v_mfma_f32_16x16x32_bf16 v[156:159], v[68:71], v[6:9], v[156:159]
    v_or3_b32 v0, v0, v34, v52
    v_bitop3_b32 v0, v0, v53, 1 bitop3:0xa8
    v_cmp_ne_u32 vcc, 0, v0
    s_cbranch_vccnz L_h1_529
L_hok_24:
    s_nop 3
    v_add_f32 v156, v156, v158
    v_add_f32 v157, v157, v159
    v_cvt_pk_bf16_f32 v156, v156, v157
    v_min_u32 v156, -2, v156
    buffer_store_dword v156, v19, s[4:7], s32 offen
    buffer_store_dword v156, v19, s[4:7], s33 offen sc1
    s_waitcnt lgkmcnt(0)
    s_barrier
    s_and_b32 s30, s29, 1
    buffer_store_dword v54, v19, s[4:7], s66 offen
    s_waitcnt vmcnt(3)
    s_branch L_entry_16
L_noown_23:
    s_waitcnt vmcnt(2)
    ds_read_b128 v[36:39], v20 offset:0
    ds_read_b128 v[40:43], v20 offset:4096
    ds_read_b128 v[84:87], v17 offset:0
    ds_read_b128 v[88:91], v17 offset:1024
    ds_read_b128 v[92:95], v17 offset:2048
    ds_read_b128 v[96:99], v17 offset:3072
    ds_read_b128 v[100:103], v17 offset:4096
    ds_read_b128 v[104:107], v17 offset:5120
    ds_read_b128 v[108:111], v17 offset:6144
    ds_read_b128 v[112:115], v17 offset:7168
    ds_read_b128 v[116:119], v17 offset:8192
    ds_read_b128 v[120:123], v17 offset:9216
    ds_read_b128 v[124:127], v17 offset:10240
    ds_read_b128 v[128:131], v17 offset:11264
    v_mov_b32 v132, 0
    v_mov_b32 v133, 0
    v_mov_b32 v134, 0
    v_mov_b32 v135, 0
    v_mov_b32 v136, 0
    v_mov_b32 v137, 0
    v_mov_b32 v138, 0
    v_mov_b32 v139, 0
    v_mov_b32 v140, 0
    v_mov_b32 v141, 0
    v_mov_b32 v142, 0
    v_mov_b32 v143, 0
    v_mov_b32 v144, 0
    v_mov_b32 v145, 0
    v_mov_b32 v146, 0
    v_mov_b32 v147, 0
    v_mov_b32 v148, 0
    v_mov_b32 v149, 0
    v_mov_b32 v150, 0
    v_mov_b32 v151, 0
    s_add_u32 s39, s39, 65536
    s_add_u32 s40, s40, 65536
    s_add_u32 s33, s33, 16384
    s_add_u32 s34, s34, 16384
    s_add_u32 s29, s29, 1
    s_and_b32 s47, s29, 3
    s_lshl_b32 s47, s47, 14
    s_add_u32 s32, s45, s47
    s_xor_b32 s47, s47, 32768
    s_add_u32 s66, s45, s47
    s_bfe_u32 s36, s29, 0x10004
    s_and_b32 s47, s29, 7
    s_lshl_b32 s47, s47, 10
    s_and_b32 s46, s29, 8
    s_lshl_b32 s46, s46, 11
    s_or_b32 s46, s46, s47
    s_add_u32 s42, s64, s46
    s_add_u32 s43, s65, s46
    s_and_b32 s30, s29, 1
    s_waitcnt lgkmcnt(0)
    s_cmp_ge_u32 s28, 2
    s_barrier
    s_cbranch_scc1 L_step_15
    s_branch L_entry_16
L_h2l_518:
    s_mov_b64 exec, vcc
L_h2lp_519:
    buffer_load_dwordx4 v[74:77], v18, s[4:7], s32 offen offset:0 sc1
    buffer_load_dwordx4 v[78:81], v18, s[4:7], s32 offen offset:1024 sc1
    buffer_load_dwordx2 v[82:83], v19, s[4:7], s32 offen sc1
    s_mov_b64 exec, -1
    s_waitcnt vmcnt(3)
    v_max3_u32 v0, v74, v75, v76
    v_max3_u32 v0, v0, v77, v78
    v_max3_u32 v0, v0, v79, v80
    v_max3_u32 v0, v0, v81, v82
    v_max_u32 v0, v0, v83
    v_cmp_eq_u32 vcc, -1, v0
    s_cbranch_vccz L_ok_520
    s_mov_b64 exec, vcc
    s_sub_u32 s31, s31, 1
    s_cbranch_scc0 L_h2lp_519
    s_mov_b32 s31, 0
    s_mov_b64 exec, -1
L_ok_520:
    ds_write_b128 v31, v[74:77] offset:0
    ds_write_b128 v31, v[78:81] offset:1024
    ds_write_b64 v32, v[82:83] offset:0
    s_branch L_lok_18
L_h2r_521:
    buffer_load_dwordx4 v[74:77], v18, s[4:7], s34 offen offset:0 sc1
    buffer_load_dwordx4 v[78:81], v18, s[4:7], s34 offen offset:1024 sc1
    buffer_load_dwordx2 v[82:83], v19, s[4:7], s34 offen sc1
    s_waitcnt vmcnt(0)
    ds_write_b128 v31, v[74:77] offset:5120
    ds_write_b128 v31, v[78:81] offset:6144
    ds_write_b64 v32, v[82:83] offset:5120
    v_max3_u32 v0, v74, v75, v76
    v_max3_u32 v0, v0, v77, v78
    v_max3_u32 v0, v0, v79, v80
    v_max3_u32 v0, v0, v81, v82
    v_max_u32 v0, v0, v83
    v_cmp_eq_u32 vcc, -1, v0
    s_cbranch_vccz L_ok_522
    s_sub_u32 s31, s31, 1
    s_cbranch_scc0 L_h2r_521
    s_mov_b32 s31, 0
L_ok_522:
    s_branch L_join_20
L_kvw_523:
    v_bfe_u32 v46, v16, 4, 1
    v_lshlrev_b32 v46, 3, v46
    v_bfe_u32 v47, v16, 5, 1
    v_lshl_add_u32 v46, v47, 9, v46
    s_lshl_b32 s47, s27, 4
    s_add_u32 s47, s47, 8704
L_kvp_524:
    buffer_load_dwordx2 v[44:45], v46, s[4:7], s47 offen sc1
    s_waitcnt vmcnt(0)
    v_subrev_u32 v44, s96, v44
    v_xor_b32 v45, s97, v45
    v_lshrrev_b32 v47, 8, v44
    v_or_b32 v45, v45, v47
    v_cmp_eq_u32 vcc, 0, v45
    s_nop 1
    v_cndmask_b32 v44, 0, v44, vcc
    v_cmp_ge_u32 vcc, s46, v44
    s_cbranch_vccz L_ok_525
    s_sub_u32 s31, s31, 1
    s_cbranch_scc0 L_kvp_524
    s_mov_b32 s31, 0
L_ok_525:
    v_readlane_b32 s73, v44, 0
    v_readlane_b32 s47, v44, 1
    s_nop 0
    s_min_u32 s73, s73, s47
    v_readlane_b32 s47, v44, 2
    s_nop 0
    s_min_u32 s73, s73, s47
    v_readlane_b32 s47, v44, 3
    s_nop 0
    s_min_u32 s73, s73, s47
    s_branch L_kvok_21
L_vx_526:
    s_waitcnt vmcnt(7)
    v_mov_b32 v14, v35
    v_bitop3_b32 v34, v35, 1, s36 bitop3:0x48
    v_cmp_ne_u32 vcc, 0, v34
    s_cbranch_vccz L_vok_22
L_vx2_527:
    buffer_load_dword v14, v21, s[4:7], s43 offen sc1
    s_waitcnt vmcnt(0)
    v_bitop3_b32 v34, v14, 1, s36 bitop3:0x48
    v_cmp_ne_u32 vcc, 0, v34
    s_cbranch_vccz L_ok_528
    s_sub_u32 s31, s31, 1
    s_cbranch_scc0 L_vx2_527
    s_mov_b32 s31, 0
L_ok_528:
    s_branch L_vok_22
L_h1_529:
    s_mov_b64 exec, vcc
L_h1p_530:
    buffer_load_dwordx4 v[56:59], v18, s[4:7], s41 offen offset:0 sc1
    buffer_load_dwordx4 v[60:63], v18, s[4:7], s41 offen offset:1024 sc1
    buffer_load_dwordx4 v[64:67], v18, s[4:7], s41 offen offset:2048 sc1
    buffer_load_dwordx4 v[68:71], v18, s[4:7], s41 offen offset:3072 sc1
    s_mov_b64 exec, -1
    s_waitcnt vmcnt(7)
    v_bitop3_b32 v0, v56, v58, s30 bitop3:0x7e
    v_mfma_f32_16x16x32_bf16 v[156:159], v[56:59], v[6:9], 0
    s_waitcnt vmcnt(6)
    v_bitop3_b32 v34, v60, v62, s30 bitop3:0x7e
    v_mfma_f32_16x16x32_bf16 v[156:159], v[60:63], v[6:9], v[156:159]
    s_waitcnt vmcnt(5)
    v_bitop3_b32 v52, v64, v66, s30 bitop3:0x7e
    v_mfma_f32_16x16x32_bf16 v[156:159], v[64:67], v[6:9], v[156:159]
    s_waitcnt vmcnt(4)
    v_bitop3_b32 v53, v68, v70, s30 bitop3:0x7e
    v_mfma_f32_16x16x32_bf16 v[156:159], v[68:71], v[6:9], v[156:159]
    v_or3_b32 v0, v0, v34, v52
    v_bitop3_b32 v0, v0, v53, 1 bitop3:0xa8
    v_cmp_ne_u32 vcc, 0, v0
    s_cbranch_vccz L_ok_531
    s_mov_b64 exec, vcc
    s_sub_u32 s31, s31, 1
    s_cbranch_scc0 L_h1p_530
    s_mov_b32 s31, 0
    s_mov_b64 exec, -1
L_ok_531:
    s_branch L_hok_24
L_done_17:
    buffer_store_dword v12, v33, s[4:7], s40 offen sc1
    buffer_store_dword v140, v23, s[4:7], s39 offen sc1
    s_branch L_fin_14
L_spread_13:
    s_branch L_entry_533
L_step_532:
    s_nop 15
    s_nop 15
    s_nop 15
    s_nop 7
    buffer_load_dwordx4 v[64:67], v18, s[4:7], s32 offen offset:0 sc1
    buffer_load_dwordx4 v[68:71], v18, s[4:7], s32 offen offset:1024 sc1
    buffer_load_dwordx2 v[72:73], v19, s[4:7], s32 offen sc1
    s_nop 15
    s_nop 7
    buffer_load_dwordx4 v[74:77], v18, s[4:7], s32 offen offset:0 sc1
    buffer_load_dwordx4 v[78:81], v18, s[4:7], s32 offen offset:1024 sc1
    buffer_load_dwordx2 v[82:83], v19, s[4:7], s32 offen sc1
    s_waitcnt vmcnt(5)
    ds_write_b128 v31, v[64:67] offset:0
    s_waitcnt vmcnt(4)
    ds_write_b128 v31, v[68:71] offset:1024
    s_waitcnt vmcnt(3)
    ds_write_b64 v32, v[72:73] offset:0
    v_max3_u32 v0, v64, v65, v66
    v_max3_u32 v0, v0, v67, v68
    v_max3_u32 v0, v0, v69, v70
    v_max3_u32 v0, v0, v71, v72
    v_max_u32 v0, v0, v73
    v_cmp_eq_u32 vcc, -1, v0
    s_cbranch_vccnz L_h2l_1035
L_lok_535:
    buffer_load_dwordx4 v[74:77], v18, s[4:7], s34 offen offset:0 sc1
    buffer_load_dwordx4 v[78:81], v18, s[4:7], s34 offen offset:1024 sc1
    buffer_load_dwordx2 v[82:83], v19, s[4:7], s34 offen sc1
L_entry_533:
    s_waitcnt lgkmcnt(0)
    s_barrier
    ds_read_b128 v[44:47], v16 offset:0
    ds_read_b128 v[48:51], v16 offset:1024
    ds_read_b128 v[52:55], v16 offset:2048
    ds_read_b128 v[56:59], v16 offset:3072
    ds_read_b128 v[60:63], v16 offset:4096
    s_waitcnt lgkmcnt(4)
    v_smfmac_f32_16x16x64_bf16 v[132:135], v[44:47], v[84:91], v1
    v_smfmac_f32_16x16x64_bf16 v[136:139], v[44:47], v[92:99], v1
    ds_read_b128 v[84:87], v17 offset:12288
    v_smfmac_f32_16x16x64_bf16 v[148:151], v[44:47], a[192:199], v1
    ds_read_b128 v[88:91], v17 offset:13312
    s_waitcnt lgkmcnt(5)
    v_smfmac_f32_16x16x64_bf16 v[132:135], v[48:51], v[100:107], v1
    ds_read_b128 v[92:95], v17 offset:14336
    v_smfmac_f32_16x16x64_bf16 v[136:139], v[48:51], v[108:115], v1
    ds_read_b128 v[96:99], v17 offset:15360
    v_smfmac_f32_16x16x64_bf16 v[148:151], v[48:51], a[200:207], v1
    ds_read_b128 v[100:103], v17 offset:16384
    s_waitcnt lgkmcnt(7)
    v_smfmac_f32_16x16x64_bf16 v[132:135], v[52:55], v[116:123], v1
    ds_read_b128 v[104:107], v17 offset:17408
    v_smfmac_f32_16x16x64_bf16 v[136:139], v[52:55], v[124:131], v1
    ds_read_b128 v[108:111], v17 offset:18432
    v_smfmac_f32_16x16x64_bf16 v[148:151], v[52:55], a[208:215], v1
    ds_read_b128 v[112:115], v17 offset:19456
    s_waitcnt lgkmcnt(9)
    s_waitcnt lgkmcnt(6)
    v_smfmac_f32_16x16x64_bf16 v[132:135], v[56:59], v[84:91], v1
    ds_read_b128 v[116:119], v17 offset:20480
    s_waitcnt lgkmcnt(5)
    v_smfmac_f32_16x16x64_bf16 v[136:139], v[56:59], v[92:99], v1
    ds_read_b128 v[120:123], v17 offset:21504
    v_smfmac_f32_16x16x64_bf16 v[148:151], v[56:59], a[216:223], v1
    ds_read_b128 v[124:127], v17 offset:22528
    s_waitcnt lgkmcnt(5)
    v_smfmac_f32_16x16x64_bf16 v[132:135], v[60:63], v[100:107], v1
    ds_read_b128 v[128:131], v17 offset:23552
    s_waitcnt lgkmcnt(4)
    v_smfmac_f32_16x16x64_bf16 v[136:139], v[60:63], v[108:115], v1
    v_smfmac_f32_16x16x64_bf16 v[148:151], v[60:63], a[224:231], v1
    s_waitcnt lgkmcnt(0)
    v_smfmac_f32_16x16x64_bf16 v[140:143], v[44:47], v[116:123], v1
    s_cmp_ge_u32 s28, 2
    s_cbranch_scc1 L_stB_536
    v_smfmac_f32_16x16x64_bf16 v[140:143], v[48:51], a[48:55], v1
    v_smfmac_f32_16x16x64_bf16 v[140:143], v[52:55], v[124:131], v1
    v_smfmac_f32_16x16x64_bf16 v[140:143], v[56:59], a[56:63], v1
    v_smfmac_f32_16x16x64_bf16 v[140:143], v[60:63], a[64:71], v1
    v_smfmac_f32_16x16x64_bf16 v[144:147], v[44:47], a[112:119], v1
    s_branch L_join_537
L_stB_536:
    s_waitcnt vmcnt(0)
    v_smfmac_f32_16x16x64_bf16 v[140:143], v[48:51], a[48:55], v1
    ds_write_b128 v31, v[74:77] offset:5120
    v_max3_u32 v0, v74, v75, v76
    v_smfmac_f32_16x16x64_bf16 v[140:143], v[52:55], v[124:131], v1
    ds_write_b128 v31, v[78:81] offset:6144
    v_max3_u32 v0, v0, v77, v78
    v_smfmac_f32_16x16x64_bf16 v[140:143], v[56:59], a[56:63], v1
    ds_write_b64 v32, v[82:83] offset:5120
    v_max3_u32 v0, v0, v79, v80
    v_smfmac_f32_16x16x64_bf16 v[140:143], v[60:63], a[64:71], v1
    v_max3_u32 v0, v0, v81, v82
    v_smfmac_f32_16x16x64_bf16 v[144:147], v[44:47], a[112:119], v1
    v_max_u32 v0, v0, v83
    v_cmp_eq_u32 vcc, -1, v0
    s_cbranch_vccnz L_h2r_1038
L_join_537:
    s_waitcnt lgkmcnt(0)
    s_barrier
    ds_read_b128 v[64:67], v16 offset:5120
    v_smfmac_f32_16x16x64_bf16 v[144:147], v[48:51], a[120:127], v1
    ds_read_b128 v[68:71], v16 offset:6144
    v_smfmac_f32_16x16x64_bf16 v[144:147], v[52:55], a[128:135], v1
    ds_read_b128 v[72:75], v16 offset:7168
    v_smfmac_f32_16x16x64_bf16 v[144:147], v[56:59], a[136:143], v1
    ds_read_b128 v[76:79], v16 offset:8192
    v_smfmac_f32_16x16x64_bf16 v[144:147], v[60:63], a[144:151], v1
    ds_read_b128 v[80:83], v16 offset:9216
    s_waitcnt lgkmcnt(4)
    v_smfmac_f32_16x16x64_bf16 v[148:151], v[64:67], a[232:239], v1
    s_waitcnt lgkmcnt(3)
    v_smfmac_f32_16x16x64_bf16 v[148:151], v[68:71], a[240:247], v1
    ds_read_b128 v[84:87], v17 offset:24576
    s_waitcnt lgkmcnt(3)
    v_smfmac_f32_16x16x64_bf16 v[148:151], v[72:75], a[248:255], v1
    ds_read_b128 v[88:91], v17 offset:25600
    s_waitcnt lgkmcnt(3)
    v_smfmac_f32_16x16x64_bf16 v[148:151], v[76:79], v[160:167], v1
    ds_read_b128 v[92:95], v17 offset:26624
    s_waitcnt lgkmcnt(3)
    v_smfmac_f32_16x16x64_bf16 v[148:151], v[80:83], v[168:175], v1
    ds_read_b128 v[96:99], v17 offset:27648
    v_smfmac_f32_16x16x64_bf16 v[132:135], v[64:67], a[0:7], v1
    ds_read_b128 v[100:103], v17 offset:28672
    s_nop 1
    v_smfmac_f32_16x16x64_bf16 v[132:135], v[68:71], a[8:15], v1
    ds_read_b128 v[104:107], v17 offset:29696
    s_nop 0
    v_add_f32 v148, v148, v150
    v_add_f32 v149, v149, v151
    v_smfmac_f32_16x16x64_bf16 v[132:135], v[72:75], a[16:23], v1
    ds_read_b128 v[108:111], v17 offset:30720
    v_cvt_pk_bf16_f32 v12, v148, v149
    v_and_or_b32 v0, v12, -2, s36
    v_smfmac_f32_16x16x64_bf16 v[132:135], v[76:79], a[24:31], v1
    buffer_store_dword v0, v21, s[4:7], s42 offen sc1
    v_smfmac_f32_16x16x64_bf16 v[132:135], v[80:83], a[32:39], v1
    ds_read_b128 v[112:115], v17 offset:31744
    buffer_store_dword v0, v21, s[68:71], s42 offen sc1
    s_waitcnt lgkmcnt(6)
    v_smfmac_f32_16x16x64_bf16 v[136:139], v[64:67], v[84:91], v1
    s_nop 1
    s_waitcnt lgkmcnt(4)
    v_smfmac_f32_16x16x64_bf16 v[136:139], v[68:71], v[92:99], v1
    s_nop 1
    s_waitcnt lgkmcnt(2)
    v_smfmac_f32_16x16x64_bf16 v[136:139], v[72:75], v[100:107], v1
    ds_read_b128 v[84:87], v16 offset:10240
    v_add_f32 v132, v132, v134
    s_waitcnt lgkmcnt(1)
    v_smfmac_f32_16x16x64_bf16 v[136:139], v[76:79], v[108:115], v1
    ds_read_b128 v[88:91], v16 offset:11264
    v_add_f32 v133, v133, v135
    v_smfmac_f32_16x16x64_bf16 v[136:139], v[80:83], a[40:47], v1
    ds_read_b128 v[92:95], v16 offset:12288
    v_cvt_pk_bf16_f32 v132, v132, v133
    v_smfmac_f32_16x16x64_bf16 v[140:143], v[64:67], a[72:79], v1
    ds_write_b32 v23, v132
    s_nop 1
    v_smfmac_f32_16x16x64_bf16 v[140:143], v[68:71], a[80:87], v1
    ds_read_b128 v[96:99], v16 offset:13312
    s_nop 0
    v_smfmac_f32_16x16x64_bf16 v[140:143], v[72:75], a[88:95], v1
    ds_read_b128 v[100:103], v16 offset:14336
    v_add_f32 v136, v136, v138
    v_smfmac_f32_16x16x64_bf16 v[140:143], v[76:79], a[96:103], v1
    ds_read_b128 v[104:107], v16 offset:15360
    v_add_f32 v137, v137, v139
    v_smfmac_f32_16x16x64_bf16 v[140:143], v[80:83], a[104:111], v1
    ds_read_b128 v[108:111], v16 offset:16384
    v_cvt_pk_bf16_f32 v136, v136, v137
    v_smfmac_f32_16x16x64_bf16 v[144:147], v[64:67], a[152:159], v1
    ds_write_b32 v23, v136 offset:256
    s_nop 1
    v_smfmac_f32_16x16x64_bf16 v[144:147], v[68:71], a[160:167], v1
    ds_read_b128 v[112:115], v16 offset:17408
    s_nop 0
    v_smfmac_f32_16x16x64_bf16 v[144:147], v[72:75], a[168:175], v1
    v_add_f32 v140, v140, v142
    v_smfmac_f32_16x16x64_bf16 v[144:147], v[76:79], a[176:183], v1
    v_add_f32 v141, v141, v143
    s_waitcnt lgkmcnt(0)
    s_barrier
    v_smfmac_f32_16x16x64_bf16 v[144:147], v[80:83], a[184:191], v1
    ds_read_b64_tr_b16 v[116:117], v25 offset:0
    ds_read_b64_tr_b16 v[118:119], v25 offset:128
    ds_read_b64_tr_b16 v[120:121], v25 offset:512
    ds_read_b64_tr_b16 v[122:123], v25 offset:640
    ds_read_b64_tr_b16 v[124:125], v25 offset:1024
    ds_read_b64_tr_b16 v[126:127], v25 offset:1152
    ds_read_b64_tr_b16 v[128:129], v25 offset:1536
    ds_read_b64_tr_b16 v[130:131], v25 offset:1664
    v_cvt_pk_bf16_f32 v140, v140, v141
    v_add_f32 v144, v144, v146
    v_add_f32 v145, v145, v147
    v_cvt_pk_bf16_f32 v141, v144, v145
    ds_write2_b32 v24, v140, v141 offset0:0 offset1:128
    s_waitcnt lgkmcnt(7)
    v_mfma_f32_16x16x32_bf16 v[132:135], v[84:87], v[116:119], 0
    v_mfma_f32_16x16x32_bf16 v[136:139], v[88:91], v[116:119], 0
    s_waitcnt lgkmcnt(5)
    v_mfma_f32_16x16x32_bf16 v[132:135], v[92:95], v[120:123], v[132:135]
    buffer_load_dword v14, v21, s[4:7], s43 offen sc1
    v_mfma_f32_16x16x32_bf16 v[136:139], v[96:99], v[120:123], v[136:139]
    s_cmp_eq_u32 s29, 63
    s_cbranch_scc1 L_done_534
    s_add_u32 s46, s29, 1
    s_cmp_le_u32 s73, s46
    s_cbranch_scc1 L_kvw_1040
L_kvok_538:
    s_waitcnt lgkmcnt(0)
    s_barrier
    ds_read_b64_tr_b16 v[84:85], v26 offset:0
    ds_read_b64_tr_b16 v[86:87], v26 offset:256
    s_add_u32 m0, s72, 10240
    v_mfma_f32_16x16x32_bf16 v[132:135], v[100:103], v[124:127], v[132:135]
    ds_read_b64_tr_b16 v[88:89], v26 offset:1024
    ds_read_b64_tr_b16 v[90:91], v26 offset:1280
    v_mfma_f32_16x16x32_bf16 v[136:139], v[104:107], v[124:127], v[136:139]
    ds_read_b64_tr_b16 v[92:93], v26 offset:2048
    ds_read_b64_tr_b16 v[94:95], v26 offset:2304
    v_mfma_f32_16x16x32_bf16 v[132:135], v[108:111], v[128:131], v[132:135]
    ds_read_b64_tr_b16 v[96:97], v26 offset:3072
    ds_read_b64_tr_b16 v[98:99], v26 offset:3328
    v_mfma_f32_16x16x32_bf16 v[136:139], v[112:115], v[128:131], v[136:139]
    buffer_load_dword v35, v21, s[68:71], s43 offen sc1
    buffer_load_dwordx4 v20, s[4:7], s35 offen sc1 lds
    s_add_u32 s35, s35, 262144
    s_waitcnt lgkmcnt(6)
    v_mfma_f32_16x16x32_bf16 v[156:159], v[84:87], v[116:119], 0
    s_add_u32 m0, s72, 14336
    v_max3_f32 v0, v132, v133, v134
    s_add_u32 s46, s96, s29
    v_mov_b32 v44, s46
    v_mov_b32 v45, s97
    s_waitcnt lgkmcnt(4)
    v_mfma_f32_16x16x32_bf16 v[156:159], v[88:91], v[120:123], v[156:159]
    buffer_store_dword v12, v33, s[4:7], s40 offen sc1
    v_max3_f32 v0, v0, v135, v136
    s_waitcnt lgkmcnt(2)
    v_mfma_f32_16x16x32_bf16 v[156:159], v[92:95], v[124:127], v[156:159]
    buffer_store_dword v140, v23, s[4:7], s39 offen sc1
    v_max3_f32 v0, v0, v137, v138
    s_waitcnt lgkmcnt(0)
    v_mfma_f32_16x16x32_bf16 v[156:159], v[96:99], v[128:131], v[156:159]
    buffer_load_dwordx4 v20, s[4:7], s67 offen sc1 lds
    s_add_u32 s67, s67, 262144
    s_mov_b64 exec, s[74:75]
    buffer_store_dwordx2 v[44:45], off, s[4:7], s76 sc1
    s_mov_b64 exec, -1
    s_add_u32 m0, s72, 0
    v_mov_b32 v64, 0
    v_mov_b32 v65, 0
    v_mov_b32 v66, 0
    v_mov_b32 v67, 0
    v_mov_b32 v68, 0
    v_max3_f32 v34, v139, v156, v157
    v_max_f32 v0, v0, v34
    v_mov_b32 v34, v0
    s_nop 1
    v_permlane32_swap_b32 v0, v34
    v_max_f32 v0, v0, v34
    v_mov_b32 v34, v0
    s_nop 1
    v_permlane16_swap_b32 v0, v34
    v_max_f32 v0, v0, v34
    v_mul_f32 v0, s50, v0
    v_fma_f32 v132, v132, s50, -v0
    v_fma_f32 v133, v133, s50, -v0
    v_exp_f32 v132, v132
    buffer_load_dwordx4 v20, s[4:7], s37 offen sc1 lds
    s_add_u32 s37, s37, 262144
    s_add_u32 m0, s72, 4096
    v_fma_f32 v134, v134, s50, -v0
    v_exp_f32 v133, v133
    v_fma_f32 v135, v135, s50, -v0
    v_exp_f32 v134, v134
    v_fma_f32 v136, v136, s50, -v0
    v_exp_f32 v135, v135
    v_fma_f32 v137, v137, s50, -v0
    v_exp_f32 v136, v136
    v_fma_f32 v138, v138, s50, -v0
    v_exp_f32 v137, v137
    v_fma_f32 v139, v139, s50, -v0
    v_exp_f32 v138, v138
    buffer_load_dwordx4 v20, s[4:7], s38 offen sc1 lds
    s_add_u32 s38, s38, 262144
    v_fma_f32 v156, v156, s50, -v0
    v_exp_f32 v139, v139
    v_fma_f32 v157, v157, s50, -v0
    v_exp_f32 v156, v156
    v_exp_f32 v157, v157
    v_cvt_pk_bf16_f32 v132, v132, v133
    v_cvt_pk_bf16_f32 v133, v134, v135
    v_cvt_pk_bf16_f32 v134, v136, v137
    v_cvt_pk_bf16_f32 v135, v138, v139
    v_cvt_pk_bf16_f32 v10, v156, v157
    s_nop 0
    v_mfma_f32_16x16x32_bf16 v[152:155], v[2:5], v[132:135], 0
    s_waitcnt vmcnt(8)
    v_bitop3_b32 v34, v14, 1, s36 bitop3:0x48
    v_mfma_f32_16x16x32_bf16 v[140:143], v[36:39], v[132:135], 0
    v_cmp_ne_u32 vcc, 0, v34
    v_mov_b32 v69, 0
    v_mfma_f32_16x16x32_bf16 v[144:147], v[40:43], v[132:135], 0
    v_mov_b32 v70, 0
    v_mfma_f32_16x16x16_bf16 v[152:155], v[2:3], v[10:11], v[152:155]
    v_mov_b32 v71, 0
    v_mov_b32 v72, 0
    v_mfma_f32_16x16x16_bf16 v[140:143], v[12:13], v[10:11], v[140:143]
    s_cbranch_vccnz L_vx_1043
L_vok_539:
    v_mfma_f32_16x16x16_bf16 v[144:147], v[14:15], v[10:11], v[144:147]
    s_nop 2
    v_rcp_f32 v0, v152
    s_nop 1
    v_mul_f32 v140, v140, v0
    v_mul_f32 v141, v141, v0
    v_mul_f32 v142, v142, v0
    v_mul_f32 v143, v143, v0
    v_cvt_pk_bf16_f32 v140, v140, v141
    v_cvt_pk_bf16_f32 v141, v142, v143
    v_mul_f32 v144, v144, v0
    v_mul_f32 v145, v145, v0
    v_mul_f32 v146, v146, v0
    v_mul_f32 v147, v147, v0
    v_cvt_pk_bf16_f32 v144, v144, v145
    v_cvt_pk_bf16_f32 v145, v146, v147
    ds_write2_b64 v27, v[140:141], v[144:145] offset0:0 offset1:16
    v_mov_b32 v73, 0
    v_mov_b32 v74, 0
    v_mov_b32 v75, 0
    v_mov_b32 v76, 0
    v_mov_b32 v77, 0
    v_mov_b32 v78, 0
    v_mov_b32 v79, 0
    v_mov_b32 v80, 0
    v_mov_b32 v81, 0
    v_mov_b32 v82, 0
    v_mov_b32 v83, 0
    s_waitcnt lgkmcnt(0)
    s_barrier
    ds_read_b128 v[36:39], v28
    ds_read_b128 v[40:43], v28 offset:128
    s_waitcnt lgkmcnt(1)
    v_smfmac_f32_16x16x64_bf16 v[64:67], v[36:39], v[176:183], v1
    s_waitcnt lgkmcnt(0)
    v_smfmac_f32_16x16x64_bf16 v[64:67], v[40:43], v[184:191], v1
    v_smfmac_f32_16x16x64_bf16 v[68:71], v[36:39], v[192:199], v1
    s_nop 1
    v_smfmac_f32_16x16x64_bf16 v[68:71], v[40:43], v[200:207], v1
    s_nop 2
    v_smfmac_f32_16x16x64_bf16 v[72:75], v[36:39], v[208:215], v1
    v_add_f32 v64, v64, v66
    v_smfmac_f32_16x16x64_bf16 v[72:75], v[40:43], v[216:223], v1
    v_add_f32 v65, v65, v67
    v_smfmac_f32_16x16x64_bf16 v[76:79], v[36:39], v[224:231], v1
    v_cvt_pk_bf16_f32 v44, v64, v65
    v_smfmac_f32_16x16x64_bf16 v[76:79], v[40:43], v[232:239], v1
    v_add_f32 v68, v68, v70
    v_smfmac_f32_16x16x64_bf16 v[80:83], v[36:39], v[240:247], v1
    v_add_f32 v69, v69, v71
    v_smfmac_f32_16x16x64_bf16 v[80:83], v[40:43], v[248:255], v1
    v_cvt_pk_bf16_f32 v45, v68, v69
    v_add_f32 v72, v72, v74
    v_add_f32 v73, v73, v75
    v_and_or_b32 v44, v44, -2, s30
    v_cvt_pk_bf16_f32 v46, v72, v73
    v_add_f32 v76, v76, v78
    v_add_f32 v77, v77, v79
    v_and_or_b32 v46, v46, -2, s30
    v_cvt_pk_bf16_f32 v47, v76, v77
    buffer_store_dwordx4 v[44:47], v29, s[4:7], s41 offen sc1
    v_add_f32 v80, v80, v82
    v_add_f32 v81, v81, v83
    v_cvt_pk_bf16_f32 v48, v80, v81
    v_and_or_b32 v48, v48, -2, s30
    buffer_store_dword v48, v30, s[4:7], s41 offen sc1
    s_cmp_eq_u32 s44, 0
    s_cbranch_scc1 L_noown_540
    s_add_u32 s39, s39, 65536
    s_add_u32 s40, s40, 65536
    s_add_u32 s33, s33, 16384
    s_add_u32 s34, s34, 16384
    s_add_u32 s29, s29, 1
    s_and_b32 s47, s29, 3
    s_lshl_b32 s47, s47, 14
    s_add_u32 s32, s45, s47
    s_xor_b32 s47, s47, 32768
    s_add_u32 s66, s45, s47
    s_bfe_u32 s36, s29, 0x10004
    s_and_b32 s47, s29, 7
    s_lshl_b32 s47, s47, 10
    s_and_b32 s46, s29, 8
    s_lshl_b32 s46, s46, 11
    s_or_b32 s46, s46, s47
    s_add_u32 s42, s64, s46
    s_add_u32 s43, s65, s46
    s_nop 11
    buffer_load_dwordx4 v[56:59], v18, s[4:7], s41 offen offset:0 sc1
    buffer_load_dwordx4 v[60:63], v18, s[4:7], s41 offen offset:1024 sc1
    buffer_load_dwordx4 v[64:67], v18, s[4:7], s41 offen offset:2048 sc1
    buffer_load_dwordx4 v[68:71], v18, s[4:7], s41 offen offset:3072 sc1
    s_waitcnt vmcnt(6)
    ds_read_b128 v[36:39], v20 offset:0
    ds_read_b128 v[40:43], v20 offset:4096
    ds_read_b128 v[84:87], v17 offset:0
    ds_read_b128 v[88:91], v17 offset:1024
    ds_read_b128 v[92:95], v17 offset:2048
    ds_read_b128 v[96:99], v17 offset:3072
    ds_read_b128 v[100:103], v17 offset:4096
    ds_read_b128 v[104:107], v17 offset:5120
    ds_read_b128 v[108:111], v17 offset:6144
    ds_read_b128 v[112:115], v17 offset:7168
    ds_read_b128 v[116:119], v17 offset:8192
    ds_read_b128 v[120:123], v17 offset:9216
    ds_read_b128 v[124:127], v17 offset:10240
    ds_read_b128 v[128:131], v17 offset:11264
    s_nop 3
    buffer_load_dwordx4 v[56:59], v18, s[4:7], s41 offen offset:0 sc1
    buffer_load_dwordx4 v[60:63], v18, s[4:7], s41 offen offset:1024 sc1
    buffer_load_dwordx4 v[64:67], v18, s[4:7], s41 offen offset:2048 sc1
    buffer_load_dwordx4 v[68:71], v18, s[4:7], s41 offen offset:3072 sc1
    v_mov_b32 v132, 0
    v_mov_b32 v133, 0
    v_mov_b32 v134, 0
    v_mov_b32 v135, 0
    v_mov_b32 v136, 0
    v_mov_b32 v137, 0
    v_mov_b32 v138, 0
    v_mov_b32 v139, 0
    v_mov_b32 v140, 0
    v_mov_b32 v141, 0
    v_mov_b32 v142, 0
    v_mov_b32 v143, 0
    v_mov_b32 v144, 0
    v_mov_b32 v145, 0
    v_mov_b32 v146, 0
    v_mov_b32 v147, 0
    v_mov_b32 v148, 0
    v_mov_b32 v149, 0
    v_mov_b32 v150, 0
    v_mov_b32 v151, 0
    v_mov_b32 v54, -1
    s_waitcnt vmcnt(7)
    v_bitop3_b32 v0, v56, v58, s30 bitop3:0x7e
    v_bitop3_b32 v55, v57, v59, s30 bitop3:0x7e
    v_and_or_b32 v0, v55, s28, v0
    v_mfma_f32_16x16x32_bf16 v[156:159], v[56:59], v[6:9], 0
    s_waitcnt vmcnt(6)
    v_bitop3_b32 v34, v60, v62, s30 bitop3:0x7e
    v_bitop3_b32 v55, v61, v63, s30 bitop3:0x7e
    v_and_or_b32 v34, v55, s28, v34
    v_mfma_f32_16x16x32_bf16 v[156:159], v[60:63], v[6:9], v[156:159]
    s_waitcnt vmcnt(5)
    v_bitop3_b32 v52, v64, v66, s30 bitop3:0x7e
    v_bitop3_b32 v55, v65, v67, s30 bitop3:0x7e
    v_and_or_b32 v52, v55, s28, v52
    v_mfma_f32_16x16x32_bf16 v[156:159], v[64:67], v[6:9], v[156:159]
    s_waitcnt vmcnt(4)
    v_bitop3_b32 v53, v68, v70, s30 bitop3:0x7e
    v_bitop3_b32 v55, v69, v71, s30 bitop3:0x7e
    v_and_or_b32 v53, v55, s28, v53
    v_mfma_f32_16x16x32_bf16 v[156:159], v[68:71], v[6:9], v[156:159]
    v_or3_b32 v0, v0, v34, v52
    v_bitop3_b32 v0, v0, v53, 1 bitop3:0xa8
    v_cmp_ne_u32 vcc, 0, v0
    s_cbranch_vccnz L_h1_1046
L_hok_541:
    s_nop 3
    v_add_f32 v156, v156, v158
    v_add_f32 v157, v157, v159
    v_cvt_pk_bf16_f32 v156, v156, v157
    v_min_u32 v156, -2, v156
    buffer_store_dword v156, v19, s[4:7], s32 offen sc1
    buffer_store_dword v156, v19, s[4:7], s33 offen sc1
    s_waitcnt lgkmcnt(0)
    s_barrier
    s_and_b32 s30, s29, 1
    buffer_store_dword v54, v19, s[4:7], s66 offen sc1
    s_waitcnt vmcnt(3)
    s_branch L_entry_533
L_noown_540:
    s_waitcnt vmcnt(2)
    ds_read_b128 v[36:39], v20 offset:0
    ds_read_b128 v[40:43], v20 offset:4096
    ds_read_b128 v[84:87], v17 offset:0
    ds_read_b128 v[88:91], v17 offset:1024
    ds_read_b128 v[92:95], v17 offset:2048
    ds_read_b128 v[96:99], v17 offset:3072
    ds_read_b128 v[100:103], v17 offset:4096
    ds_read_b128 v[104:107], v17 offset:5120
    ds_read_b128 v[108:111], v17 offset:6144
    ds_read_b128 v[112:115], v17 offset:7168
    ds_read_b128 v[116:119], v17 offset:8192
    ds_read_b128 v[120:123], v17 offset:9216
    ds_read_b128 v[124:127], v17 offset:10240
    ds_read_b128 v[128:131], v17 offset:11264
    v_mov_b32 v132, 0
    v_mov_b32 v133, 0
    v_mov_b32 v134, 0
    v_mov_b32 v135, 0
    v_mov_b32 v136, 0
    v_mov_b32 v137, 0
    v_mov_b32 v138, 0
    v_mov_b32 v139, 0
    v_mov_b32 v140, 0
    v_mov_b32 v141, 0
    v_mov_b32 v142, 0
    v_mov_b32 v143, 0
    v_mov_b32 v144, 0
    v_mov_b32 v145, 0
    v_mov_b32 v146, 0
    v_mov_b32 v147, 0
    v_mov_b32 v148, 0
    v_mov_b32 v149, 0
    v_mov_b32 v150, 0
    v_mov_b32 v151, 0
    s_add_u32 s39, s39, 65536
    s_add_u32 s40, s40, 65536
    s_add_u32 s33, s33, 16384
    s_add_u32 s34, s34, 16384
    s_add_u32 s29, s29, 1
    s_and_b32 s47, s29, 3
    s_lshl_b32 s47, s47, 14
    s_add_u32 s32, s45, s47
    s_xor_b32 s47, s47, 32768
    s_add_u32 s66, s45, s47
    s_bfe_u32 s36, s29, 0x10004
    s_and_b32 s47, s29, 7
    s_lshl_b32 s47, s47, 10
    s_and_b32 s46, s29, 8
    s_lshl_b32 s46, s46, 11
    s_or_b32 s46, s46, s47
    s_add_u32 s42, s64, s46
    s_add_u32 s43, s65, s46
    s_and_b32 s30, s29, 1
    s_waitcnt lgkmcnt(0)
    s_cmp_ge_u32 s28, 2
    s_barrier
    s_cbranch_scc1 L_step_532
    s_branch L_entry_533
L_h2l_1035:
    s_mov_b64 exec, vcc
L_h2lp_1036:
    buffer_load_dwordx4 v[74:77], v18, s[4:7], s32 offen offset:0 sc1
    buffer_load_dwordx4 v[78:81], v18, s[4:7], s32 offen offset:1024 sc1
    buffer_load_dwordx2 v[82:83], v19, s[4:7], s32 offen sc1
    s_mov_b64 exec, -1
    s_waitcnt vmcnt(3)
    v_max3_u32 v0, v74, v75, v76
    v_max3_u32 v0, v0, v77, v78
    v_max3_u32 v0, v0, v79, v80
    v_max3_u32 v0, v0, v81, v82
    v_max_u32 v0, v0, v83
    v_cmp_eq_u32 vcc, -1, v0
    s_cbranch_vccz L_ok_1037
    s_mov_b64 exec, vcc
    s_sub_u32 s31, s31, 1
    s_cbranch_scc0 L_h2lp_1036
    s_mov_b32 s31, 0
    s_mov_b64 exec, -1
L_ok_1037:
    ds_write_b128 v31, v[74:77] offset:0
    ds_write_b128 v31, v[78:81] offset:1024
    ds_write_b64 v32, v[82:83] offset:0
    s_branch L_lok_535
L_h2r_1038:
    buffer_load_dwordx4 v[74:77], v18, s[4:7], s34 offen offset:0 sc1
    buffer_load_dwordx4 v[78:81], v18, s[4:7], s34 offen offset:1024 sc1
    buffer_load_dwordx2 v[82:83], v19, s[4:7], s34 offen sc1
    s_waitcnt vmcnt(0)
    ds_write_b128 v31, v[74:77] offset:5120
    ds_write_b128 v31, v[78:81] offset:6144
    ds_write_b64 v32, v[82:83] offset:5120
    v_max3_u32 v0, v74, v75, v76
    v_max3_u32 v0, v0, v77, v78
    v_max3_u32 v0, v0, v79, v80
    v_max3_u32 v0, v0, v81, v82
    v_max_u32 v0, v0, v83
    v_cmp_eq_u32 vcc, -1, v0
    s_cbranch_vccz L_ok_1039
    s_sub_u32 s31, s31, 1
    s_cbranch_scc0 L_h2r_1038
    s_mov_b32 s31, 0
L_ok_1039:
    s_branch L_join_537
L_kvw_1040:
    v_bfe_u32 v46, v16, 4, 1
    v_lshlrev_b32 v46, 3, v46
    v_bfe_u32 v47, v16, 5, 1
    v_lshl_add_u32 v46, v47, 9, v46
    s_lshl_b32 s47, s27, 4
    s_add_u32 s47, s47, 8704
L_kvp_1041:
    buffer_load_dwordx2 v[44:45], v46, s[4:7], s47 offen sc1
    s_waitcnt vmcnt(0)
    v_subrev_u32 v44, s96, v44
    v_xor_b32 v45, s97, v45
    v_lshrrev_b32 v47, 8, v44
    v_or_b32 v45, v45, v47
    v_cmp_eq_u32 vcc, 0, v45
    s_nop 1
    v_cndmask_b32 v44, 0, v44, vcc
    v_cmp_ge_u32 vcc, s46, v44
    s_cbranch_vccz L_ok_1042
    s_sub_u32 s31, s31, 1
    s_cbranch_scc0 L_kvp_1041
    s_mov_b32 s31, 0
L_ok_1042:
    v_readlane_b32 s73, v44, 0
    v_readlane_b32 s47, v44, 1
    s_nop 0
    s_min_u32 s73, s73, s47
    v_readlane_b32 s47, v44, 2
    s_nop 0
    s_min_u32 s73, s73, s47
    v_readlane_b32 s47, v44, 3
    s_nop 0
    s_min_u32 s73, s73, s47
    s_branch L_kvok_538
L_vx_1043:
    s_waitcnt vmcnt(7)
    v_mov_b32 v14, v35
    v_bitop3_b32 v34, v35, 1, s36 bitop3:0x48
    v_cmp_ne_u32 vcc, 0, v34
    s_cbranch_vccz L_vok_539
L_vx2_1044:
    buffer_load_dword v14, v21, s[4:7], s43 offen sc1
    s_waitcnt vmcnt(0)
    v_bitop3_b32 v34, v14, 1, s36 bitop3:0x48
    v_cmp_ne_u32 vcc, 0, v34
    s_cbranch_vccz L_ok_1045
    s_sub_u32 s31, s31, 1
    s_cbranch_scc0 L_vx2_1044
    s_mov_b32 s31, 0
L_ok_1045:
    s_branch L_vok_539
L_h1_1046:
    s_mov_b64 exec, vcc
L_h1p_1047:
    buffer_load_dwordx4 v[56:59], v18, s[4:7], s41 offen offset:0 sc1
    buffer_load_dwordx4 v[60:63], v18, s[4:7], s41 offen offset:1024 sc1
    buffer_load_dwordx4 v[64:67], v18, s[4:7], s41 offen offset:2048 sc1
    buffer_load_dwordx4 v[68:71], v18, s[4:7], s41 offen offset:3072 sc1
    s_mov_b64 exec, -1
    s_waitcnt vmcnt(7)
    v_bitop3_b32 v0, v56, v58, s30 bitop3:0x7e
    v_bitop3_b32 v55, v57, v59, s30 bitop3:0x7e
    v_and_or_b32 v0, v55, s28, v0
    v_mfma_f32_16x16x32_bf16 v[156:159], v[56:59], v[6:9], 0
    s_waitcnt vmcnt(6)
    v_bitop3_b32 v34, v60, v62, s30 bitop3:0x7e
    v_bitop3_b32 v55, v61, v63, s30 bitop3:0x7e
    v_and_or_b32 v34, v55, s28, v34
    v_mfma_f32_16x16x32_bf16 v[156:159], v[60:63], v[6:9], v[156:159]
    s_waitcnt vmcnt(5)
    v_bitop3_b32 v52, v64, v66, s30 bitop3:0x7e
    v_bitop3_b32 v55, v65, v67, s30 bitop3:0x7e
    v_and_or_b32 v52, v55, s28, v52
    v_mfma_f32_16x16x32_bf16 v[156:159], v[64:67], v[6:9], v[156:159]
    s_waitcnt vmcnt(4)
    v_bitop3_b32 v53, v68, v70, s30 bitop3:0x7e
    v_bitop3_b32 v55, v69, v71, s30 bitop3:0x7e
    v_and_or_b32 v53, v55, s28, v53
    v_mfma_f32_16x16x32_bf16 v[156:159], v[68:71], v[6:9], v[156:159]
    v_or3_b32 v0, v0, v34, v52
    v_bitop3_b32 v0, v0, v53, 1 bitop3:0xa8
    v_cmp_ne_u32 vcc, 0, v0
    s_cbranch_vccz L_ok_1048
    s_mov_b64 exec, vcc
    s_sub_u32 s31, s31, 1
    s_cbranch_scc0 L_h1p_1047
    s_mov_b32 s31, 0
    s_mov_b64 exec, -1
L_ok_1048:
    s_branch L_hok_541
L_done_534:
    buffer_store_dword v12, v33, s[4:7], s40 offen sc1
    buffer_store_dword v140, v23, s[4:7], s39 offen sc1
L_fin_14:
    s_waitcnt vmcnt(0) lgkmcnt(0)
    s_barrier
    s_add_u32 s46, s96, 255
    v_mov_b32 v44, s46
    v_mov_b32 v45, s97
    s_mov_b64 exec, s[74:75]
    buffer_store_dwordx2 v[44:45], off, s[4:7], s76 sc1
    s_mov_b64 exec, -1
    s_endpgm
L_worker_2:
    s_and_b32 s95, s2, 7
    s_sub_u32 s95, s95, 2
    s_lshl_b32 s95, s95, 5
    s_lshr_b32 s33, s2, 3
    s_add_u32 s95, s95, s33
    s_load_dwordx2 s[100:101], s[0:1], 120
    s_mov_b32 s98, 200000
    s_waitcnt lgkmcnt(0)
    s_lshr_b32 s62, s95, 1
    s_cmp_ge_u32 s95, 152
    s_cbranch_scc1 L_ismod_3050
    s_cmp_ge_u32 s95, 24
    s_cbranch_scc1 L_isln_3049
    s_load_dwordx2 s[26:27], s[0:1], 128
    v_lshrrev_b32 v1, 6, v0
    s_nop 0
    v_readfirstlane_b32 s28, v1
    s_waitcnt lgkmcnt(0)
    s_mov_b32 s4, s26
    s_and_b32 s5, s27, 0xffff
    s_mov_b32 s6, 268435456
    s_mov_b32 s7, 0x20000
    s_cmp_lg_u32 s95, 0
    s_cbranch_scc1 L_nolead_3053
    s_cmp_lg_u32 s28, 0
    s_cbranch_scc1 L_led_3054
    s_load_dwordx2 s[26:27], s[0:1], 128
    v_lshrrev_b32 v1, 6, v0
    s_nop 0
    v_readfirstlane_b32 s28, v1
    s_waitcnt lgkmcnt(0)
    s_mov_b32 s4, s26
    s_and_b32 s5, s27, 0xffff
    s_mov_b32 s6, 268435456
    s_mov_b32 s7, 0x20000
    v_mov_b32 v2, 0
    s_load_dwordx2 s[56:57], s[26:27], 128
    s_waitcnt lgkmcnt(0)
    s_and_b32 s56, s56, 0xffffff00
    s_add_u32 s56, s56, 256
    s_addc_u32 s57, s57, 0
    s_max_u32 s57, s57, 1
    v_mov_b32 v4, s56
    v_mov_b32 v5, s57
    global_store_dwordx2 v2, v[4:5], s[100:101] offset:128 sc1
    s_mov_b32 s35, 128
    buffer_store_dwordx2 v[4:5], v2, s[4:7], s35 offen sc1
    s_waitcnt vmcnt(0)
    v_mov_b32 v3, -1
    s_mov_b32 s40, -1
    s_mov_b32 s41, -1
    s_mov_b32 s35, 4200448
    s_memtime s[56:57]
    s_waitcnt lgkmcnt(0)
    buffer_store_dword v3, v2, s[4:7], s35 offen sc1
    s_waitcnt vmcnt(0)
    s_memtime s[58:59]
    s_waitcnt lgkmcnt(0)
    s_mov_b32 s35, 4208640
    s_memtime s[56:57]
    s_waitcnt lgkmcnt(0)
    buffer_store_dword v3, v2, s[4:7], s35 offen sc1
    s_waitcnt vmcnt(0)
    s_memtime s[58:59]
    s_waitcnt lgkmcnt(0)
    s_mov_b32 s35, 4200448
    s_memtime s[56:57]
    s_waitcnt lgkmcnt(0)
    buffer_store_dword v3, v2, s[4:7], s35 offen sc1
    s_waitcnt vmcnt(0)
    s_memtime s[58:59]
    s_waitcnt lgkmcnt(0)
    s_sub_u32 s33, s58, s56
    s_min_u32 s40, s40, s33
    s_mov_b32 s35, 4208640
    s_memtime s[56:57]
    s_waitcnt lgkmcnt(0)
    buffer_store_dword v3, v2, s[4:7], s35 offen sc1
    s_waitcnt vmcnt(0)
    s_memtime s[58:59]
    s_waitcnt lgkmcnt(0)
    s_sub_u32 s33, s58, s56
    s_min_u32 s41, s41, s33
    s_mov_b32 s35, 4200448
    s_memtime s[56:57]
    s_waitcnt lgkmcnt(0)
    buffer_store_dword v3, v2, s[4:7], s35 offen sc1
    s_waitcnt vmcnt(0)
    s_memtime s[58:59]
    s_waitcnt lgkmcnt(0)
    s_sub_u32 s33, s58, s56
    s_min_u32 s40, s40, s33
    s_mov_b32 s35, 4208640
    s_memtime s[56:57]
    s_waitcnt lgkmcnt(0)
    buffer_store_dword v3, v2, s[4:7], s35 offen sc1
    s_waitcnt vmcnt(0)
    s_memtime s[58:59]
    s_waitcnt lgkmcnt(0)
    s_sub_u32 s33, s58, s56
    s_min_u32 s41, s41, s33
    s_mov_b32 s35, 4200448
    s_memtime s[56:57]
    s_waitcnt lgkmcnt(0)
    buffer_store_dword v3, v2, s[4:7], s35 offen sc1
    s_waitcnt vmcnt(0)
    s_memtime s[58:59]
    s_waitcnt lgkmcnt(0)
    s_sub_u32 s33, s58, s56
    s_min_u32 s40, s40, s33
    s_mov_b32 s35, 4208640
    s_memtime s[56:57]
    s_waitcnt lgkmcnt(0)
    buffer_store_dword v3, v2, s[4:7], s35 offen sc1
    s_waitcnt vmcnt(0)
    s_memtime s[58:59]
    s_waitcnt lgkmcnt(0)
    s_sub_u32 s33, s58, s56
    s_min_u32 s41, s41, s33
    s_mov_b32 s35, 4200448
    s_memtime s[56:57]
    s_waitcnt lgkmcnt(0)
    buffer_store_dword v3, v2, s[4:7], s35 offen sc1
    s_waitcnt vmcnt(0)
    s_memtime s[58:59]
    s_waitcnt lgkmcnt(0)
    s_sub_u32 s33, s58, s56
    s_min_u32 s40, s40, s33
    s_mov_b32 s35, 4208640
    s_memtime s[56:57]
    s_waitcnt lgkmcnt(0)
    buffer_store_dword v3, v2, s[4:7], s35 offen sc1
    s_waitcnt vmcnt(0)
    s_memtime s[58:59]
    s_waitcnt lgkmcnt(0)
    s_sub_u32 s33, s58, s56
    s_min_u32 s41, s41, s33
    s_cmp_lt_u32 s41, s40
    s_cselect_b32 s33, 8192, 0
    s_or_b32 s33, s33, 1
    v_mov_b32 v3, s33
    global_store_dword v2, v3, s[100:101] offset:136 sc1
L_led_3054:
    s_barrier
L_nolead_3053:
    v_mov_b32 v254, 0
L_epoch_3055:
    global_load_dwordx2 v[252:253], v254, s[100:101] offset:128 sc1
    s_waitcnt vmcnt(0)
    v_cmp_eq_u32 vcc, 0, v253
    s_cbranch_vccz L_ok_3056
    s_sleep 2
    s_sub_u32 s98, s98, 1
    s_cbranch_scc0 L_epoch_3055
    s_mov_b32 s98, 0
L_ok_3056:
    v_readfirstlane_b32 s96, v252
    v_readfirstlane_b32 s97, v253
    s_branch L_req_3051
L_isln_3049:
    s_sub_u32 s29, s95, 24
    s_load_dwordx2 s[20:21], s[0:1], 0
    s_load_dwordx2 s[26:27], s[0:1], 128
    v_lshrrev_b32 v1, 6, v0
    s_nop 0
    v_readfirstlane_b32 s28, v1
    s_waitcnt lgkmcnt(0)
    s_mov_b32 s4, s26
    s_and_b32 s5, s27, 0xffff
    s_mov_b32 s6, 268435456
    s_mov_b32 s7, 0x20000
    s_mov_b32 s12, s20
    s_and_b32 s13, s21, 0xffff
    s_mov_b32 s14, 2621440
    s_mov_b32 s15, 0x20000
    v_and_b32 v1, 63, v0
    v_lshlrev_b32 v2, 4, v1
    v_lshlrev_b32 v3, 3, v1
    v_lshlrev_b32 v4, 2, v1
    v_lshrrev_b32 v7, 2, v1
    v_lshlrev_b32 v5, 7, v7
    v_bfe_u32 v7, v1, 0, 1
    v_lshl_add_u32 v5, v7, 6, v5
    v_bfe_u32 v7, v1, 1, 1
    v_lshl_add_u32 v5, v7, 3, v5
    v_lshrrev_b32 v7, 3, v1
    v_lshlrev_b32 v6, 7, v7
    v_bfe_u32 v7, v1, 1, 1
    v_lshl_add_u32 v6, v7, 6, v6
    v_bfe_u32 v7, v1, 2, 1
    v_lshl_add_u32 v6, v7, 3, v6
    v_and_b32 v7, 1, v1
    v_lshl_add_u32 v6, v7, 2, v6
    s_mov_b32 s48, 0x3acccccd
    s_mov_b32 s49, 0x3727c5ac
    s_lshl_b32 s33, s29, 2
    s_add_u32 s33, s33, s28
    s_lshl_b32 s33, s33, 2
    s_add_u32 s64, s33, 0
    s_mul_i32 s35, s64, 1280
    buffer_load_dwordx2 v[86:87], v3, s[12:15], s35 offen
    buffer_load_dwordx2 v[88:89], v3, s[12:15], s35 offen offset:512
    buffer_load_dword v90, v4, s[12:15], s35 offen offset:1024
    s_add_u32 s65, s33, 1
    s_mul_i32 s35, s65, 1280
    buffer_load_dwordx2 v[92:93], v3, s[12:15], s35 offen
    buffer_load_dwordx2 v[94:95], v3, s[12:15], s35 offen offset:512
    buffer_load_dword v96, v4, s[12:15], s35 offen offset:1024
    s_add_u32 s66, s33, 2
    s_mul_i32 s35, s66, 1280
    buffer_load_dwordx2 v[98:99], v3, s[12:15], s35 offen
    buffer_load_dwordx2 v[100:101], v3, s[12:15], s35 offen offset:512
    buffer_load_dword v102, v4, s[12:15], s35 offen offset:1024
    s_add_u32 s67, s33, 3
    s_mul_i32 s35, s67, 1280
    buffer_load_dwordx2 v[104:105], v3, s[12:15], s35 offen
    buffer_load_dwordx2 v[106:107], v3, s[12:15], s35 offen offset:512
    buffer_load_dword v108, v4, s[12:15], s35 offen offset:1024
    s_lshr_b32 s33, s62, 5
    s_lshl_b32 s33, s33, 3
    s_add_u32 s33, s33, 16
    s_load_dwordx2 s[22:23], s[0:1], s33
    v_bfe_u32 v249, v0, 4, 2
    v_lshlrev_b32 v248, 2, v249
    v_xor_b32 v248, v248, v0
    v_and_b32 v248, 15, v248
    v_lshlrev_b32 v248, 4, v248
    v_lshl_add_u32 v248, v249, 13, v248
    s_and_b32 s33, s62, 31
    s_lshl_b32 s33, s33, 8
    s_lshl_b32 s34, s28, 15
    s_add_u32 s58, s33, s34
    s_lshl_b32 s57, s28, 10
    s_waitcnt lgkmcnt(0)
    s_mov_b32 s8, s22
    s_and_b32 s9, s23, 0xffff
    s_mov_b32 s10, 5242880
    s_mov_b32 s11, 0x20000
    s_add_u32 m0, s57, 0
    s_nop 0
    buffer_load_dwordx4 v248, s[8:11], s58 offen lds
    s_add_u32 s58, s58, 131072
    s_add_u32 m0, s57, 4096
    s_nop 0
    buffer_load_dwordx4 v248, s[8:11], s58 offen lds
    s_add_u32 s58, s58, 131072
    s_add_u32 m0, s57, 8192
    s_nop 0
    buffer_load_dwordx4 v248, s[8:11], s58 offen lds
    s_add_u32 s58, s58, 131072
    s_add_u32 m0, s57, 12288
    s_nop 0
    buffer_load_dwordx4 v248, s[8:11], s58 offen lds
    s_add_u32 s58, s58, 131072
    s_add_u32 m0, s57, 16384
    s_nop 0
    buffer_load_dwordx4 v248, s[8:11], s58 offen lds
    s_add_u32 s58, s58, 131072
    s_add_u32 m0, s57, 20480
    s_nop 0
    buffer_load_dwordx4 v248, s[8:11], s58 offen lds
    s_add_u32 s58, s58, 131072
    s_add_u32 m0, s57, 24576
    s_nop 0
    buffer_load_dwordx4 v248, s[8:11], s58 offen lds
    s_add_u32 s58, s58, 131072
    s_add_u32 m0, s57, 28672
    s_nop 0
    buffer_load_dwordx4 v248, s[8:11], s58 offen lds
    s_add_u32 s58, s58, 131072
    s_add_u32 m0, s57, 32768
    s_nop 0
    buffer_load_dwordx4 v248, s[8:11], s58 offen lds
    s_add_u32 s58, s58, 131072
    s_add_u32 m0, s57, 36864
    s_nop 0
    buffer_load_dwordx4 v248, s[8:11], s58 offen lds
    s_add_u32 s58, s58, 131072
    s_add_u32 m0, s57, 40960
    s_nop 0
    buffer_load_dwordx4 v248, s[8:11], s58 offen lds
    s_add_u32 s58, s58, 131072
    s_add_u32 m0, s57, 45056
    s_nop 0
    buffer_load_dwordx4 v248, s[8:11], s58 offen lds
    s_add_u32 s58, s58, 131072
    s_add_u32 m0, s57, 49152
    s_nop 0
    buffer_load_dwordx4 v248, s[8:11], s58 offen lds
    s_add_u32 s58, s58, 131072
    s_add_u32 m0, s57, 53248
    s_nop 0
    buffer_load_dwordx4 v248, s[8:11], s58 offen lds
    s_add_u32 s58, s58, 131072
    s_add_u32 m0, s57, 57344
    s_nop 0
    buffer_load_dwordx4 v248, s[8:11], s58 offen lds
    s_add_u32 s58, s58, 131072
    s_add_u32 m0, s57, 61440
    s_nop 0
    buffer_load_dwordx4 v248, s[8:11], s58 offen lds
    s_add_u32 s58, s58, 131072
    s_add_u32 m0, s57, 65536
    s_nop 0
    buffer_load_dwordx4 v248, s[8:11], s58 offen lds
    s_add_u32 s58, s58, 131072
    s_add_u32 m0, s57, 69632
    s_nop 0
    buffer_load_dwordx4 v248, s[8:11], s58 offen lds
    s_add_u32 s58, s58, 131072
    s_add_u32 m0, s57, 73728
    s_nop 0
    buffer_load_dwordx4 v248, s[8:11], s58 offen lds
    s_add_u32 s58, s58, 131072
    s_add_u32 m0, s57, 77824
    s_nop 0
    buffer_load_dwordx4 v248, s[8:11], s58 offen lds
    s_add_u32 s58, s58, 131072
    s_add_u32 m0, s57, 81920
    s_nop 0
    buffer_load_dwordx4 v248, s[8:11], s58 offen lds
    s_add_u32 s58, s58, 131072
    s_add_u32 m0, s57, 86016
    s_nop 0
    buffer_load_dwordx4 v248, s[8:11], s58 offen lds
    s_add_u32 s58, s58, 131072
    s_add_u32 m0, s57, 90112
    s_nop 0
    buffer_load_dwordx4 v248, s[8:11], s58 offen lds
    s_add_u32 s58, s58, 131072
    s_add_u32 m0, s57, 94208
    s_nop 0
    buffer_load_dwordx4 v248, s[8:11], s58 offen lds
    s_add_u32 s58, s58, 131072
    s_add_u32 m0, s57, 98304
    s_nop 0
    buffer_load_dwordx4 v248, s[8:11], s58 offen lds
    s_add_u32 s58, s58, 131072
    s_add_u32 m0, s57, 102400
    s_nop 0
    buffer_load_dwordx4 v248, s[8:11], s58 offen lds
    s_add_u32 s58, s58, 131072
    s_add_u32 m0, s57, 106496
    s_nop 0
    buffer_load_dwordx4 v248, s[8:11], s58 offen lds
    s_add_u32 s58, s58, 131072
    s_add_u32 m0, s57, 110592
    s_nop 0
    buffer_load_dwordx4 v248, s[8:11], s58 offen lds
    s_add_u32 s58, s58, 131072
    s_add_u32 m0, s57, 114688
    s_nop 0
    buffer_load_dwordx4 v248, s[8:11], s58 offen lds
    s_add_u32 s58, s58, 131072
    s_add_u32 m0, s57, 118784
    s_nop 0
    buffer_load_dwordx4 v248, s[8:11], s58 offen lds
    s_add_u32 s58, s58, 131072
    s_add_u32 m0, s57, 122880
    s_nop 0
    buffer_load_dwordx4 v248, s[8:11], s58 offen lds
    s_add_u32 s58, s58, 131072
    s_add_u32 m0, s57, 126976
    s_nop 0
    buffer_load_dwordx4 v248, s[8:11], s58 offen lds
    s_add_u32 s58, s58, 131072
    s_add_u32 m0, s57, 131072
    s_nop 0
    buffer_load_dwordx4 v248, s[8:11], s58 offen lds
    s_add_u32 s58, s58, 131072
    s_add_u32 m0, s57, 135168
    s_nop 0
    buffer_load_dwordx4 v248, s[8:11], s58 offen lds
    s_add_u32 s58, s58, 131072
    s_add_u32 m0, s57, 139264
    s_nop 0
    buffer_load_dwordx4 v248, s[8:11], s58 offen lds
    s_add_u32 s58, s58, 131072
    s_add_u32 m0, s57, 143360
    s_nop 0
    buffer_load_dwordx4 v248, s[8:11], s58 offen lds
    s_add_u32 s58, s58, 131072
    s_add_u32 m0, s57, 147456
    s_nop 0
    buffer_load_dwordx4 v248, s[8:11], s58 offen lds
    s_add_u32 s58, s58, 131072
    s_add_u32 m0, s57, 151552
    s_nop 0
    buffer_load_dwordx4 v248, s[8:11], s58 offen lds
    s_add_u32 s58, s58, 131072
    s_add_u32 m0, s57, 155648
    s_nop 0
    buffer_load_dwordx4 v248, s[8:11], s58 offen lds
    s_add_u32 s58, s58, 131072
    s_add_u32 m0, s57, 159744
    s_nop 0
    buffer_load_dwordx4 v248, s[8:11], s58 offen lds
    s_add_u32 s58, s58, 131072
    s_waitcnt vmcnt(49)
    v_and_b32 v51, 0xffff0000, v86
    v_lshlrev_b32 v50, 16, v86
    v_and_b32 v53, 0xffff0000, v87
    v_lshlrev_b32 v52, 16, v87
    v_and_b32 v55, 0xffff0000, v88
    v_lshlrev_b32 v54, 16, v88
    v_and_b32 v57, 0xffff0000, v89
    v_lshlrev_b32 v56, 16, v89
    v_and_b32 v59, 0xffff0000, v90
    v_lshlrev_b32 v58, 16, v90
    v_add_f32 v7, v50, v51
    v_add_f32 v8, v52, v53
    v_add_f32 v7, v7, v54
    v_add_f32 v8, v8, v55
    v_add_f32 v7, v7, v56
    v_add_f32 v8, v8, v57
    v_add_f32 v7, v7, v58
    v_add_f32 v8, v8, v59
    v_add_f32 v7, v7, v8
    s_nop 1
    v_add_f32_dpp v7, v7, v7 row_ror:1 row_mask:0xf bank_mask:0xf
    s_nop 1
    v_add_f32_dpp v7, v7, v7 row_ror:2 row_mask:0xf bank_mask:0xf
    s_nop 1
    v_add_f32_dpp v7, v7, v7 row_ror:4 row_mask:0xf bank_mask:0xf
    s_nop 1
    v_add_f32_dpp v7, v7, v7 row_ror:8 row_mask:0xf bank_mask:0xf
    v_mov_b32 v9, v7
    s_nop 1
    v_permlane16_swap_b32 v7, v9
    v_add_f32 v7, v7, v9
    v_mov_b32 v9, v7
    s_nop 1
    v_permlane32_swap_b32 v7, v9
    v_add_f32 v7, v7, v9
    v_mul_f32 v7, s48, v7
    v_sub_f32 v10, v50, v7
    v_sub_f32 v11, v51, v7
    v_sub_f32 v12, v52, v7
    v_sub_f32 v13, v53, v7
    v_sub_f32 v14, v54, v7
    v_sub_f32 v15, v55, v7
    v_sub_f32 v16, v56, v7
    v_sub_f32 v17, v57, v7
    v_sub_f32 v18, v58, v7
    v_sub_f32 v19, v59, v7
    v_mul_f32 v8, v10, v10
    v_fmac_f32 v8, v11, v11
    v_fmac_f32 v8, v12, v12
    v_fmac_f32 v8, v13, v13
    v_fmac_f32 v8, v14, v14
    v_fmac_f32 v8, v15, v15
    v_fmac_f32 v8, v16, v16
    v_fmac_f32 v8, v17, v17
    v_fmac_f32 v8, v18, v18
    v_fmac_f32 v8, v19, v19
    v_cvt_pk_bf16_f32 v7, v7, v7
    v_lshlrev_b32 v7, 16, v7
    v_add_f32_dpp v8, v8, v8 row_ror:1 row_mask:0xf bank_mask:0xf
    s_nop 1
    v_add_f32_dpp v8, v8, v8 row_ror:2 row_mask:0xf bank_mask:0xf
    s_nop 1
    v_add_f32_dpp v8, v8, v8 row_ror:4 row_mask:0xf bank_mask:0xf
    s_nop 1
    v_add_f32_dpp v8, v8, v8 row_ror:8 row_mask:0xf bank_mask:0xf
    v_mov_b32 v9, v8
    s_nop 1
    v_permlane16_swap_b32 v8, v9
    v_add_f32 v8, v8, v9
    v_mov_b32 v9, v8
    s_nop 1
    v_permlane32_swap_b32 v8, v9
    v_add_f32 v8, v8, v9
    v_sub_f32 v10, v50, v7
    v_sub_f32 v11, v51, v7
    v_sub_f32 v12, v52, v7
    v_sub_f32 v13, v53, v7
    v_sub_f32 v14, v54, v7
    v_sub_f32 v15, v55, v7
    v_sub_f32 v16, v56, v7
    v_sub_f32 v17, v57, v7
    v_sub_f32 v18, v58, v7
    v_sub_f32 v19, v59, v7
    v_mul_f32 v8, s48, v8
    v_cvt_pk_bf16_f32 v8, v8, v8
    v_lshlrev_b32 v8, 16, v8
    v_add_f32 v8, s49, v8
    v_cvt_pk_bf16_f32 v8, v8, v8
    v_lshlrev_b32 v8, 16, v8
    v_sqrt_f32 v8, v8
    v_cvt_pk_bf16_f32 v60, v10, v11
    v_lshlrev_b32 v10, 16, v60
    v_and_b32 v11, 0xffff0000, v60
    v_cvt_pk_bf16_f32 v61, v12, v13
    v_lshlrev_b32 v12, 16, v61
    v_and_b32 v13, 0xffff0000, v61
    v_cvt_pk_bf16_f32 v62, v14, v15
    v_lshlrev_b32 v14, 16, v62
    v_and_b32 v15, 0xffff0000, v62
    v_cvt_pk_bf16_f32 v63, v16, v17
    v_lshlrev_b32 v16, 16, v63
    v_and_b32 v17, 0xffff0000, v63
    v_cvt_pk_bf16_f32 v64, v18, v19
    v_lshlrev_b32 v18, 16, v64
    v_and_b32 v19, 0xffff0000, v64
    v_cvt_pk_bf16_f32 v8, v8, v8
    v_lshlrev_b32 v8, 16, v8
    v_rcp_f32 v8, v8
    s_nop 0
    v_mul_f32 v10, v10, v8
    v_mul_f32 v11, v11, v8
    v_mul_f32 v12, v12, v8
    v_mul_f32 v13, v13, v8
    v_mul_f32 v14, v14, v8
    v_mul_f32 v15, v15, v8
    v_mul_f32 v16, v16, v8
    v_mul_f32 v17, v17, v8
    v_mul_f32 v18, v18, v8
    v_mul_f32 v19, v19, v8
    s_waitcnt vmcnt(46)
    v_and_b32 v51, 0xffff0000, v92
    v_lshlrev_b32 v50, 16, v92
    v_and_b32 v53, 0xffff0000, v93
    v_lshlrev_b32 v52, 16, v93
    v_and_b32 v55, 0xffff0000, v94
    v_lshlrev_b32 v54, 16, v94
    v_and_b32 v57, 0xffff0000, v95
    v_lshlrev_b32 v56, 16, v95
    v_and_b32 v59, 0xffff0000, v96
    v_lshlrev_b32 v58, 16, v96
    v_add_f32 v7, v50, v51
    v_add_f32 v8, v52, v53
    v_add_f32 v7, v7, v54
    v_add_f32 v8, v8, v55
    v_add_f32 v7, v7, v56
    v_add_f32 v8, v8, v57
    v_add_f32 v7, v7, v58
    v_add_f32 v8, v8, v59
    v_add_f32 v7, v7, v8
    s_nop 1
    v_add_f32_dpp v7, v7, v7 row_ror:1 row_mask:0xf bank_mask:0xf
    s_nop 1
    v_add_f32_dpp v7, v7, v7 row_ror:2 row_mask:0xf bank_mask:0xf
    s_nop 1
    v_add_f32_dpp v7, v7, v7 row_ror:4 row_mask:0xf bank_mask:0xf
    s_nop 1
    v_add_f32_dpp v7, v7, v7 row_ror:8 row_mask:0xf bank_mask:0xf
    v_mov_b32 v9, v7
    s_nop 1
    v_permlane16_swap_b32 v7, v9
    v_add_f32 v7, v7, v9
    v_mov_b32 v9, v7
    s_nop 1
    v_permlane32_swap_b32 v7, v9
    v_add_f32 v7, v7, v9
    v_mul_f32 v7, s48, v7
    v_sub_f32 v20, v50, v7
    v_sub_f32 v21, v51, v7
    v_sub_f32 v22, v52, v7
    v_sub_f32 v23, v53, v7
    v_sub_f32 v24, v54, v7
    v_sub_f32 v25, v55, v7
    v_sub_f32 v26, v56, v7
    v_sub_f32 v27, v57, v7
    v_sub_f32 v28, v58, v7
    v_sub_f32 v29, v59, v7
    v_mul_f32 v8, v20, v20
    v_fmac_f32 v8, v21, v21
    v_fmac_f32 v8, v22, v22
    v_fmac_f32 v8, v23, v23
    v_fmac_f32 v8, v24, v24
    v_fmac_f32 v8, v25, v25
    v_fmac_f32 v8, v26, v26
    v_fmac_f32 v8, v27, v27
    v_fmac_f32 v8, v28, v28
    v_fmac_f32 v8, v29, v29
    v_cvt_pk_bf16_f32 v7, v7, v7
    v_lshlrev_b32 v7, 16, v7
    v_add_f32_dpp v8, v8, v8 row_ror:1 row_mask:0xf bank_mask:0xf
    s_nop 1
    v_add_f32_dpp v8, v8, v8 row_ror:2 row_mask:0xf bank_mask:0xf
    s_nop 1
    v_add_f32_dpp v8, v8, v8 row_ror:4 row_mask:0xf bank_mask:0xf
    s_nop 1
    v_add_f32_dpp v8, v8, v8 row_ror:8 row_mask:0xf bank_mask:0xf
    v_mov_b32 v9, v8
    s_nop 1
    v_permlane16_swap_b32 v8, v9
    v_add_f32 v8, v8, v9
    v_mov_b32 v9, v8
    s_nop 1
    v_permlane32_swap_b32 v8, v9
    v_add_f32 v8, v8, v9
    v_sub_f32 v20, v50, v7
    v_sub_f32 v21, v51, v7
    v_sub_f32 v22, v52, v7
    v_sub_f32 v23, v53, v7
    v_sub_f32 v24, v54, v7
    v_sub_f32 v25, v55, v7
    v_sub_f32 v26, v56, v7
    v_sub_f32 v27, v57, v7
    v_sub_f32 v28, v58, v7
    v_sub_f32 v29, v59, v7
    v_mul_f32 v8, s48, v8
    v_cvt_pk_bf16_f32 v8, v8, v8
    v_lshlrev_b32 v8, 16, v8
    v_add_f32 v8, s49, v8
    v_cvt_pk_bf16_f32 v8, v8, v8
    v_lshlrev_b32 v8, 16, v8
    v_sqrt_f32 v8, v8
    v_cvt_pk_bf16_f32 v60, v20, v21
    v_lshlrev_b32 v20, 16, v60
    v_and_b32 v21, 0xffff0000, v60
    v_cvt_pk_bf16_f32 v61, v22, v23
    v_lshlrev_b32 v22, 16, v61
    v_and_b32 v23, 0xffff0000, v61
    v_cvt_pk_bf16_f32 v62, v24, v25
    v_lshlrev_b32 v24, 16, v62
    v_and_b32 v25, 0xffff0000, v62
    v_cvt_pk_bf16_f32 v63, v26, v27
    v_lshlrev_b32 v26, 16, v63
    v_and_b32 v27, 0xffff0000, v63
    v_cvt_pk_bf16_f32 v64, v28, v29
    v_lshlrev_b32 v28, 16, v64
    v_and_b32 v29, 0xffff0000, v64
    v_cvt_pk_bf16_f32 v8, v8, v8
    v_lshlrev_b32 v8, 16, v8
    v_rcp_f32 v8, v8
    s_nop 0
    v_mul_f32 v20, v20, v8
    v_mul_f32 v21, v21, v8
    v_mul_f32 v22, v22, v8
    v_mul_f32 v23, v23, v8
    v_mul_f32 v24, v24, v8
    v_mul_f32 v25, v25, v8
    v_mul_f32 v26, v26, v8
    v_mul_f32 v27, v27, v8
    v_mul_f32 v28, v28, v8
    v_mul_f32 v29, v29, v8
    s_waitcnt vmcnt(43)
    v_and_b32 v51, 0xffff0000, v98
    v_lshlrev_b32 v50, 16, v98
    v_and_b32 v53, 0xffff0000, v99
    v_lshlrev_b32 v52, 16, v99
    v_and_b32 v55, 0xffff0000, v100
    v_lshlrev_b32 v54, 16, v100
    v_and_b32 v57, 0xffff0000, v101
    v_lshlrev_b32 v56, 16, v101
    v_and_b32 v59, 0xffff0000, v102
    v_lshlrev_b32 v58, 16, v102
    v_add_f32 v7, v50, v51
    v_add_f32 v8, v52, v53
    v_add_f32 v7, v7, v54
    v_add_f32 v8, v8, v55
    v_add_f32 v7, v7, v56
    v_add_f32 v8, v8, v57
    v_add_f32 v7, v7, v58
    v_add_f32 v8, v8, v59
    v_add_f32 v7, v7, v8
    s_nop 1
    v_add_f32_dpp v7, v7, v7 row_ror:1 row_mask:0xf bank_mask:0xf
    s_nop 1
    v_add_f32_dpp v7, v7, v7 row_ror:2 row_mask:0xf bank_mask:0xf
    s_nop 1
    v_add_f32_dpp v7, v7, v7 row_ror:4 row_mask:0xf bank_mask:0xf
    s_nop 1
    v_add_f32_dpp v7, v7, v7 row_ror:8 row_mask:0xf bank_mask:0xf
    v_mov_b32 v9, v7
    s_nop 1
    v_permlane16_swap_b32 v7, v9
    v_add_f32 v7, v7, v9
    v_mov_b32 v9, v7
    s_nop 1
    v_permlane32_swap_b32 v7, v9
    v_add_f32 v7, v7, v9
    v_mul_f32 v7, s48, v7
    v_sub_f32 v30, v50, v7
    v_sub_f32 v31, v51, v7
    v_sub_f32 v32, v52, v7
    v_sub_f32 v33, v53, v7
    v_sub_f32 v34, v54, v7
    v_sub_f32 v35, v55, v7
    v_sub_f32 v36, v56, v7
    v_sub_f32 v37, v57, v7
    v_sub_f32 v38, v58, v7
    v_sub_f32 v39, v59, v7
    v_mul_f32 v8, v30, v30
    v_fmac_f32 v8, v31, v31
    v_fmac_f32 v8, v32, v32
    v_fmac_f32 v8, v33, v33
    v_fmac_f32 v8, v34, v34
    v_fmac_f32 v8, v35, v35
    v_fmac_f32 v8, v36, v36
    v_fmac_f32 v8, v37, v37
    v_fmac_f32 v8, v38, v38
    v_fmac_f32 v8, v39, v39
    v_cvt_pk_bf16_f32 v7, v7, v7
    v_lshlrev_b32 v7, 16, v7
    v_add_f32_dpp v8, v8, v8 row_ror:1 row_mask:0xf bank_mask:0xf
    s_nop 1
    v_add_f32_dpp v8, v8, v8 row_ror:2 row_mask:0xf bank_mask:0xf
    s_nop 1
    v_add_f32_dpp v8, v8, v8 row_ror:4 row_mask:0xf bank_mask:0xf
    s_nop 1
    v_add_f32_dpp v8, v8, v8 row_ror:8 row_mask:0xf bank_mask:0xf
    v_mov_b32 v9, v8
    s_nop 1
    v_permlane16_swap_b32 v8, v9
    v_add_f32 v8, v8, v9
    v_mov_b32 v9, v8
    s_nop 1
    v_permlane32_swap_b32 v8, v9
    v_add_f32 v8, v8, v9
    v_sub_f32 v30, v50, v7
    v_sub_f32 v31, v51, v7
    v_sub_f32 v32, v52, v7
    v_sub_f32 v33, v53, v7
    v_sub_f32 v34, v54, v7
    v_sub_f32 v35, v55, v7
    v_sub_f32 v36, v56, v7
    v_sub_f32 v37, v57, v7
    v_sub_f32 v38, v58, v7
    v_sub_f32 v39, v59, v7
    v_mul_f32 v8, s48, v8
    v_cvt_pk_bf16_f32 v8, v8, v8
    v_lshlrev_b32 v8, 16, v8
    v_add_f32 v8, s49, v8
    v_cvt_pk_bf16_f32 v8, v8, v8
    v_lshlrev_b32 v8, 16, v8
    v_sqrt_f32 v8, v8
    v_cvt_pk_bf16_f32 v60, v30, v31
    v_lshlrev_b32 v30, 16, v60
    v_and_b32 v31, 0xffff0000, v60
    v_cvt_pk_bf16_f32 v61, v32, v33
    v_lshlrev_b32 v32, 16, v61
    v_and_b32 v33, 0xffff0000, v61
    v_cvt_pk_bf16_f32 v62, v34, v35
    v_lshlrev_b32 v34, 16, v62
    v_and_b32 v35, 0xffff0000, v62
    v_cvt_pk_bf16_f32 v63, v36, v37
    v_lshlrev_b32 v36, 16, v63
    v_and_b32 v37, 0xffff0000, v63
    v_cvt_pk_bf16_f32 v64, v38, v39
    v_lshlrev_b32 v38, 16, v64
    v_and_b32 v39, 0xffff0000, v64
    v_cvt_pk_bf16_f32 v8, v8, v8
    v_lshlrev_b32 v8, 16, v8
    v_rcp_f32 v8, v8
    s_nop 0
    v_mul_f32 v30, v30, v8
    v_mul_f32 v31, v31, v8
    v_mul_f32 v32, v32, v8
    v_mul_f32 v33, v33, v8
    v_mul_f32 v34, v34, v8
    v_mul_f32 v35, v35, v8
    v_mul_f32 v36, v36, v8
    v_mul_f32 v37, v37, v8
    v_mul_f32 v38, v38, v8
    v_mul_f32 v39, v39, v8
    s_waitcnt vmcnt(40)
    v_and_b32 v51, 0xffff0000, v104
    v_lshlrev_b32 v50, 16, v104
    v_and_b32 v53, 0xffff0000, v105
    v_lshlrev_b32 v52, 16, v105
    v_and_b32 v55, 0xffff0000, v106
    v_lshlrev_b32 v54, 16, v106
    v_and_b32 v57, 0xffff0000, v107
    v_lshlrev_b32 v56, 16, v107
    v_and_b32 v59, 0xffff0000, v108
    v_lshlrev_b32 v58, 16, v108
    v_add_f32 v7, v50, v51
    v_add_f32 v8, v52, v53
    v_add_f32 v7, v7, v54
    v_add_f32 v8, v8, v55
    v_add_f32 v7, v7, v56
    v_add_f32 v8, v8, v57
    v_add_f32 v7, v7, v58
    v_add_f32 v8, v8, v59
    v_add_f32 v7, v7, v8
    s_nop 1
    v_add_f32_dpp v7, v7, v7 row_ror:1 row_mask:0xf bank_mask:0xf
    s_nop 1
    v_add_f32_dpp v7, v7, v7 row_ror:2 row_mask:0xf bank_mask:0xf
    s_nop 1
    v_add_f32_dpp v7, v7, v7 row_ror:4 row_mask:0xf bank_mask:0xf
    s_nop 1
    v_add_f32_dpp v7, v7, v7 row_ror:8 row_mask:0xf bank_mask:0xf
    v_mov_b32 v9, v7
    s_nop 1
    v_permlane16_swap_b32 v7, v9
    v_add_f32 v7, v7, v9
    v_mov_b32 v9, v7
    s_nop 1
    v_permlane32_swap_b32 v7, v9
    v_add_f32 v7, v7, v9
    v_mul_f32 v7, s48, v7
    v_sub_f32 v40, v50, v7
    v_sub_f32 v41, v51, v7
    v_sub_f32 v42, v52, v7
    v_sub_f32 v43, v53, v7
    v_sub_f32 v44, v54, v7
    v_sub_f32 v45, v55, v7
    v_sub_f32 v46, v56, v7
    v_sub_f32 v47, v57, v7
    v_sub_f32 v48, v58, v7
    v_sub_f32 v49, v59, v7
    v_mul_f32 v8, v40, v40
    v_fmac_f32 v8, v41, v41
    v_fmac_f32 v8, v42, v42
    v_fmac_f32 v8, v43, v43
    v_fmac_f32 v8, v44, v44
    v_fmac_f32 v8, v45, v45
    v_fmac_f32 v8, v46, v46
    v_fmac_f32 v8, v47, v47
    v_fmac_f32 v8, v48, v48
    v_fmac_f32 v8, v49, v49
    v_cvt_pk_bf16_f32 v7, v7, v7
    v_lshlrev_b32 v7, 16, v7
    v_add_f32_dpp v8, v8, v8 row_ror:1 row_mask:0xf bank_mask:0xf
    s_nop 1
    v_add_f32_dpp v8, v8, v8 row_ror:2 row_mask:0xf bank_mask:0xf
    s_nop 1
    v_add_f32_dpp v8, v8, v8 row_ror:4 row_mask:0xf bank_mask:0xf
    s_nop 1
    v_add_f32_dpp v8, v8, v8 row_ror:8 row_mask:0xf bank_mask:0xf
    v_mov_b32 v9, v8
    s_nop 1
    v_permlane16_swap_b32 v8, v9
    v_add_f32 v8, v8, v9
    v_mov_b32 v9, v8
    s_nop 1
    v_permlane32_swap_b32 v8, v9
    v_add_f32 v8, v8, v9
    v_sub_f32 v40, v50, v7
    v_sub_f32 v41, v51, v7
    v_sub_f32 v42, v52, v7
    v_sub_f32 v43, v53, v7
    v_sub_f32 v44, v54, v7
    v_sub_f32 v45, v55, v7
    v_sub_f32 v46, v56, v7
    v_sub_f32 v47, v57, v7
    v_sub_f32 v48, v58, v7
    v_sub_f32 v49, v59, v7
    v_mul_f32 v8, s48, v8
    v_cvt_pk_bf16_f32 v8, v8, v8
    v_lshlrev_b32 v8, 16, v8
    v_add_f32 v8, s49, v8
    v_cvt_pk_bf16_f32 v8, v8, v8
    v_lshlrev_b32 v8, 16, v8
    v_sqrt_f32 v8, v8
    v_cvt_pk_bf16_f32 v60, v40, v41
    v_lshlrev_b32 v40, 16, v60
    v_and_b32 v41, 0xffff0000, v60
    v_cvt_pk_bf16_f32 v61, v42, v43
    v_lshlrev_b32 v42, 16, v61
    v_and_b32 v43, 0xffff0000, v61
    v_cvt_pk_bf16_f32 v62, v44, v45
    v_lshlrev_b32 v44, 16, v62
    v_and_b32 v45, 0xffff0000, v62
    v_cvt_pk_bf16_f32 v63, v46, v47
    v_lshlrev_b32 v46, 16, v63
    v_and_b32 v47, 0xffff0000, v63
    v_cvt_pk_bf16_f32 v64, v48, v49
    v_lshlrev_b32 v48, 16, v64
    v_and_b32 v49, 0xffff0000, v64
    v_cvt_pk_bf16_f32 v8, v8, v8
    v_lshlrev_b32 v8, 16, v8
    v_rcp_f32 v8, v8
    s_nop 0
    v_mul_f32 v40, v40, v8
    v_mul_f32 v41, v41, v8
    v_mul_f32 v42, v42, v8
    v_mul_f32 v43, v43, v8
    v_mul_f32 v44, v44, v8
    v_mul_f32 v45, v45, v8
    v_mul_f32 v46, v46, v8
    v_mul_f32 v47, v47, v8
    v_mul_f32 v48, v48, v8
    v_mul_f32 v49, v49, v8
    v_bfe_u32 v248, v0, 2, 2
    v_xor_b32 v249, s28, v248
    v_lshlrev_b32 v249, 6, v249
    v_lshl_add_u32 v249, v248, 8, v249
    v_bfe_u32 v248, v0, 5, 1
    v_lshl_add_u32 v249, v248, 10, v249
    v_bfe_u32 v248, v0, 4, 1
    v_lshl_add_u32 v249, v248, 5, v249
    v_and_b32 v248, 3, v0
    v_lshl_add_u32 v249, v248, 3, v249
    s_waitcnt vmcnt(30)
    s_barrier
    ds_read_b64_tr_b16 a[0:1], v249 offset:0
    ds_read_b64_tr_b16 a[2:3], v249 offset:2048
    ds_read_b64_tr_b16 a[4:5], v249 offset:4096
    ds_read_b64_tr_b16 a[6:7], v249 offset:6144
    ds_read_b64_tr_b16 a[8:9], v249 offset:8192
    ds_read_b64_tr_b16 a[10:11], v249 offset:10240
    ds_read_b64_tr_b16 a[12:13], v249 offset:12288
    ds_read_b64_tr_b16 a[14:15], v249 offset:14336
    ds_read_b64_tr_b16 a[16:17], v249 offset:16384
    ds_read_b64_tr_b16 a[18:19], v249 offset:18432
    ds_read_b64_tr_b16 a[20:21], v249 offset:20480
    ds_read_b64_tr_b16 a[22:23], v249 offset:22528
    ds_read_b64_tr_b16 a[24:25], v249 offset:24576
    ds_read_b64_tr_b16 a[26:27], v249 offset:26624
    ds_read_b64_tr_b16 a[28:29], v249 offset:28672
    ds_read_b64_tr_b16 a[30:31], v249 offset:30720
    ds_read_b64_tr_b16 a[32:33], v249 offset:32768
    ds_read_b64_tr_b16 a[34:35], v249 offset:34816
    ds_read_b64_tr_b16 a[36:37], v249 offset:36864
    ds_read_b64_tr_b16 a[38:39], v249 offset:38912
    v_add_u32 v249, 40960, v249
    s_waitcnt vmcnt(20)
    s_barrier
    ds_read_b64_tr_b16 a[40:41], v249 offset:0
    ds_read_b64_tr_b16 a[42:43], v249 offset:2048
    ds_read_b64_tr_b16 a[44:45], v249 offset:4096
    ds_read_b64_tr_b16 a[46:47], v249 offset:6144
    ds_read_b64_tr_b16 a[48:49], v249 offset:8192
    ds_read_b64_tr_b16 a[50:51], v249 offset:10240
    ds_read_b64_tr_b16 a[52:53], v249 offset:12288
    ds_read_b64_tr_b16 a[54:55], v249 offset:14336
    ds_read_b64_tr_b16 a[56:57], v249 offset:16384
    ds_read_b64_tr_b16 a[58:59], v249 offset:18432
    ds_read_b64_tr_b16 a[60:61], v249 offset:20480
    ds_read_b64_tr_b16 a[62:63], v249 offset:22528
    ds_read_b64_tr_b16 a[64:65], v249 offset:24576
    ds_read_b64_tr_b16 a[66:67], v249 offset:26624
    ds_read_b64_tr_b16 a[68:69], v249 offset:28672
    ds_read_b64_tr_b16 a[70:71], v249 offset:30720
    ds_read_b64_tr_b16 a[72:73], v249 offset:32768
    ds_read_b64_tr_b16 a[74:75], v249 offset:34816
    ds_read_b64_tr_b16 a[76:77], v249 offset:36864
    ds_read_b64_tr_b16 a[78:79], v249 offset:38912
    v_add_u32 v249, 40960, v249
    s_waitcnt vmcnt(10)
    s_barrier
    ds_read_b64_tr_b16 a[80:81], v249 offset:0
    ds_read_b64_tr_b16 a[82:83], v249 offset:2048
    ds_read_b64_tr_b16 a[84:85], v249 offset:4096
    ds_read_b64_tr_b16 a[86:87], v249 offset:6144
    ds_read_b64_tr_b16 a[88:89], v249 offset:8192
    ds_read_b64_tr_b16 a[90:91], v249 offset:10240
    ds_read_b64_tr_b16 a[92:93], v249 offset:12288
    ds_read_b64_tr_b16 a[94:95], v249 offset:14336
    ds_read_b64_tr_b16 a[96:97], v249 offset:16384
    ds_read_b64_tr_b16 a[98:99], v249 offset:18432
    ds_read_b64_tr_b16 a[100:101], v249 offset:20480
    ds_read_b64_tr_b16 a[102:103], v249 offset:22528
    ds_read_b64_tr_b16 a[104:105], v249 offset:24576
    ds_read_b64_tr_b16 a[106:107], v249 offset:26624
    ds_read_b64_tr_b16 a[108:109], v249 offset:28672
    ds_read_b64_tr_b16 a[110:111], v249 offset:30720
    ds_read_b64_tr_b16 a[112:113], v249 offset:32768
    ds_read_b64_tr_b16 a[114:115], v249 offset:34816
    ds_read_b64_tr_b16 a[116:117], v249 offset:36864
    ds_read_b64_tr_b16 a[118:119], v249 offset:38912
    v_add_u32 v249, 40960, v249
    s_waitcnt vmcnt(0)
    s_barrier
    ds_read_b64_tr_b16 a[120:121], v249 offset:0
    ds_read_b64_tr_b16 a[122:123], v249 offset:2048
    ds_read_b64_tr_b16 a[124:125], v249 offset:4096
    ds_read_b64_tr_b16 a[126:127], v249 offset:6144
    ds_read_b64_tr_b16 a[128:129], v249 offset:8192
    ds_read_b64_tr_b16 a[130:131], v249 offset:10240
    ds_read_b64_tr_b16 a[132:133], v249 offset:12288
    ds_read_b64_tr_b16 a[134:135], v249 offset:14336
    ds_read_b64_tr_b16 a[136:137], v249 offset:16384
    ds_read_b64_tr_b16 a[138:139], v249 offset:18432
    ds_read_b64_tr_b16 a[140:141], v249 offset:20480
    ds_read_b64_tr_b16 a[142:143], v249 offset:22528
    ds_read_b64_tr_b16 a[144:145], v249 offset:24576
    ds_read_b64_tr_b16 a[146:147], v249 offset:26624
    ds_read_b64_tr_b16 a[148:149], v249 offset:28672
    ds_read_b64_tr_b16 a[150:151], v249 offset:30720
    ds_read_b64_tr_b16 a[152:153], v249 offset:32768
    ds_read_b64_tr_b16 a[154:155], v249 offset:34816
    ds_read_b64_tr_b16 a[156:157], v249 offset:36864
    ds_read_b64_tr_b16 a[158:159], v249 offset:38912
    s_waitcnt lgkmcnt(0)
    s_barrier
    v_mov_b32 v254, 0
L_epoch_3057:
    global_load_dwordx2 v[252:253], v254, s[100:101] offset:128 sc1
    s_waitcnt vmcnt(0)
    v_cmp_eq_u32 vcc, 0, v253
    s_cbranch_vccz L_ok_3058
    s_sleep 2
    s_sub_u32 s98, s98, 1
    s_cbranch_scc0 L_epoch_3057
    s_mov_b32 s98, 0
L_ok_3058:
    v_readfirstlane_b32 s96, v252
    v_readfirstlane_b32 s97, v253
    s_mov_b32 s35, 4096
    s_cmp_lg_u32 s28, 0
    s_cbranch_scc1 L_wf_3059
    v_and_b32 v254, 63, v0
    v_min_u32 v254, 39, v254
    v_lshlrev_b32 v254, 3, v254
L_poll_3060:
    buffer_load_dwordx2 v[252:253], v254, s[4:7], s35 offen sc1
    s_waitcnt vmcnt(0)
    v_subrev_u32 v252, s96, v252
    v_xor_b32 v253, s97, v253
    v_lshrrev_b32 v255, 8, v252
    v_or_b32 v253, v253, v255
    v_cmp_eq_u32 vcc, 0, v253
    s_nop 1
    v_cndmask_b32 v252, 0, v252, vcc
    v_cmp_gt_u32 vcc, 1, v252
    s_cbranch_vccz L_ok_3061
    s_sleep 2
    s_sub_u32 s98, s98, 1
    s_cbranch_scc0 L_poll_3060
    s_mov_b32 s98, 0
L_ok_3061:
L_wf_3059:
    s_barrier
    s_mov_b32 s33, 131072
    buffer_load_dwordx4 v[76:79], v2, s[4:7], s33 offen sc1
    buffer_load_dwordx4 v[80:83], v2, s[4:7], s33 offen offset:1024 sc1
    buffer_load_dwordx2 v[84:85], v3, s[4:7], s33 offen offset:2048 sc1
    s_mov_b32 s33, 133632
    buffer_load_dwordx4 v[66:69], v2, s[4:7], s33 offen sc1
    buffer_load_dwordx4 v[70:73], v2, s[4:7], s33 offen offset:1024 sc1
    buffer_load_dwordx2 v[74:75], v3, s[4:7], s33 offen offset:2048 sc1
    s_waitcnt vmcnt(0)
    v_add_f32 v66, 1.0, v66
    v_add_f32 v67, 1.0, v67
    v_add_f32 v68, 1.0, v68
    v_add_f32 v69, 1.0, v69
    v_add_f32 v70, 1.0, v70
    v_add_f32 v71, 1.0, v71
    v_add_f32 v72, 1.0, v72
    v_add_f32 v73, 1.0, v73
    v_add_f32 v74, 1.0, v74
    v_add_f32 v75, 1.0, v75
    v_cvt_pk_bf16_f32 v60, v66, v67
    v_lshlrev_b32 v66, 16, v60
    v_and_b32 v67, 0xffff0000, v60
    v_cvt_pk_bf16_f32 v61, v68, v69
    v_lshlrev_b32 v68, 16, v61
    v_and_b32 v69, 0xffff0000, v61
    v_cvt_pk_bf16_f32 v62, v70, v71
    v_lshlrev_b32 v70, 16, v62
    v_and_b32 v71, 0xffff0000, v62
    v_cvt_pk_bf16_f32 v63, v72, v73
    v_lshlrev_b32 v72, 16, v63
    v_and_b32 v73, 0xffff0000, v63
    v_cvt_pk_bf16_f32 v64, v74, v75
    v_lshlrev_b32 v74, 16, v64
    v_and_b32 v75, 0xffff0000, v64
    s_mul_i32 s33, s28, 5120
    v_add_u32 v5, s33, v5
    v_add_u32 v6, s33, v6
    v_add_u32 v1, s33, v2
    v_cvt_pk_bf16_f32 v86, v10, v11
    v_lshlrev_b32 v10, 16, v86
    v_and_b32 v11, 0xffff0000, v86
    v_cvt_pk_bf16_f32 v87, v12, v13
    v_lshlrev_b32 v12, 16, v87
    v_and_b32 v13, 0xffff0000, v87
    v_cvt_pk_bf16_f32 v88, v14, v15
    v_lshlrev_b32 v14, 16, v88
    v_and_b32 v15, 0xffff0000, v88
    v_cvt_pk_bf16_f32 v89, v16, v17
    v_lshlrev_b32 v16, 16, v89
    v_and_b32 v17, 0xffff0000, v89
    v_cvt_pk_bf16_f32 v90, v18, v19
    v_lshlrev_b32 v18, 16, v90
    v_and_b32 v19, 0xffff0000, v90
    v_mul_f32 v10, v10, v66
    v_mul_f32 v11, v11, v67
    v_mul_f32 v12, v12, v68
    v_mul_f32 v13, v13, v69
    v_mul_f32 v14, v14, v70
    v_mul_f32 v15, v15, v71
    v_mul_f32 v16, v16, v72
    v_mul_f32 v17, v17, v73
    v_mul_f32 v18, v18, v74
    v_mul_f32 v19, v19, v75
    v_cvt_pk_bf16_f32 v86, v10, v11
    v_lshlrev_b32 v10, 16, v86
    v_and_b32 v11, 0xffff0000, v86
    v_cvt_pk_bf16_f32 v87, v12, v13
    v_lshlrev_b32 v12, 16, v87
    v_and_b32 v13, 0xffff0000, v87
    v_cvt_pk_bf16_f32 v88, v14, v15
    v_lshlrev_b32 v14, 16, v88
    v_and_b32 v15, 0xffff0000, v88
    v_cvt_pk_bf16_f32 v89, v16, v17
    v_lshlrev_b32 v16, 16, v89
    v_and_b32 v17, 0xffff0000, v89
    v_cvt_pk_bf16_f32 v90, v18, v19
    v_lshlrev_b32 v18, 16, v90
    v_and_b32 v19, 0xffff0000, v90
    v_add_f32 v10, v10, v76
    v_add_f32 v11, v11, v77
    v_add_f32 v12, v12, v78
    v_add_f32 v13, v13, v79
    v_add_f32 v14, v14, v80
    v_add_f32 v15, v15, v81
    v_add_f32 v16, v16, v82
    v_add_f32 v17, v17, v83
    v_add_f32 v18, v18, v84
    v_add_f32 v19, v19, v85
    v_cvt_pk_bf16_f32 v86, v10, v11
    v_cvt_pk_bf16_f32 v87, v12, v13
    v_cvt_pk_bf16_f32 v88, v14, v15
    v_cvt_pk_bf16_f32 v89, v16, v17
    v_cvt_pk_bf16_f32 v90, v18, v19
    ds_write_b64 v5, v[86:87] offset:0
    ds_write_b64 v5, v[88:89] offset:2048
    ds_write_b32 v6, v90 offset:4096
    v_cvt_pk_bf16_f32 v92, v20, v21
    v_lshlrev_b32 v20, 16, v92
    v_and_b32 v21, 0xffff0000, v92
    v_cvt_pk_bf16_f32 v93, v22, v23
    v_lshlrev_b32 v22, 16, v93
    v_and_b32 v23, 0xffff0000, v93
    v_cvt_pk_bf16_f32 v94, v24, v25
    v_lshlrev_b32 v24, 16, v94
    v_and_b32 v25, 0xffff0000, v94
    v_cvt_pk_bf16_f32 v95, v26, v27
    v_lshlrev_b32 v26, 16, v95
    v_and_b32 v27, 0xffff0000, v95
    v_cvt_pk_bf16_f32 v96, v28, v29
    v_lshlrev_b32 v28, 16, v96
    v_and_b32 v29, 0xffff0000, v96
    v_mul_f32 v20, v20, v66
    v_mul_f32 v21, v21, v67
    v_mul_f32 v22, v22, v68
    v_mul_f32 v23, v23, v69
    v_mul_f32 v24, v24, v70
    v_mul_f32 v25, v25, v71
    v_mul_f32 v26, v26, v72
    v_mul_f32 v27, v27, v73
    v_mul_f32 v28, v28, v74
    v_mul_f32 v29, v29, v75
    v_cvt_pk_bf16_f32 v92, v20, v21
    v_lshlrev_b32 v20, 16, v92
    v_and_b32 v21, 0xffff0000, v92
    v_cvt_pk_bf16_f32 v93, v22, v23
    v_lshlrev_b32 v22, 16, v93
    v_and_b32 v23, 0xffff0000, v93
    v_cvt_pk_bf16_f32 v94, v24, v25
    v_lshlrev_b32 v24, 16, v94
    v_and_b32 v25, 0xffff0000, v94
    v_cvt_pk_bf16_f32 v95, v26, v27
    v_lshlrev_b32 v26, 16, v95
    v_and_b32 v27, 0xffff0000, v95
    v_cvt_pk_bf16_f32 v96, v28, v29
    v_lshlrev_b32 v28, 16, v96
    v_and_b32 v29, 0xffff0000, v96
    v_add_f32 v20, v20, v76
    v_add_f32 v21, v21, v77
    v_add_f32 v22, v22, v78
    v_add_f32 v23, v23, v79
    v_add_f32 v24, v24, v80
    v_add_f32 v25, v25, v81
    v_add_f32 v26, v26, v82
    v_add_f32 v27, v27, v83
    v_add_f32 v28, v28, v84
    v_add_f32 v29, v29, v85
    v_cvt_pk_bf16_f32 v92, v20, v21
    v_cvt_pk_bf16_f32 v93, v22, v23
    v_cvt_pk_bf16_f32 v94, v24, v25
    v_cvt_pk_bf16_f32 v95, v26, v27
    v_cvt_pk_bf16_f32 v96, v28, v29
    ds_write_b64 v5, v[92:93] offset:16
    ds_write_b64 v5, v[94:95] offset:2064
    ds_write_b32 v6, v96 offset:4112
    v_cvt_pk_bf16_f32 v98, v30, v31
    v_lshlrev_b32 v30, 16, v98
    v_and_b32 v31, 0xffff0000, v98
    v_cvt_pk_bf16_f32 v99, v32, v33
    v_lshlrev_b32 v32, 16, v99
    v_and_b32 v33, 0xffff0000, v99
    v_cvt_pk_bf16_f32 v100, v34, v35
    v_lshlrev_b32 v34, 16, v100
    v_and_b32 v35, 0xffff0000, v100
    v_cvt_pk_bf16_f32 v101, v36, v37
    v_lshlrev_b32 v36, 16, v101
    v_and_b32 v37, 0xffff0000, v101
    v_cvt_pk_bf16_f32 v102, v38, v39
    v_lshlrev_b32 v38, 16, v102
    v_and_b32 v39, 0xffff0000, v102
    v_mul_f32 v30, v30, v66
    v_mul_f32 v31, v31, v67
    v_mul_f32 v32, v32, v68
    v_mul_f32 v33, v33, v69
    v_mul_f32 v34, v34, v70
    v_mul_f32 v35, v35, v71
    v_mul_f32 v36, v36, v72
    v_mul_f32 v37, v37, v73
    v_mul_f32 v38, v38, v74
    v_mul_f32 v39, v39, v75
    v_cvt_pk_bf16_f32 v98, v30, v31
    v_lshlrev_b32 v30, 16, v98
    v_and_b32 v31, 0xffff0000, v98
    v_cvt_pk_bf16_f32 v99, v32, v33
    v_lshlrev_b32 v32, 16, v99
    v_and_b32 v33, 0xffff0000, v99
    v_cvt_pk_bf16_f32 v100, v34, v35
    v_lshlrev_b32 v34, 16, v100
    v_and_b32 v35, 0xffff0000, v100
    v_cvt_pk_bf16_f32 v101, v36, v37
    v_lshlrev_b32 v36, 16, v101
    v_and_b32 v37, 0xffff0000, v101
    v_cvt_pk_bf16_f32 v102, v38, v39
    v_lshlrev_b32 v38, 16, v102
    v_and_b32 v39, 0xffff0000, v102
    v_add_f32 v30, v30, v76
    v_add_f32 v31, v31, v77
    v_add_f32 v32, v32, v78
    v_add_f32 v33, v33, v79
    v_add_f32 v34, v34, v80
    v_add_f32 v35, v35, v81
    v_add_f32 v36, v36, v82
    v_add_f32 v37, v37, v83
    v_add_f32 v38, v38, v84
    v_add_f32 v39, v39, v85
    v_cvt_pk_bf16_f32 v98, v30, v31
    v_cvt_pk_bf16_f32 v99, v32, v33
    v_cvt_pk_bf16_f32 v100, v34, v35
    v_cvt_pk_bf16_f32 v101, v36, v37
    v_cvt_pk_bf16_f32 v102, v38, v39
    ds_write_b64 v5, v[98:99] offset:32
    ds_write_b64 v5, v[100:101] offset:2080
    ds_write_b32 v6, v102 offset:4128
    v_cvt_pk_bf16_f32 v104, v40, v41
    v_lshlrev_b32 v40, 16, v104
    v_and_b32 v41, 0xffff0000, v104
    v_cvt_pk_bf16_f32 v105, v42, v43
    v_lshlrev_b32 v42, 16, v105
    v_and_b32 v43, 0xffff0000, v105
    v_cvt_pk_bf16_f32 v106, v44, v45
    v_lshlrev_b32 v44, 16, v106
    v_and_b32 v45, 0xffff0000, v106
    v_cvt_pk_bf16_f32 v107, v46, v47
    v_lshlrev_b32 v46, 16, v107
    v_and_b32 v47, 0xffff0000, v107
    v_cvt_pk_bf16_f32 v108, v48, v49
    v_lshlrev_b32 v48, 16, v108
    v_and_b32 v49, 0xffff0000, v108
    v_mul_f32 v40, v40, v66
    v_mul_f32 v41, v41, v67
    v_mul_f32 v42, v42, v68
    v_mul_f32 v43, v43, v69
    v_mul_f32 v44, v44, v70
    v_mul_f32 v45, v45, v71
    v_mul_f32 v46, v46, v72
    v_mul_f32 v47, v47, v73
    v_mul_f32 v48, v48, v74
    v_mul_f32 v49, v49, v75
    v_cvt_pk_bf16_f32 v104, v40, v41
    v_lshlrev_b32 v40, 16, v104
    v_and_b32 v41, 0xffff0000, v104
    v_cvt_pk_bf16_f32 v105, v42, v43
    v_lshlrev_b32 v42, 16, v105
    v_and_b32 v43, 0xffff0000, v105
    v_cvt_pk_bf16_f32 v106, v44, v45
    v_lshlrev_b32 v44, 16, v106
    v_and_b32 v45, 0xffff0000, v106
    v_cvt_pk_bf16_f32 v107, v46, v47
    v_lshlrev_b32 v46, 16, v107
    v_and_b32 v47, 0xffff0000, v107
    v_cvt_pk_bf16_f32 v108, v48, v49
    v_lshlrev_b32 v48, 16, v108
    v_and_b32 v49, 0xffff0000, v108
    v_add_f32 v40, v40, v76
    v_add_f32 v41, v41, v77
    v_add_f32 v42, v42, v78
    v_add_f32 v43, v43, v79
    v_add_f32 v44, v44, v80
    v_add_f32 v45, v45, v81
    v_add_f32 v46, v46, v82
    v_add_f32 v47, v47, v83
    v_add_f32 v48, v48, v84
    v_add_f32 v49, v49, v85
    v_cvt_pk_bf16_f32 v104, v40, v41
    v_cvt_pk_bf16_f32 v105, v42, v43
    v_cvt_pk_bf16_f32 v106, v44, v45
    v_cvt_pk_bf16_f32 v107, v46, v47
    v_cvt_pk_bf16_f32 v108, v48, v49
    ds_write_b64 v5, v[104:105] offset:48
    ds_write_b64 v5, v[106:107] offset:2096
    ds_write_b32 v6, v108 offset:4144
    s_waitcnt lgkmcnt(0)
    ds_read_b128 v[12:15], v1 offset:0
    ds_read_b128 v[16:19], v1 offset:1024
    ds_read_b128 v[20:23], v1 offset:2048
    ds_read_b128 v[24:27], v1 offset:3072
    ds_read_b128 v[28:31], v1 offset:4096
    s_mul_i32 s33, s64, 1280
    s_add_u32 s33, s33, 8388608
    s_add_u32 s34, s33, 4096
    s_waitcnt lgkmcnt(4)
    buffer_store_dwordx4 v[12:15], v2, s[4:7], s33 offen offset:0 sc1
    s_waitcnt lgkmcnt(3)
    buffer_store_dwordx4 v[16:19], v2, s[4:7], s33 offen offset:1024 sc1
    s_waitcnt lgkmcnt(2)
    buffer_store_dwordx4 v[20:23], v2, s[4:7], s33 offen offset:2048 sc1
    s_waitcnt lgkmcnt(1)
    buffer_store_dwordx4 v[24:27], v2, s[4:7], s33 offen offset:3072 sc1
    s_waitcnt lgkmcnt(0)
    buffer_store_dwordx4 v[28:31], v2, s[4:7], s34 offen offset:0 sc1
    s_lshl_b32 s99, s29, 3
    s_add_u32 s99, s99, 6144
    s_waitcnt vmcnt(0)
    s_barrier
    s_cmp_lg_u32 s28, 0
    s_cbranch_scc1 L_sig_3062
    s_add_u32 s33, s96, 1
    v_mov_b32 v252, s33
    v_mov_b32 v253, s97
    s_mov_b64 exec, 1
    buffer_store_dwordx2 v[252:253], off, s[4:7], s99 sc1
    s_mov_b64 exec, -1
L_sig_3062:
    s_branch L_proj_3052
L_ismod_3050:
    s_sub_u32 s29, s95, 152
    s_load_dwordx2 s[20:21], s[0:1], 96
    s_load_dwordx2 s[22:23], s[0:1], 104
    s_load_dwordx2 s[26:27], s[0:1], 128
    v_lshrrev_b32 v1, 6, v0
    s_nop 0
    v_readfirstlane_b32 s28, v1
    s_waitcnt lgkmcnt(0)
    s_mov_b32 s4, s26
    s_and_b32 s5, s27, 0xffff
    s_mov_b32 s6, 268435456
    s_mov_b32 s7, 0x20000
    s_mov_b32 s8, s20
    s_and_b32 s9, s21, 0xffff
    s_mov_b32 s10, 1280
    s_mov_b32 s11, 0x20000
    s_mov_b32 s12, s22
    s_and_b32 s13, s23, 0xffff
    s_mov_b32 s14, 4915200
    s_mov_b32 s15, 0x20000
    v_lshrrev_b32 v2, 2, v0
    v_mul_u32_u24 v3, 20, v2
    buffer_load_dword v60, v3, s[8:11], 0 offen offset:0
    buffer_load_dword v62, v3, s[8:11], 0 offen offset:4
    buffer_load_dword v64, v3, s[8:11], 0 offen offset:8
    buffer_load_dword v66, v3, s[8:11], 0 offen offset:12
    buffer_load_dword v68, v3, s[8:11], 0 offen offset:16
    v_mul_u32_u24 v3, 76800, v2
    v_and_b32 v4, 3, v0
    v_lshl_add_u32 v3, v4, 4, v3
    s_lshl_b32 s33, s29, 6
    buffer_load_dwordx4 v[16:19], v3, s[12:15], s33 offen
    s_add_u32 s33, s33, 7680
    buffer_load_dwordx4 v[20:23], v3, s[12:15], s33 offen
    s_add_u32 s33, s33, 7680
    buffer_load_dwordx4 v[24:27], v3, s[12:15], s33 offen
    s_add_u32 s33, s33, 7680
    buffer_load_dwordx4 v[28:31], v3, s[12:15], s33 offen
    s_add_u32 s33, s33, 7680
    buffer_load_dwordx4 v[32:35], v3, s[12:15], s33 offen
    s_add_u32 s33, s33, 7680
    buffer_load_dwordx4 v[36:39], v3, s[12:15], s33 offen
    s_add_u32 s33, s33, 7680
    buffer_load_dwordx4 v[40:43], v3, s[12:15], s33 offen
    s_add_u32 s33, s33, 7680
    buffer_load_dwordx4 v[44:47], v3, s[12:15], s33 offen
    s_add_u32 s33, s33, 7680
    buffer_load_dwordx4 v[48:51], v3, s[12:15], s33 offen
    s_add_u32 s33, s33, 7680
    buffer_load_dwordx4 v[52:55], v3, s[12:15], s33 offen
    s_add_u32 s33, s33, 7680
    s_waitcnt vmcnt(10)
    s_mov_b32 s48, 0xbfb8aa3b
    v_and_b32 v61, 0xffff0000, v60
    v_lshlrev_b32 v60, 16, v60
    v_and_b32 v63, 0xffff0000, v62
    v_lshlrev_b32 v62, 16, v62
    v_and_b32 v65, 0xffff0000, v64
    v_lshlrev_b32 v64, 16, v64
    v_and_b32 v67, 0xffff0000, v66
    v_lshlrev_b32 v66, 16, v66
    v_and_b32 v69, 0xffff0000, v68
    v_lshlrev_b32 v68, 16, v68
    v_mul_f32 v4, s48, v60
    v_exp_f32 v4, v4
    s_nop 0
    v_add_f32 v4, 1.0, v4
    v_rcp_f32 v4, v4
    s_nop 0
    v_mul_f32 v60, v60, v4
    v_cvt_pk_bf16_f32 v60, v60, v60
    v_lshlrev_b32 v60, 16, v60
    v_mul_f32 v4, s48, v61
    v_exp_f32 v4, v4
    s_nop 0
    v_add_f32 v4, 1.0, v4
    v_rcp_f32 v4, v4
    s_nop 0
    v_mul_f32 v61, v61, v4
    v_cvt_pk_bf16_f32 v61, v61, v61
    v_lshlrev_b32 v61, 16, v61
    v_mul_f32 v4, s48, v62
    v_exp_f32 v4, v4
    s_nop 0
    v_add_f32 v4, 1.0, v4
    v_rcp_f32 v4, v4
    s_nop 0
    v_mul_f32 v62, v62, v4
    v_cvt_pk_bf16_f32 v62, v62, v62
    v_lshlrev_b32 v62, 16, v62
    v_mul_f32 v4, s48, v63
    v_exp_f32 v4, v4
    s_nop 0
    v_add_f32 v4, 1.0, v4
    v_rcp_f32 v4, v4
    s_nop 0
    v_mul_f32 v63, v63, v4
    v_cvt_pk_bf16_f32 v63, v63, v63
    v_lshlrev_b32 v63, 16, v63
    v_mul_f32 v4, s48, v64
    v_exp_f32 v4, v4
    s_nop 0
    v_add_f32 v4, 1.0, v4
    v_rcp_f32 v4, v4
    s_nop 0
    v_mul_f32 v64, v64, v4
    v_cvt_pk_bf16_f32 v64, v64, v64
    v_lshlrev_b32 v64, 16, v64
    v_mul_f32 v4, s48, v65
    v_exp_f32 v4, v4
    s_nop 0
    v_add_f32 v4, 1.0, v4
    v_rcp_f32 v4, v4
    s_nop 0
    v_mul_f32 v65, v65, v4
    v_cvt_pk_bf16_f32 v65, v65, v65
    v_lshlrev_b32 v65, 16, v65
    v_mul_f32 v4, s48, v66
    v_exp_f32 v4, v4
    s_nop 0
    v_add_f32 v4, 1.0, v4
    v_rcp_f32 v4, v4
    s_nop 0
    v_mul_f32 v66, v66, v4
    v_cvt_pk_bf16_f32 v66, v66, v66
    v_lshlrev_b32 v66, 16, v66
    v_mul_f32 v4, s48, v67
    v_exp_f32 v4, v4
    s_nop 0
    v_add_f32 v4, 1.0, v4
    v_rcp_f32 v4, v4
    s_nop 0
    v_mul_f32 v67, v67, v4
    v_cvt_pk_bf16_f32 v67, v67, v67
    v_lshlrev_b32 v67, 16, v67
    v_mul_f32 v4, s48, v68
    v_exp_f32 v4, v4
    s_nop 0
    v_add_f32 v4, 1.0, v4
    v_rcp_f32 v4, v4
    s_nop 0
    v_mul_f32 v68, v68, v4
    v_cvt_pk_bf16_f32 v68, v68, v68
    v_lshlrev_b32 v68, 16, v68
    v_mul_f32 v4, s48, v69
    v_exp_f32 v4, v4
    s_nop 0
    v_add_f32 v4, 1.0, v4
    v_rcp_f32 v4, v4
    s_nop 0
    v_mul_f32 v69, v69, v4
    v_cvt_pk_bf16_f32 v69, v69, v69
    v_lshlrev_b32 v69, 16, v69
    s_waitcnt vmcnt(9)
    v_and_b32 v5, 0xffff0000, v16
    v_lshlrev_b32 v4, 16, v16
    v_mul_f32 v72, v60, v4
    v_mul_f32 v73, v60, v5
    v_and_b32 v5, 0xffff0000, v17
    v_lshlrev_b32 v4, 16, v17
    v_mul_f32 v74, v60, v4
    v_mul_f32 v75, v60, v5
    v_and_b32 v5, 0xffff0000, v18
    v_lshlrev_b32 v4, 16, v18
    v_mul_f32 v76, v60, v4
    v_mul_f32 v77, v60, v5
    v_and_b32 v5, 0xffff0000, v19
    v_lshlrev_b32 v4, 16, v19
    v_mul_f32 v78, v60, v4
    v_mul_f32 v79, v60, v5
    s_waitcnt vmcnt(8)
    v_and_b32 v5, 0xffff0000, v20
    v_lshlrev_b32 v4, 16, v20
    v_fmac_f32 v72, v61, v4
    v_fmac_f32 v73, v61, v5
    v_and_b32 v5, 0xffff0000, v21
    v_lshlrev_b32 v4, 16, v21
    v_fmac_f32 v74, v61, v4
    v_fmac_f32 v75, v61, v5
    v_and_b32 v5, 0xffff0000, v22
    v_lshlrev_b32 v4, 16, v22
    v_fmac_f32 v76, v61, v4
    v_fmac_f32 v77, v61, v5
    v_and_b32 v5, 0xffff0000, v23
    v_lshlrev_b32 v4, 16, v23
    v_fmac_f32 v78, v61, v4
    v_fmac_f32 v79, v61, v5
    s_waitcnt vmcnt(7)
    v_and_b32 v5, 0xffff0000, v24
    v_lshlrev_b32 v4, 16, v24
    v_fmac_f32 v72, v62, v4
    v_fmac_f32 v73, v62, v5
    v_and_b32 v5, 0xffff0000, v25
    v_lshlrev_b32 v4, 16, v25
    v_fmac_f32 v74, v62, v4
    v_fmac_f32 v75, v62, v5
    v_and_b32 v5, 0xffff0000, v26
    v_lshlrev_b32 v4, 16, v26
    v_fmac_f32 v76, v62, v4
    v_fmac_f32 v77, v62, v5
    v_and_b32 v5, 0xffff0000, v27
    v_lshlrev_b32 v4, 16, v27
    v_fmac_f32 v78, v62, v4
    v_fmac_f32 v79, v62, v5
    s_waitcnt vmcnt(6)
    v_and_b32 v5, 0xffff0000, v28
    v_lshlrev_b32 v4, 16, v28
    v_fmac_f32 v72, v63, v4
    v_fmac_f32 v73, v63, v5
    v_and_b32 v5, 0xffff0000, v29
    v_lshlrev_b32 v4, 16, v29
    v_fmac_f32 v74, v63, v4
    v_fmac_f32 v75, v63, v5
    v_and_b32 v5, 0xffff0000, v30
    v_lshlrev_b32 v4, 16, v30
    v_fmac_f32 v76, v63, v4
    v_fmac_f32 v77, v63, v5
    v_and_b32 v5, 0xffff0000, v31
    v_lshlrev_b32 v4, 16, v31
    v_fmac_f32 v78, v63, v4
    v_fmac_f32 v79, v63, v5
    s_waitcnt vmcnt(5)
    v_and_b32 v5, 0xffff0000, v32
    v_lshlrev_b32 v4, 16, v32
    v_fmac_f32 v72, v64, v4
    v_fmac_f32 v73, v64, v5
    v_and_b32 v5, 0xffff0000, v33
    v_lshlrev_b32 v4, 16, v33
    v_fmac_f32 v74, v64, v4
    v_fmac_f32 v75, v64, v5
    v_and_b32 v5, 0xffff0000, v34
    v_lshlrev_b32 v4, 16, v34
    v_fmac_f32 v76, v64, v4
    v_fmac_f32 v77, v64, v5
    v_and_b32 v5, 0xffff0000, v35
    v_lshlrev_b32 v4, 16, v35
    v_fmac_f32 v78, v64, v4
    v_fmac_f32 v79, v64, v5
    s_waitcnt vmcnt(4)
    v_and_b32 v5, 0xffff0000, v36
    v_lshlrev_b32 v4, 16, v36
    v_fmac_f32 v72, v65, v4
    v_fmac_f32 v73, v65, v5
    v_and_b32 v5, 0xffff0000, v37
    v_lshlrev_b32 v4, 16, v37
    v_fmac_f32 v74, v65, v4
    v_fmac_f32 v75, v65, v5
    v_and_b32 v5, 0xffff0000, v38
    v_lshlrev_b32 v4, 16, v38
    v_fmac_f32 v76, v65, v4
    v_fmac_f32 v77, v65, v5
    v_and_b32 v5, 0xffff0000, v39
    v_lshlrev_b32 v4, 16, v39
    v_fmac_f32 v78, v65, v4
    v_fmac_f32 v79, v65, v5
    s_waitcnt vmcnt(3)
    v_and_b32 v5, 0xffff0000, v40
    v_lshlrev_b32 v4, 16, v40
    v_fmac_f32 v72, v66, v4
    v_fmac_f32 v73, v66, v5
    v_and_b32 v5, 0xffff0000, v41
    v_lshlrev_b32 v4, 16, v41
    v_fmac_f32 v74, v66, v4
    v_fmac_f32 v75, v66, v5
    v_and_b32 v5, 0xffff0000, v42
    v_lshlrev_b32 v4, 16, v42
    v_fmac_f32 v76, v66, v4
    v_fmac_f32 v77, v66, v5
    v_and_b32 v5, 0xffff0000, v43
    v_lshlrev_b32 v4, 16, v43
    v_fmac_f32 v78, v66, v4
    v_fmac_f32 v79, v66, v5
    s_waitcnt vmcnt(2)
    v_and_b32 v5, 0xffff0000, v44
    v_lshlrev_b32 v4, 16, v44
    v_fmac_f32 v72, v67, v4
    v_fmac_f32 v73, v67, v5
    v_and_b32 v5, 0xffff0000, v45
    v_lshlrev_b32 v4, 16, v45
    v_fmac_f32 v74, v67, v4
    v_fmac_f32 v75, v67, v5
    v_and_b32 v5, 0xffff0000, v46
    v_lshlrev_b32 v4, 16, v46
    v_fmac_f32 v76, v67, v4
    v_fmac_f32 v77, v67, v5
    v_and_b32 v5, 0xffff0000, v47
    v_lshlrev_b32 v4, 16, v47
    v_fmac_f32 v78, v67, v4
    v_fmac_f32 v79, v67, v5
    s_waitcnt vmcnt(1)
    v_and_b32 v5, 0xffff0000, v48
    v_lshlrev_b32 v4, 16, v48
    v_fmac_f32 v72, v68, v4
    v_fmac_f32 v73, v68, v5
    v_and_b32 v5, 0xffff0000, v49
    v_lshlrev_b32 v4, 16, v49
    v_fmac_f32 v74, v68, v4
    v_fmac_f32 v75, v68, v5
    v_and_b32 v5, 0xffff0000, v50
    v_lshlrev_b32 v4, 16, v50
    v_fmac_f32 v76, v68, v4
    v_fmac_f32 v77, v68, v5
    v_and_b32 v5, 0xffff0000, v51
    v_lshlrev_b32 v4, 16, v51
    v_fmac_f32 v78, v68, v4
    v_fmac_f32 v79, v68, v5
    s_waitcnt vmcnt(0)
    v_and_b32 v5, 0xffff0000, v52
    v_lshlrev_b32 v4, 16, v52
    v_fmac_f32 v72, v69, v4
    v_fmac_f32 v73, v69, v5
    v_and_b32 v5, 0xffff0000, v53
    v_lshlrev_b32 v4, 16, v53
    v_fmac_f32 v74, v69, v4
    v_fmac_f32 v75, v69, v5
    v_and_b32 v5, 0xffff0000, v54
    v_lshlrev_b32 v4, 16, v54
    v_fmac_f32 v76, v69, v4
    v_fmac_f32 v77, v69, v5
    v_and_b32 v5, 0xffff0000, v55
    v_lshlrev_b32 v4, 16, v55
    v_fmac_f32 v78, v69, v4
    v_fmac_f32 v79, v69, v5
    v_add_f32_dpp v72, v72, v72 row_ror:4 row_mask:0xf bank_mask:0xf
    v_add_f32_dpp v73, v73, v73 row_ror:4 row_mask:0xf bank_mask:0xf
    v_add_f32_dpp v74, v74, v74 row_ror:4 row_mask:0xf bank_mask:0xf
    v_add_f32_dpp v75, v75, v75 row_ror:4 row_mask:0xf bank_mask:0xf
    v_add_f32_dpp v76, v76, v76 row_ror:4 row_mask:0xf bank_mask:0xf
    v_add_f32_dpp v77, v77, v77 row_ror:4 row_mask:0xf bank_mask:0xf
    v_add_f32_dpp v78, v78, v78 row_ror:4 row_mask:0xf bank_mask:0xf
    v_add_f32_dpp v79, v79, v79 row_ror:4 row_mask:0xf bank_mask:0xf
    v_add_f32_dpp v72, v72, v72 row_ror:8 row_mask:0xf bank_mask:0xf
    v_add_f32_dpp v73, v73, v73 row_ror:8 row_mask:0xf bank_mask:0xf
    v_add_f32_dpp v74, v74, v74 row_ror:8 row_mask:0xf bank_mask:0xf
    v_add_f32_dpp v75, v75, v75 row_ror:8 row_mask:0xf bank_mask:0xf
    v_add_f32_dpp v76, v76, v76 row_ror:8 row_mask:0xf bank_mask:0xf
    v_add_f32_dpp v77, v77, v77 row_ror:8 row_mask:0xf bank_mask:0xf
    v_add_f32_dpp v78, v78, v78 row_ror:8 row_mask:0xf bank_mask:0xf
    v_add_f32_dpp v79, v79, v79 row_ror:8 row_mask:0xf bank_mask:0xf
    v_mov_b32 v16, v72
    v_mov_b32 v17, v73
    v_mov_b32 v18, v74
    v_mov_b32 v19, v75
    v_mov_b32 v20, v76
    v_mov_b32 v21, v77
    v_mov_b32 v22, v78
    v_mov_b32 v23, v79
    v_permlane16_swap_b32 v72, v16
    v_permlane16_swap_b32 v73, v17
    v_permlane16_swap_b32 v74, v18
    v_permlane16_swap_b32 v75, v19
    v_permlane16_swap_b32 v76, v20
    v_permlane16_swap_b32 v77, v21
    v_permlane16_swap_b32 v78, v22
    v_permlane16_swap_b32 v79, v23
    v_add_f32 v72, v72, v16
    v_add_f32 v73, v73, v17
    v_add_f32 v74, v74, v18
    v_add_f32 v75, v75, v19
    v_add_f32 v76, v76, v20
    v_add_f32 v77, v77, v21
    v_add_f32 v78, v78, v22
    v_add_f32 v79, v79, v23
    v_mov_b32 v16, v72
    v_mov_b32 v17, v73
    v_mov_b32 v18, v74
    v_mov_b32 v19, v75
    v_mov_b32 v20, v76
    v_mov_b32 v21, v77
    v_mov_b32 v22, v78
    v_mov_b32 v23, v79
    v_permlane32_swap_b32 v72, v16
    v_permlane32_swap_b32 v73, v17
    v_permlane32_swap_b32 v74, v18
    v_permlane32_swap_b32 v75, v19
    v_permlane32_swap_b32 v76, v20
    v_permlane32_swap_b32 v77, v21
    v_permlane32_swap_b32 v78, v22
    v_permlane32_swap_b32 v79, v23
    v_add_f32 v72, v72, v16
    v_add_f32 v73, v73, v17
    v_add_f32 v74, v74, v18
    v_add_f32 v75, v75, v19
    v_add_f32 v76, v76, v20
    v_add_f32 v77, v77, v21
    v_add_f32 v78, v78, v22
    v_add_f32 v79, v79, v23
    v_and_b32 v4, 3, v0
    v_lshlrev_b32 v4, 5, v4
    s_lshl_b32 s33, s28, 7
    v_add_u32 v4, s33, v4
    ds_write_b128 v4, v[72:75]
    ds_write_b128 v4, v[76:79] offset:16
    s_waitcnt lgkmcnt(0)
    s_barrier
    v_and_b32 v4, 31, v0
    v_lshlrev_b32 v4, 2, v4
    ds_read_b32 v16, v4 offset:0
    ds_read_b32 v17, v4 offset:128
    ds_read_b32 v18, v4 offset:256
    ds_read_b32 v19, v4 offset:384
    s_waitcnt lgkmcnt(0)
    v_add_f32 v16, v16, v17
    v_add_f32 v18, v18, v19
    v_add_f32 v16, v16, v18
    v_cvt_pk_bf16_f32 v16, v16, v16
    v_lshlrev_b32 v16, 16, v16
    s_lshl_b32 s33, s29, 7
    s_add_u32 s33, s33, 131072
    s_cmp_lg_u32 s28, 0
    s_cbranch_scc1 L_modst_3063
    buffer_store_dword v16, v4, s[4:7], s33 offen sc1
L_modst_3063:
    v_mov_b32 v254, 0
L_epoch_3064:
    global_load_dwordx2 v[252:253], v254, s[100:101] offset:128 sc1
    s_waitcnt vmcnt(0)
    v_cmp_eq_u32 vcc, 0, v253
    s_cbranch_vccz L_ok_3065
    s_sleep 2
    s_sub_u32 s98, s98, 1
    s_cbranch_scc0 L_epoch_3064
    s_mov_b32 s98, 0
L_ok_3065:
    v_readfirstlane_b32 s96, v252
    v_readfirstlane_b32 s97, v253
    s_lshl_b32 s99, s29, 3
    s_add_u32 s99, s99, 4096
    s_waitcnt vmcnt(0)
    s_barrier
    s_cmp_lg_u32 s28, 0
    s_cbranch_scc1 L_sig_3066
    s_add_u32 s33, s96, 1
    v_mov_b32 v252, s33
    v_mov_b32 v253, s97
    s_mov_b64 exec, 1
    buffer_store_dwordx2 v[252:253], off, s[4:7], s99 sc1
    s_mov_b64 exec, -1
L_sig_3066:
L_req_3051:
    s_lshr_b32 s33, s62, 5
    s_lshl_b32 s33, s33, 3
    s_add_u32 s33, s33, 16
    s_load_dwordx2 s[22:23], s[0:1], s33
    v_bfe_u32 v249, v0, 4, 2
    v_lshlrev_b32 v248, 2, v249
    v_xor_b32 v248, v248, v0
    v_and_b32 v248, 15, v248
    v_lshlrev_b32 v248, 4, v248
    v_lshl_add_u32 v248, v249, 13, v248
    s_and_b32 s33, s62, 31
    s_lshl_b32 s33, s33, 8
    s_lshl_b32 s34, s28, 15
    s_add_u32 s58, s33, s34
    s_lshl_b32 s57, s28, 10
    s_waitcnt lgkmcnt(0)
    s_mov_b32 s8, s22
    s_and_b32 s9, s23, 0xffff
    s_mov_b32 s10, 5242880
    s_mov_b32 s11, 0x20000
    s_add_u32 m0, s57, 0
    s_nop 0
    buffer_load_dwordx4 v248, s[8:11], s58 offen lds
    s_add_u32 s58, s58, 131072
    s_add_u32 m0, s57, 4096
    s_nop 0
    buffer_load_dwordx4 v248, s[8:11], s58 offen lds
    s_add_u32 s58, s58, 131072
    s_add_u32 m0, s57, 8192
    s_nop 0
    buffer_load_dwordx4 v248, s[8:11], s58 offen lds
    s_add_u32 s58, s58, 131072
    s_add_u32 m0, s57, 12288
    s_nop 0
    buffer_load_dwordx4 v248, s[8:11], s58 offen lds
    s_add_u32 s58, s58, 131072
    s_add_u32 m0, s57, 16384
    s_nop 0
    buffer_load_dwordx4 v248, s[8:11], s58 offen lds
    s_add_u32 s58, s58, 131072
    s_add_u32 m0, s57, 20480
    s_nop 0
    buffer_load_dwordx4 v248, s[8:11], s58 offen lds
    s_add_u32 s58, s58, 131072
    s_add_u32 m0, s57, 24576
    s_nop 0
    buffer_load_dwordx4 v248, s[8:11], s58 offen lds
    s_add_u32 s58, s58, 131072
    s_add_u32 m0, s57, 28672
    s_nop 0
    buffer_load_dwordx4 v248, s[8:11], s58 offen lds
    s_add_u32 s58, s58, 131072
    s_add_u32 m0, s57, 32768
    s_nop 0
    buffer_load_dwordx4 v248, s[8:11], s58 offen lds
    s_add_u32 s58, s58, 131072
    s_add_u32 m0, s57, 36864
    s_nop 0
    buffer_load_dwordx4 v248, s[8:11], s58 offen lds
    s_add_u32 s58, s58, 131072
    s_add_u32 m0, s57, 40960
    s_nop 0
    buffer_load_dwordx4 v248, s[8:11], s58 offen lds
    s_add_u32 s58, s58, 131072
    s_add_u32 m0, s57, 45056
    s_nop 0
    buffer_load_dwordx4 v248, s[8:11], s58 offen lds
    s_add_u32 s58, s58, 131072
    s_add_u32 m0, s57, 49152
    s_nop 0
    buffer_load_dwordx4 v248, s[8:11], s58 offen lds
    s_add_u32 s58, s58, 131072
    s_add_u32 m0, s57, 53248
    s_nop 0
    buffer_load_dwordx4 v248, s[8:11], s58 offen lds
    s_add_u32 s58, s58, 131072
    s_add_u32 m0, s57, 57344
    s_nop 0
    buffer_load_dwordx4 v248, s[8:11], s58 offen lds
    s_add_u32 s58, s58, 131072
    s_add_u32 m0, s57, 61440
    s_nop 0
    buffer_load_dwordx4 v248, s[8:11], s58 offen lds
    s_add_u32 s58, s58, 131072
    s_add_u32 m0, s57, 65536
    s_nop 0
    buffer_load_dwordx4 v248, s[8:11], s58 offen lds
    s_add_u32 s58, s58, 131072
    s_add_u32 m0, s57, 69632
    s_nop 0
    buffer_load_dwordx4 v248, s[8:11], s58 offen lds
    s_add_u32 s58, s58, 131072
    s_add_u32 m0, s57, 73728
    s_nop 0
    buffer_load_dwordx4 v248, s[8:11], s58 offen lds
    s_add_u32 s58, s58, 131072
    s_add_u32 m0, s57, 77824
    s_nop 0
    buffer_load_dwordx4 v248, s[8:11], s58 offen lds
    s_add_u32 s58, s58, 131072
    s_add_u32 m0, s57, 81920
    s_nop 0
    buffer_load_dwordx4 v248, s[8:11], s58 offen lds
    s_add_u32 s58, s58, 131072
    s_add_u32 m0, s57, 86016
    s_nop 0
    buffer_load_dwordx4 v248, s[8:11], s58 offen lds
    s_add_u32 s58, s58, 131072
    s_add_u32 m0, s57, 90112
    s_nop 0
    buffer_load_dwordx4 v248, s[8:11], s58 offen lds
    s_add_u32 s58, s58, 131072
    s_add_u32 m0, s57, 94208
    s_nop 0
    buffer_load_dwordx4 v248, s[8:11], s58 offen lds
    s_add_u32 s58, s58, 131072
    s_add_u32 m0, s57, 98304
    s_nop 0
    buffer_load_dwordx4 v248, s[8:11], s58 offen lds
    s_add_u32 s58, s58, 131072
    s_add_u32 m0, s57, 102400
    s_nop 0
    buffer_load_dwordx4 v248, s[8:11], s58 offen lds
    s_add_u32 s58, s58, 131072
    s_add_u32 m0, s57, 106496
    s_nop 0
    buffer_load_dwordx4 v248, s[8:11], s58 offen lds
    s_add_u32 s58, s58, 131072
    s_add_u32 m0, s57, 110592
    s_nop 0
    buffer_load_dwordx4 v248, s[8:11], s58 offen lds
    s_add_u32 s58, s58, 131072
    s_add_u32 m0, s57, 114688
    s_nop 0
    buffer_load_dwordx4 v248, s[8:11], s58 offen lds
    s_add_u32 s58, s58, 131072
    s_add_u32 m0, s57, 118784
    s_nop 0
    buffer_load_dwordx4 v248, s[8:11], s58 offen lds
    s_add_u32 s58, s58, 131072
    s_add_u32 m0, s57, 122880
    s_nop 0
    buffer_load_dwordx4 v248, s[8:11], s58 offen lds
    s_add_u32 s58, s58, 131072
    s_add_u32 m0, s57, 126976
    s_nop 0
    buffer_load_dwordx4 v248, s[8:11], s58 offen lds
    s_add_u32 s58, s58, 131072
    s_add_u32 m0, s57, 131072
    s_nop 0
    buffer_load_dwordx4 v248, s[8:11], s58 offen lds
    s_add_u32 s58, s58, 131072
    s_add_u32 m0, s57, 135168
    s_nop 0
    buffer_load_dwordx4 v248, s[8:11], s58 offen lds
    s_add_u32 s58, s58, 131072
    s_add_u32 m0, s57, 139264
    s_nop 0
    buffer_load_dwordx4 v248, s[8:11], s58 offen lds
    s_add_u32 s58, s58, 131072
    s_add_u32 m0, s57, 143360
    s_nop 0
    buffer_load_dwordx4 v248, s[8:11], s58 offen lds
    s_add_u32 s58, s58, 131072
    s_add_u32 m0, s57, 147456
    s_nop 0
    buffer_load_dwordx4 v248, s[8:11], s58 offen lds
    s_add_u32 s58, s58, 131072
    s_add_u32 m0, s57, 151552
    s_nop 0
    buffer_load_dwordx4 v248, s[8:11], s58 offen lds
    s_add_u32 s58, s58, 131072
    s_add_u32 m0, s57, 155648
    s_nop 0
    buffer_load_dwordx4 v248, s[8:11], s58 offen lds
    s_add_u32 s58, s58, 131072
    s_add_u32 m0, s57, 159744
    s_nop 0
    buffer_load_dwordx4 v248, s[8:11], s58 offen lds
    s_add_u32 s58, s58, 131072
    v_bfe_u32 v248, v0, 2, 2
    v_xor_b32 v249, s28, v248
    v_lshlrev_b32 v249, 6, v249
    v_lshl_add_u32 v249, v248, 8, v249
    v_bfe_u32 v248, v0, 5, 1
    v_lshl_add_u32 v249, v248, 10, v249
    v_bfe_u32 v248, v0, 4, 1
    v_lshl_add_u32 v249, v248, 5, v249
    v_and_b32 v248, 3, v0
    v_lshl_add_u32 v249, v248, 3, v249
    s_waitcnt vmcnt(30)
    s_barrier
    ds_read_b64_tr_b16 a[0:1], v249 offset:0
    ds_read_b64_tr_b16 a[2:3], v249 offset:2048
    ds_read_b64_tr_b16 a[4:5], v249 offset:4096
    ds_read_b64_tr_b16 a[6:7], v249 offset:6144
    ds_read_b64_tr_b16 a[8:9], v249 offset:8192
    ds_read_b64_tr_b16 a[10:11], v249 offset:10240
    ds_read_b64_tr_b16 a[12:13], v249 offset:12288
    ds_read_b64_tr_b16 a[14:15], v249 offset:14336
    ds_read_b64_tr_b16 a[16:17], v249 offset:16384
    ds_read_b64_tr_b16 a[18:19], v249 offset:18432
    ds_read_b64_tr_b16 a[20:21], v249 offset:20480
    ds_read_b64_tr_b16 a[22:23], v249 offset:22528
    ds_read_b64_tr_b16 a[24:25], v249 offset:24576
    ds_read_b64_tr_b16 a[26:27], v249 offset:26624
    ds_read_b64_tr_b16 a[28:29], v249 offset:28672
    ds_read_b64_tr_b16 a[30:31], v249 offset:30720
    ds_read_b64_tr_b16 a[32:33], v249 offset:32768
    ds_read_b64_tr_b16 a[34:35], v249 offset:34816
    ds_read_b64_tr_b16 a[36:37], v249 offset:36864
    ds_read_b64_tr_b16 a[38:39], v249 offset:38912
    v_add_u32 v249, 40960, v249
    s_waitcnt vmcnt(20)
    s_barrier
    ds_read_b64_tr_b16 a[40:41], v249 offset:0
    ds_read_b64_tr_b16 a[42:43], v249 offset:2048
    ds_read_b64_tr_b16 a[44:45], v249 offset:4096
    ds_read_b64_tr_b16 a[46:47], v249 offset:6144
    ds_read_b64_tr_b16 a[48:49], v249 offset:8192
    ds_read_b64_tr_b16 a[50:51], v249 offset:10240
    ds_read_b64_tr_b16 a[52:53], v249 offset:12288
    ds_read_b64_tr_b16 a[54:55], v249 offset:14336
    ds_read_b64_tr_b16 a[56:57], v249 offset:16384
    ds_read_b64_tr_b16 a[58:59], v249 offset:18432
    ds_read_b64_tr_b16 a[60:61], v249 offset:20480
    ds_read_b64_tr_b16 a[62:63], v249 offset:22528
    ds_read_b64_tr_b16 a[64:65], v249 offset:24576
    ds_read_b64_tr_b16 a[66:67], v249 offset:26624
    ds_read_b64_tr_b16 a[68:69], v249 offset:28672
    ds_read_b64_tr_b16 a[70:71], v249 offset:30720
    ds_read_b64_tr_b16 a[72:73], v249 offset:32768
    ds_read_b64_tr_b16 a[74:75], v249 offset:34816
    ds_read_b64_tr_b16 a[76:77], v249 offset:36864
    ds_read_b64_tr_b16 a[78:79], v249 offset:38912
    v_add_u32 v249, 40960, v249
    s_waitcnt vmcnt(10)
    s_barrier
    ds_read_b64_tr_b16 a[80:81], v249 offset:0
    ds_read_b64_tr_b16 a[82:83], v249 offset:2048
    ds_read_b64_tr_b16 a[84:85], v249 offset:4096
    ds_read_b64_tr_b16 a[86:87], v249 offset:6144
    ds_read_b64_tr_b16 a[88:89], v249 offset:8192
    ds_read_b64_tr_b16 a[90:91], v249 offset:10240
    ds_read_b64_tr_b16 a[92:93], v249 offset:12288
    ds_read_b64_tr_b16 a[94:95], v249 offset:14336
    ds_read_b64_tr_b16 a[96:97], v249 offset:16384
    ds_read_b64_tr_b16 a[98:99], v249 offset:18432
    ds_read_b64_tr_b16 a[100:101], v249 offset:20480
    ds_read_b64_tr_b16 a[102:103], v249 offset:22528
    ds_read_b64_tr_b16 a[104:105], v249 offset:24576
    ds_read_b64_tr_b16 a[106:107], v249 offset:26624
    ds_read_b64_tr_b16 a[108:109], v249 offset:28672
    ds_read_b64_tr_b16 a[110:111], v249 offset:30720
    ds_read_b64_tr_b16 a[112:113], v249 offset:32768
    ds_read_b64_tr_b16 a[114:115], v249 offset:34816
    ds_read_b64_tr_b16 a[116:117], v249 offset:36864
    ds_read_b64_tr_b16 a[118:119], v249 offset:38912
    v_add_u32 v249, 40960, v249
    s_waitcnt vmcnt(0)
    s_barrier
    ds_read_b64_tr_b16 a[120:121], v249 offset:0
    ds_read_b64_tr_b16 a[122:123], v249 offset:2048
    ds_read_b64_tr_b16 a[124:125], v249 offset:4096
    ds_read_b64_tr_b16 a[126:127], v249 offset:6144
    ds_read_b64_tr_b16 a[128:129], v249 offset:8192
    ds_read_b64_tr_b16 a[130:131], v249 offset:10240
    ds_read_b64_tr_b16 a[132:133], v249 offset:12288
    ds_read_b64_tr_b16 a[134:135], v249 offset:14336
    ds_read_b64_tr_b16 a[136:137], v249 offset:16384
    ds_read_b64_tr_b16 a[138:139], v249 offset:18432
    ds_read_b64_tr_b16 a[140:141], v249 offset:20480
    ds_read_b64_tr_b16 a[142:143], v249 offset:22528
    ds_read_b64_tr_b16 a[144:145], v249 offset:24576
    ds_read_b64_tr_b16 a[146:147], v249 offset:26624
    ds_read_b64_tr_b16 a[148:149], v249 offset:28672
    ds_read_b64_tr_b16 a[150:151], v249 offset:30720
    ds_read_b64_tr_b16 a[152:153], v249 offset:32768
    ds_read_b64_tr_b16 a[154:155], v249 offset:34816
    ds_read_b64_tr_b16 a[156:157], v249 offset:36864
    ds_read_b64_tr_b16 a[158:159], v249 offset:38912
    s_waitcnt lgkmcnt(0)
    s_barrier
L_proj_3052:
    s_mov_b32 s29, s62
    s_and_b32 s30, s95, 1
    s_mov_b32 s31, 2
    s_mov_b32 s32, 64
    s_lshl_b32 s99, s95, 3
    s_add_u32 s99, s99, 8192
    s_lshr_b32 s56, s29, 5
    v_and_b32 v1, 63, v0
    v_and_b32 v2, 15, v0
    v_bfe_u32 v3, v0, 4, 2
    v_lshlrev_b32 v7, 4, v1
    s_and_b32 s33, s29, 31
    s_lshl_b32 s59, s33, 13
    v_and_b32 v4, 1, v3
    v_lshlrev_b32 v8, 10, v4
    v_lshrrev_b32 v4, 1, v3
    v_lshl_add_u32 v8, v4, 8, v8
    v_lshl_add_u32 v8, v2, 4, v8
    s_lshl_b32 s33, s28, 11
    v_add_u32 v8, s33, v8
    s_lshl_b32 s33, s56, 24
    s_add_u32 s59, s59, s33
    s_add_u32 s59, s59, 20971520
    v_bfe_u32 v4, v1, 2, 3
    v_mul_u32_u24 v9, 5120, v4
    v_lshrrev_b32 v4, 5, v1
    v_lshl_add_u32 v9, v4, 6, v9
    v_and_b32 v4, 3, v1
    v_lshl_add_u32 v9, v4, 4, v9
    s_lshl_b32 s33, s28, 7
    v_add_u32 v9, s33, v9
    s_cmp_ge_u32 s28, 2
    s_cbranch_scc1 L_wm_3067
    s_lshl_b32 s33, s28, 9
    s_add_u32 s33, s33, 6144
    v_and_b32 v254, 63, v0
    v_min_u32 v254, 63, v254
    v_lshlrev_b32 v254, 3, v254
L_poll_3068:
    buffer_load_dwordx2 v[252:253], v254, s[4:7], s33 offen sc1
    s_waitcnt vmcnt(0)
    v_subrev_u32 v252, s96, v252
    v_xor_b32 v253, s97, v253
    v_lshrrev_b32 v255, 8, v252
    v_or_b32 v253, v253, v255
    v_cmp_eq_u32 vcc, 0, v253
    s_nop 1
    v_cndmask_b32 v252, 0, v252, vcc
    v_cmp_gt_u32 vcc, 1, v252
    s_cbranch_vccz L_ok_3069
    s_sleep 2
    s_sub_u32 s98, s98, 1
    s_cbranch_scc0 L_poll_3068
    s_mov_b32 s98, 0
L_ok_3069:
L_wm_3067:
    s_barrier
    s_mov_b32 s60, 0
    s_min_u32 s33, s30, 63
    s_mul_i32 s33, s33, 40960
    s_add_u32 s33, s33, 8388608
    s_add_u32 s34, s60, s57
    s_add_u32 m0, s34, 0
    s_nop 0
    buffer_load_dwordx4 v9, s[4:7], s33 offen sc1 lds
    s_add_u32 s33, s33, 512
    s_add_u32 m0, s34, 4096
    s_nop 0
    buffer_load_dwordx4 v9, s[4:7], s33 offen sc1 lds
    s_add_u32 s33, s33, 512
    s_add_u32 m0, s34, 8192
    s_nop 0
    buffer_load_dwordx4 v9, s[4:7], s33 offen sc1 lds
    s_add_u32 s33, s33, 512
    s_add_u32 m0, s34, 12288
    s_nop 0
    buffer_load_dwordx4 v9, s[4:7], s33 offen sc1 lds
    s_add_u32 s33, s33, 512
    s_add_u32 m0, s34, 16384
    s_nop 0
    buffer_load_dwordx4 v9, s[4:7], s33 offen sc1 lds
    s_add_u32 s33, s33, 512
    s_add_u32 m0, s34, 20480
    s_nop 0
    buffer_load_dwordx4 v9, s[4:7], s33 offen sc1 lds
    s_add_u32 s33, s33, 512
    s_add_u32 m0, s34, 24576
    s_nop 0
    buffer_load_dwordx4 v9, s[4:7], s33 offen sc1 lds
    s_add_u32 s33, s33, 512
    s_add_u32 m0, s34, 28672
    s_nop 0
    buffer_load_dwordx4 v9, s[4:7], s33 offen sc1 lds
    s_add_u32 s33, s33, 512
    s_add_u32 m0, s34, 32768
    s_nop 0
    buffer_load_dwordx4 v9, s[4:7], s33 offen sc1 lds
    s_add_u32 s33, s33, 512
    s_add_u32 m0, s34, 36864
    s_nop 0
    buffer_load_dwordx4 v9, s[4:7], s33 offen sc1 lds
    s_add_u32 s33, s33, 512
    s_add_u32 s61, s30, s31
    s_mov_b32 s35, 40960
    s_min_u32 s33, s61, 63
    s_mul_i32 s33, s33, 40960
    s_add_u32 s33, s33, 8388608
    s_add_u32 s34, s35, s57
    s_add_u32 m0, s34, 0
    s_nop 0
    buffer_load_dwordx4 v9, s[4:7], s33 offen sc1 lds
    s_add_u32 s33, s33, 512
    s_add_u32 m0, s34, 4096
    s_nop 0
    buffer_load_dwordx4 v9, s[4:7], s33 offen sc1 lds
    s_add_u32 s33, s33, 512
    s_add_u32 m0, s34, 8192
    s_nop 0
    buffer_load_dwordx4 v9, s[4:7], s33 offen sc1 lds
    s_add_u32 s33, s33, 512
    s_add_u32 m0, s34, 12288
    s_nop 0
    buffer_load_dwordx4 v9, s[4:7], s33 offen sc1 lds
    s_add_u32 s33, s33, 512
    s_add_u32 m0, s34, 16384
    s_nop 0
    buffer_load_dwordx4 v9, s[4:7], s33 offen sc1 lds
    s_add_u32 s33, s33, 512
    s_add_u32 m0, s34, 20480
    s_nop 0
    buffer_load_dwordx4 v9, s[4:7], s33 offen sc1 lds
    s_add_u32 s33, s33, 512
    s_add_u32 m0, s34, 24576
    s_nop 0
    buffer_load_dwordx4 v9, s[4:7], s33 offen sc1 lds
    s_add_u32 s33, s33, 512
    s_add_u32 m0, s34, 28672
    s_nop 0
    buffer_load_dwordx4 v9, s[4:7], s33 offen sc1 lds
    s_add_u32 s33, s33, 512
    s_add_u32 m0, s34, 32768
    s_nop 0
    buffer_load_dwordx4 v9, s[4:7], s33 offen sc1 lds
    s_add_u32 s33, s33, 512
    s_add_u32 m0, s34, 36864
    s_nop 0
    buffer_load_dwordx4 v9, s[4:7], s33 offen sc1 lds
    s_add_u32 s33, s33, 512
    s_waitcnt vmcnt(10)
    s_cmp_eq_u32 s56, 2
    s_cbranch_scc1 L_qkv_v_3070
L_qkv_3072:
    s_barrier
    s_cmp_lt_u32 s30, 6
    s_cbranch_scc1 L_nopub_3073
    s_sub_u32 s34, s30, s31
    s_cmp_lg_u32 s28, 0
    s_cbranch_scc1 L_sig_3074
    s_add_u32 s33, s96, s34
    v_mov_b32 v252, s33
    v_mov_b32 v253, s97
    s_mov_b64 exec, 1
    buffer_store_dwordx2 v[252:253], off, s[4:7], s99 sc1
    s_mov_b64 exec, -1
L_sig_3074:
L_nopub_3073:
    s_add_u32 s61, s61, s31
    s_add_u32 s35, s60, 81920
    s_cmp_ge_u32 s35, 122880
    s_cselect_b32 s36, 122880, 0
    s_sub_u32 s35, s35, s36
    s_min_u32 s33, s61, 63
    s_mul_i32 s33, s33, 40960
    s_add_u32 s33, s33, 8388608
    s_add_u32 s34, s35, s57
    v_add_u32 v4, s60, v7
    ds_read_b128 v[40:43], v4 offset:0
    ds_read_b128 v[44:47], v4 offset:1024
    ds_read_b128 v[48:51], v4 offset:2048
    ds_read_b128 v[52:55], v4 offset:3072
    s_waitcnt lgkmcnt(3)
    v_mfma_f32_32x32x16_bf16 v[16:31], a[0:3], v[40:43], 0
    s_add_u32 m0, s34, 0
    ds_read_b128 v[56:59], v4 offset:4096
    s_waitcnt lgkmcnt(3)
    v_mfma_f32_32x32x16_bf16 v[16:31], a[4:7], v[44:47], v[16:31]
    buffer_load_dwordx4 v9, s[4:7], s33 offen sc1 lds
    s_add_u32 s33, s33, 512
    ds_read_b128 v[40:43], v4 offset:5120
    s_waitcnt lgkmcnt(3)
    v_mfma_f32_32x32x16_bf16 v[16:31], a[8:11], v[48:51], v[16:31]
    ds_read_b128 v[44:47], v4 offset:6144
    s_waitcnt lgkmcnt(3)
    v_mfma_f32_32x32x16_bf16 v[16:31], a[12:15], v[52:55], v[16:31]
    ds_read_b128 v[48:51], v4 offset:7168
    s_waitcnt lgkmcnt(3)
    v_mfma_f32_32x32x16_bf16 v[16:31], a[16:19], v[56:59], v[16:31]
    s_add_u32 m0, s34, 4096
    ds_read_b128 v[52:55], v4 offset:8192
    s_waitcnt lgkmcnt(3)
    v_mfma_f32_32x32x16_bf16 v[16:31], a[20:23], v[40:43], v[16:31]
    buffer_load_dwordx4 v9, s[4:7], s33 offen sc1 lds
    s_add_u32 s33, s33, 512
    ds_read_b128 v[56:59], v4 offset:9216
    s_waitcnt lgkmcnt(3)
    v_mfma_f32_32x32x16_bf16 v[16:31], a[24:27], v[44:47], v[16:31]
    ds_read_b128 v[40:43], v4 offset:10240
    s_waitcnt lgkmcnt(3)
    v_mfma_f32_32x32x16_bf16 v[16:31], a[28:31], v[48:51], v[16:31]
    ds_read_b128 v[44:47], v4 offset:11264
    s_waitcnt lgkmcnt(3)
    v_mfma_f32_32x32x16_bf16 v[16:31], a[32:35], v[52:55], v[16:31]
    s_add_u32 m0, s34, 8192
    ds_read_b128 v[48:51], v4 offset:12288
    s_waitcnt lgkmcnt(3)
    v_mfma_f32_32x32x16_bf16 v[16:31], a[36:39], v[56:59], v[16:31]
    buffer_load_dwordx4 v9, s[4:7], s33 offen sc1 lds
    s_add_u32 s33, s33, 512
    ds_read_b128 v[52:55], v4 offset:13312
    s_waitcnt lgkmcnt(3)
    v_mfma_f32_32x32x16_bf16 v[16:31], a[40:43], v[40:43], v[16:31]
    ds_read_b128 v[56:59], v4 offset:14336
    s_waitcnt lgkmcnt(3)
    v_mfma_f32_32x32x16_bf16 v[16:31], a[44:47], v[44:47], v[16:31]
    ds_read_b128 v[40:43], v4 offset:15360
    s_waitcnt lgkmcnt(3)
    v_mfma_f32_32x32x16_bf16 v[16:31], a[48:51], v[48:51], v[16:31]
    s_add_u32 m0, s34, 12288
    ds_read_b128 v[44:47], v4 offset:16384
    s_waitcnt lgkmcnt(3)
    v_mfma_f32_32x32x16_bf16 v[16:31], a[52:55], v[52:55], v[16:31]
    buffer_load_dwordx4 v9, s[4:7], s33 offen sc1 lds
    s_add_u32 s33, s33, 512
    ds_read_b128 v[48:51], v4 offset:17408
    s_waitcnt lgkmcnt(3)
    v_mfma_f32_32x32x16_bf16 v[16:31], a[56:59], v[56:59], v[16:31]
    ds_read_b128 v[52:55], v4 offset:18432
    s_waitcnt lgkmcnt(3)
    v_mfma_f32_32x32x16_bf16 v[16:31], a[60:63], v[40:43], v[16:31]
    ds_read_b128 v[56:59], v4 offset:19456
    s_waitcnt lgkmcnt(3)
    v_mfma_f32_32x32x16_bf16 v[16:31], a[64:67], v[44:47], v[16:31]
    s_add_u32 m0, s34, 16384
    ds_read_b128 v[40:43], v4 offset:20480
    s_waitcnt lgkmcnt(3)
    v_mfma_f32_32x32x16_bf16 v[16:31], a[68:71], v[48:51], v[16:31]
    buffer_load_dwordx4 v9, s[4:7], s33 offen sc1 lds
    s_add_u32 s33, s33, 512
    ds_read_b128 v[44:47], v4 offset:21504
    s_waitcnt lgkmcnt(3)
    v_mfma_f32_32x32x16_bf16 v[16:31], a[72:75], v[52:55], v[16:31]
    ds_read_b128 v[48:51], v4 offset:22528
    s_waitcnt lgkmcnt(3)
    v_mfma_f32_32x32x16_bf16 v[16:31], a[76:79], v[56:59], v[16:31]
    ds_read_b128 v[52:55], v4 offset:23552
    s_waitcnt lgkmcnt(3)
    v_mfma_f32_32x32x16_bf16 v[16:31], a[80:83], v[40:43], v[16:31]
    s_add_u32 m0, s34, 20480
    ds_read_b128 v[56:59], v4 offset:24576
    s_waitcnt lgkmcnt(3)
    v_mfma_f32_32x32x16_bf16 v[16:31], a[84:87], v[44:47], v[16:31]
    buffer_load_dwordx4 v9, s[4:7], s33 offen sc1 lds
    s_add_u32 s33, s33, 512
    ds_read_b128 v[40:43], v4 offset:25600
    s_waitcnt lgkmcnt(3)
    v_mfma_f32_32x32x16_bf16 v[16:31], a[88:91], v[48:51], v[16:31]
    ds_read_b128 v[44:47], v4 offset:26624
    s_waitcnt lgkmcnt(3)
    v_mfma_f32_32x32x16_bf16 v[16:31], a[92:95], v[52:55], v[16:31]
    ds_read_b128 v[48:51], v4 offset:27648
    s_waitcnt lgkmcnt(3)
    v_mfma_f32_32x32x16_bf16 v[16:31], a[96:99], v[56:59], v[16:31]
    s_add_u32 m0, s34, 24576
    ds_read_b128 v[52:55], v4 offset:28672
    s_waitcnt lgkmcnt(3)
    v_mfma_f32_32x32x16_bf16 v[16:31], a[100:103], v[40:43], v[16:31]
    buffer_load_dwordx4 v9, s[4:7], s33 offen sc1 lds
    s_add_u32 s33, s33, 512
    ds_read_b128 v[56:59], v4 offset:29696
    s_waitcnt lgkmcnt(3)
    v_mfma_f32_32x32x16_bf16 v[16:31], a[104:107], v[44:47], v[16:31]
    ds_read_b128 v[40:43], v4 offset:30720
    s_waitcnt lgkmcnt(3)
    v_mfma_f32_32x32x16_bf16 v[16:31], a[108:111], v[48:51], v[16:31]
    ds_read_b128 v[44:47], v4 offset:31744
    s_waitcnt lgkmcnt(3)
    v_mfma_f32_32x32x16_bf16 v[16:31], a[112:115], v[52:55], v[16:31]
    s_add_u32 m0, s34, 28672
    ds_read_b128 v[48:51], v4 offset:32768
    s_waitcnt lgkmcnt(3)
    v_mfma_f32_32x32x16_bf16 v[16:31], a[116:119], v[56:59], v[16:31]
    buffer_load_dwordx4 v9, s[4:7], s33 offen sc1 lds
    s_add_u32 s33, s33, 512
    ds_read_b128 v[52:55], v4 offset:33792
    s_waitcnt lgkmcnt(3)
    v_mfma_f32_32x32x16_bf16 v[16:31], a[120:123], v[40:43], v[16:31]
    ds_read_b128 v[56:59], v4 offset:34816
    s_waitcnt lgkmcnt(3)
    v_mfma_f32_32x32x16_bf16 v[16:31], a[124:127], v[44:47], v[16:31]
    ds_read_b128 v[40:43], v4 offset:35840
    s_waitcnt lgkmcnt(3)
    v_mfma_f32_32x32x16_bf16 v[16:31], a[128:131], v[48:51], v[16:31]
    s_add_u32 m0, s34, 32768
    ds_read_b128 v[44:47], v4 offset:36864
    s_waitcnt lgkmcnt(3)
    v_mfma_f32_32x32x16_bf16 v[16:31], a[132:135], v[52:55], v[16:31]
    buffer_load_dwordx4 v9, s[4:7], s33 offen sc1 lds
    s_add_u32 s33, s33, 512
    ds_read_b128 v[48:51], v4 offset:37888
    s_waitcnt lgkmcnt(3)
    v_mfma_f32_32x32x16_bf16 v[16:31], a[136:139], v[56:59], v[16:31]
    ds_read_b128 v[52:55], v4 offset:38912
    s_waitcnt lgkmcnt(3)
    v_mfma_f32_32x32x16_bf16 v[16:31], a[140:143], v[40:43], v[16:31]
    ds_read_b128 v[56:59], v4 offset:39936
    s_waitcnt lgkmcnt(3)
    v_mfma_f32_32x32x16_bf16 v[16:31], a[144:147], v[44:47], v[16:31]
    s_add_u32 m0, s34, 36864
    s_waitcnt lgkmcnt(2)
    v_mfma_f32_32x32x16_bf16 v[16:31], a[148:151], v[48:51], v[16:31]
    buffer_load_dwordx4 v9, s[4:7], s33 offen sc1 lds
    s_add_u32 s33, s33, 512
    s_waitcnt lgkmcnt(1)
    v_mfma_f32_32x32x16_bf16 v[16:31], a[152:155], v[52:55], v[16:31]
    s_waitcnt lgkmcnt(0)
    v_mfma_f32_32x32x16_bf16 v[16:31], a[156:159], v[56:59], v[16:31]
    s_lshl_b32 s33, s30, 18
    s_add_u32 s33, s33, s59
    s_add_u32 s60, s60, 40960
    s_cmp_ge_u32 s60, 122880
    s_cselect_b32 s60, 0, s60
    s_nop 6
    v_cvt_pk_bf16_f32 v32, v16, v17
    v_cvt_pk_bf16_f32 v33, v18, v19
    v_cvt_pk_bf16_f32 v34, v20, v21
    v_cvt_pk_bf16_f32 v35, v22, v23
    v_cvt_pk_bf16_f32 v36, v24, v25
    v_cvt_pk_bf16_f32 v37, v26, v27
    v_cvt_pk_bf16_f32 v38, v28, v29
    v_cvt_pk_bf16_f32 v39, v30, v31
    buffer_store_dwordx4 v[32:35], v8, s[4:7], s33 offen offset:0 sc1
    buffer_store_dwordx4 v[36:39], v8, s[4:7], s33 offen offset:512 sc1
    s_add_u32 s30, s30, s31
    s_cmp_ge_u32 s30, 4
    s_cbranch_scc1 L_later_3075
    s_waitcnt vmcnt(0)
    s_barrier
    s_cmp_lg_u32 s28, 0
    s_cbranch_scc1 L_sig_3076
    s_add_u32 s33, s96, s30
    v_mov_b32 v252, s33
    v_mov_b32 v253, s97
    s_mov_b64 exec, 1
    buffer_store_dwordx2 v[252:253], off, s[4:7], s99 sc1
    s_mov_b64 exec, -1
L_sig_3076:
L_later_3075:
    s_waitcnt vmcnt(12)
    s_cmp_lt_u32 s30, s32
    s_cbranch_scc1 L_qkv_3072
    s_branch L_qkv_end_3071
L_qkv_v_3070:
L_qkv_3077:
    s_barrier
    s_cmp_lt_u32 s30, 6
    s_cbranch_scc1 L_nopub_3078
    s_sub_u32 s34, s30, s31
    s_cmp_lg_u32 s28, 0
    s_cbranch_scc1 L_sig_3079
    s_add_u32 s33, s96, s34
    v_mov_b32 v252, s33
    v_mov_b32 v253, s97
    s_mov_b64 exec, 1
    buffer_store_dwordx2 v[252:253], off, s[4:7], s99 sc1
    s_mov_b64 exec, -1
L_sig_3079:
L_nopub_3078:
    s_add_u32 s61, s61, s31
    s_add_u32 s35, s60, 81920
    s_cmp_ge_u32 s35, 122880
    s_cselect_b32 s36, 122880, 0
    s_sub_u32 s35, s35, s36
    s_min_u32 s33, s61, 63
    s_mul_i32 s33, s33, 40960
    s_add_u32 s33, s33, 8388608
    s_add_u32 s34, s35, s57
    v_add_u32 v4, s60, v7
    ds_read_b128 v[40:43], v4 offset:0
    ds_read_b128 v[44:47], v4 offset:1024
    ds_read_b128 v[48:51], v4 offset:2048
    ds_read_b128 v[52:55], v4 offset:3072
    s_waitcnt lgkmcnt(3)
    v_mfma_f32_32x32x16_bf16 v[16:31], v[40:43], a[0:3], 0
    s_add_u32 m0, s34, 0
    ds_read_b128 v[56:59], v4 offset:4096
    s_waitcnt lgkmcnt(3)
    v_mfma_f32_32x32x16_bf16 v[16:31], v[44:47], a[4:7], v[16:31]
    buffer_load_dwordx4 v9, s[4:7], s33 offen sc1 lds
    s_add_u32 s33, s33, 512
    ds_read_b128 v[40:43], v4 offset:5120
    s_waitcnt lgkmcnt(3)
    v_mfma_f32_32x32x16_bf16 v[16:31], v[48:51], a[8:11], v[16:31]
    ds_read_b128 v[44:47], v4 offset:6144
    s_waitcnt lgkmcnt(3)
    v_mfma_f32_32x32x16_bf16 v[16:31], v[52:55], a[12:15], v[16:31]
    ds_read_b128 v[48:51], v4 offset:7168
    s_waitcnt lgkmcnt(3)
    v_mfma_f32_32x32x16_bf16 v[16:31], v[56:59], a[16:19], v[16:31]
    s_add_u32 m0, s34, 4096
    ds_read_b128 v[52:55], v4 offset:8192
    s_waitcnt lgkmcnt(3)
    v_mfma_f32_32x32x16_bf16 v[16:31], v[40:43], a[20:23], v[16:31]
    buffer_load_dwordx4 v9, s[4:7], s33 offen sc1 lds
    s_add_u32 s33, s33, 512
    ds_read_b128 v[56:59], v4 offset:9216
    s_waitcnt lgkmcnt(3)
    v_mfma_f32_32x32x16_bf16 v[16:31], v[44:47], a[24:27], v[16:31]
    ds_read_b128 v[40:43], v4 offset:10240
    s_waitcnt lgkmcnt(3)
    v_mfma_f32_32x32x16_bf16 v[16:31], v[48:51], a[28:31], v[16:31]
    ds_read_b128 v[44:47], v4 offset:11264
    s_waitcnt lgkmcnt(3)
    v_mfma_f32_32x32x16_bf16 v[16:31], v[52:55], a[32:35], v[16:31]
    s_add_u32 m0, s34, 8192
    ds_read_b128 v[48:51], v4 offset:12288
    s_waitcnt lgkmcnt(3)
    v_mfma_f32_32x32x16_bf16 v[16:31], v[56:59], a[36:39], v[16:31]
    buffer_load_dwordx4 v9, s[4:7], s33 offen sc1 lds
    s_add_u32 s33, s33, 512
    ds_read_b128 v[52:55], v4 offset:13312
    s_waitcnt lgkmcnt(3)
    v_mfma_f32_32x32x16_bf16 v[16:31], v[40:43], a[40:43], v[16:31]
    ds_read_b128 v[56:59], v4 offset:14336
    s_waitcnt lgkmcnt(3)
    v_mfma_f32_32x32x16_bf16 v[16:31], v[44:47], a[44:47], v[16:31]
    ds_read_b128 v[40:43], v4 offset:15360
    s_waitcnt lgkmcnt(3)
    v_mfma_f32_32x32x16_bf16 v[16:31], v[48:51], a[48:51], v[16:31]
    s_add_u32 m0, s34, 12288
    ds_read_b128 v[44:47], v4 offset:16384
    s_waitcnt lgkmcnt(3)
    v_mfma_f32_32x32x16_bf16 v[16:31], v[52:55], a[52:55], v[16:31]
    buffer_load_dwordx4 v9, s[4:7], s33 offen sc1 lds
    s_add_u32 s33, s33, 512
    ds_read_b128 v[48:51], v4 offset:17408
    s_waitcnt lgkmcnt(3)
    v_mfma_f32_32x32x16_bf16 v[16:31], v[56:59], a[56:59], v[16:31]
    ds_read_b128 v[52:55], v4 offset:18432
    s_waitcnt lgkmcnt(3)
    v_mfma_f32_32x32x16_bf16 v[16:31], v[40:43], a[60:63], v[16:31]
    ds_read_b128 v[56:59], v4 offset:19456
    s_waitcnt lgkmcnt(3)
    v_mfma_f32_32x32x16_bf16 v[16:31], v[44:47], a[64:67], v[16:31]
    s_add_u32 m0, s34, 16384
    ds_read_b128 v[40:43], v4 offset:20480
    s_waitcnt lgkmcnt(3)
    v_mfma_f32_32x32x16_bf16 v[16:31], v[48:51], a[68:71], v[16:31]
    buffer_load_dwordx4 v9, s[4:7], s33 offen sc1 lds
    s_add_u32 s33, s33, 512
    ds_read_b128 v[44:47], v4 offset:21504
    s_waitcnt lgkmcnt(3)
    v_mfma_f32_32x32x16_bf16 v[16:31], v[52:55], a[72:75], v[16:31]
    ds_read_b128 v[48:51], v4 offset:22528
    s_waitcnt lgkmcnt(3)
    v_mfma_f32_32x32x16_bf16 v[16:31], v[56:59], a[76:79], v[16:31]
    ds_read_b128 v[52:55], v4 offset:23552
    s_waitcnt lgkmcnt(3)
    v_mfma_f32_32x32x16_bf16 v[16:31], v[40:43], a[80:83], v[16:31]
    s_add_u32 m0, s34, 20480
    ds_read_b128 v[56:59], v4 offset:24576
    s_waitcnt lgkmcnt(3)
    v_mfma_f32_32x32x16_bf16 v[16:31], v[44:47], a[84:87], v[16:31]
    buffer_load_dwordx4 v9, s[4:7], s33 offen sc1 lds
    s_add_u32 s33, s33, 512
    ds_read_b128 v[40:43], v4 offset:25600
    s_waitcnt lgkmcnt(3)
    v_mfma_f32_32x32x16_bf16 v[16:31], v[48:51], a[88:91], v[16:31]
    ds_read_b128 v[44:47], v4 offset:26624
    s_waitcnt lgkmcnt(3)
    v_mfma_f32_32x32x16_bf16 v[16:31], v[52:55], a[92:95], v[16:31]
    ds_read_b128 v[48:51], v4 offset:27648
    s_waitcnt lgkmcnt(3)
    v_mfma_f32_32x32x16_bf16 v[16:31], v[56:59], a[96:99], v[16:31]
    s_add_u32 m0, s34, 24576
    ds_read_b128 v[52:55], v4 offset:28672
    s_waitcnt lgkmcnt(3)
    v_mfma_f32_32x32x16_bf16 v[16:31], v[40:43], a[100:103], v[16:31]
    buffer_load_dwordx4 v9, s[4:7], s33 offen sc1 lds
    s_add_u32 s33, s33, 512
    ds_read_b128 v[56:59], v4 offset:29696
    s_waitcnt lgkmcnt(3)
    v_mfma_f32_32x32x16_bf16 v[16:31], v[44:47], a[104:107], v[16:31]
    ds_read_b128 v[40:43], v4 offset:30720
    s_waitcnt lgkmcnt(3)
    v_mfma_f32_32x32x16_bf16 v[16:31], v[48:51], a[108:111], v[16:31]
    ds_read_b128 v[44:47], v4 offset:31744
    s_waitcnt lgkmcnt(3)
    v_mfma_f32_32x32x16_bf16 v[16:31], v[52:55], a[112:115], v[16:31]
    s_add_u32 m0, s34, 28672
    ds_read_b128 v[48:51], v4 offset:32768
    s_waitcnt lgkmcnt(3)
    v_mfma_f32_32x32x16_bf16 v[16:31], v[56:59], a[116:119], v[16:31]
    buffer_load_dwordx4 v9, s[4:7], s33 offen sc1 lds
    s_add_u32 s33, s33, 512
    ds_read_b128 v[52:55], v4 offset:33792
    s_waitcnt lgkmcnt(3)
    v_mfma_f32_32x32x16_bf16 v[16:31], v[40:43], a[120:123], v[16:31]
    ds_read_b128 v[56:59], v4 offset:34816
    s_waitcnt lgkmcnt(3)
    v_mfma_f32_32x32x16_bf16 v[16:31], v[44:47], a[124:127], v[16:31]
    ds_read_b128 v[40:43], v4 offset:35840
    s_waitcnt lgkmcnt(3)
    v_mfma_f32_32x32x16_bf16 v[16:31], v[48:51], a[128:131], v[16:31]
    s_add_u32 m0, s34, 32768
    ds_read_b128 v[44:47], v4 offset:36864
    s_waitcnt lgkmcnt(3)
    v_mfma_f32_32x32x16_bf16 v[16:31], v[52:55], a[132:135], v[16:31]
    buffer_load_dwordx4 v9, s[4:7], s33 offen sc1 lds
    s_add_u32 s33, s33, 512
    ds_read_b128 v[48:51], v4 offset:37888
    s_waitcnt lgkmcnt(3)
    v_mfma_f32_32x32x16_bf16 v[16:31], v[56:59], a[136:139], v[16:31]
    ds_read_b128 v[52:55], v4 offset:38912
    s_waitcnt lgkmcnt(3)
    v_mfma_f32_32x32x16_bf16 v[16:31], v[40:43], a[140:143], v[16:31]
    ds_read_b128 v[56:59], v4 offset:39936
    s_waitcnt lgkmcnt(3)
    v_mfma_f32_32x32x16_bf16 v[16:31], v[44:47], a[144:147], v[16:31]
    s_add_u32 m0, s34, 36864
    s_waitcnt lgkmcnt(2)
    v_mfma_f32_32x32x16_bf16 v[16:31], v[48:51], a[148:151], v[16:31]
    buffer_load_dwordx4 v9, s[4:7], s33 offen sc1 lds
    s_add_u32 s33, s33, 512
    s_waitcnt lgkmcnt(1)
    v_mfma_f32_32x32x16_bf16 v[16:31], v[52:55], a[152:155], v[16:31]
    s_waitcnt lgkmcnt(0)
    v_mfma_f32_32x32x16_bf16 v[16:31], v[56:59], a[156:159], v[16:31]
    s_lshl_b32 s33, s30, 18
    s_add_u32 s33, s33, s59
    s_add_u32 s60, s60, 40960
    s_cmp_ge_u32 s60, 122880
    s_cselect_b32 s60, 0, s60
    s_nop 6
    v_cvt_pk_bf16_f32 v32, v16, v17
    v_cvt_pk_bf16_f32 v33, v18, v19
    v_cvt_pk_bf16_f32 v34, v24, v25
    v_cvt_pk_bf16_f32 v35, v26, v27
    v_cvt_pk_bf16_f32 v36, v20, v21
    v_cvt_pk_bf16_f32 v37, v22, v23
    v_cvt_pk_bf16_f32 v38, v28, v29
    v_cvt_pk_bf16_f32 v39, v30, v31
    buffer_store_dwordx4 v[32:35], v8, s[4:7], s33 offen offset:0 sc1
    buffer_store_dwordx4 v[36:39], v8, s[4:7], s33 offen offset:512 sc1
    s_add_u32 s30, s30, s31
    s_cmp_ge_u32 s30, 4
    s_cbranch_scc1 L_later_3080
    s_waitcnt vmcnt(0)
    s_barrier
    s_cmp_lg_u32 s28, 0
    s_cbranch_scc1 L_sig_3081
    s_add_u32 s33, s96, s30
    v_mov_b32 v252, s33
    v_mov_b32 v253, s97
    s_mov_b64 exec, 1
    buffer_store_dwordx2 v[252:253], off, s[4:7], s99 sc1
    s_mov_b64 exec, -1
L_sig_3081:
L_later_3080:
    s_waitcnt vmcnt(12)
    s_cmp_lt_u32 s30, s32
    s_cbranch_scc1 L_qkv_3077
L_qkv_end_3071:
    s_waitcnt vmcnt(0)
    s_waitcnt vmcnt(0)
    s_barrier
    s_cmp_lg_u32 s28, 0
    s_cbranch_scc1 L_sig_3082
    s_add_u32 s33, s96, 255
    v_mov_b32 v252, s33
    v_mov_b32 v253, s97
    s_mov_b64 exec, 1
    buffer_store_dwordx2 v[252:253], off, s[4:7], s99 sc1
    s_mov_b64 exec, -1
L_sig_3082:
    s_cmp_ge_u32 s95, 30
    s_cbranch_scc1 L_plan_3092
    s_sub_u32 s29, s95, 0
    s_mov_b32 s30, 0
    s_mov_b32 s31, 2
    s_branch L_op_3083
L_plan_3092:
    s_cmp_ge_u32 s95, 32
    s_cbranch_scc1 L_plan_3093
    s_sub_u32 s29, s95, 30
    s_mov_b32 s30, 0
    s_mov_b32 s31, 1
    s_branch L_ln4_3090
L_plan_3093:
    s_cmp_ge_u32 s95, 42
    s_cbranch_scc1 L_plan_3094
    s_sub_u32 s29, s95, 2
    s_mov_b32 s30, 0
    s_mov_b32 s31, 2
    s_branch L_op_3083
L_plan_3094:
    s_cmp_ge_u32 s95, 62
    s_cbranch_scc1 L_plan_3095
    s_sub_u32 s29, s95, 42
    s_mov_b32 s30, 1
    s_mov_b32 s31, 2
    s_branch L_op_3083
L_plan_3095:
    s_cmp_ge_u32 s95, 64
    s_cbranch_scc1 L_plan_3096
    s_sub_u32 s29, s95, 60
    s_mov_b32 s30, 0
    s_mov_b32 s31, 1
    s_branch L_ln4_3090
L_plan_3096:
    s_cmp_ge_u32 s95, 84
    s_cbranch_scc1 L_plan_3097
    s_sub_u32 s29, s95, 44
    s_mov_b32 s30, 1
    s_mov_b32 s31, 2
    s_branch L_op_3083
L_plan_3097:
    s_cmp_ge_u32 s95, 94
    s_cbranch_scc1 L_plan_3098
    s_sub_u32 s29, s95, 84
    s_mov_b32 s30, 0
    s_mov_b32 s31, 1
    s_branch L_m1_3084
L_plan_3098:
    s_cmp_ge_u32 s95, 96
    s_cbranch_scc1 L_plan_3099
    s_sub_u32 s29, s95, 90
    s_mov_b32 s30, 0
    s_mov_b32 s31, 1
    s_branch L_ln4_3090
L_plan_3099:
    s_cmp_ge_u32 s95, 123
    s_cbranch_scc1 L_plan_3100
    s_sub_u32 s29, s95, 96
    s_mov_b32 s30, 0
    s_mov_b32 s31, 1
    s_branch L_m3_3086
L_plan_3100:
    s_cmp_ge_u32 s95, 128
    s_cbranch_scc1 L_plan_3101
    s_branch L_fin_3091
L_plan_3101:
    s_cmp_ge_u32 s95, 138
    s_cbranch_scc1 L_plan_3102
    s_sub_u32 s29, s95, 128
    s_mov_b32 s30, 0
    s_mov_b32 s31, 2
    s_branch L_m4_3087
L_plan_3102:
    s_cmp_ge_u32 s95, 148
    s_cbranch_scc1 L_plan_3103
    s_sub_u32 s29, s95, 138
    s_mov_b32 s30, 1
    s_mov_b32 s31, 2
    s_branch L_m4_3087
L_plan_3103:
    s_cmp_ge_u32 s95, 158
    s_cbranch_scc1 L_plan_3104
    s_sub_u32 s29, s95, 148
    s_mov_b32 s30, 0
    s_mov_b32 s31, 1
    s_branch L_m2_3085
L_plan_3104:
    s_cmp_ge_u32 s95, 160
    s_cbranch_scc1 L_plan_3105
    s_sub_u32 s29, s95, 152
    s_mov_b32 s30, 0
    s_mov_b32 s31, 1
    s_branch L_ln4_3090
L_plan_3105:
    s_cmp_ge_u32 s95, 168
    s_cbranch_scc1 L_plan_3106
    s_sub_u32 s29, s95, 160
    s_mov_b32 s30, 0
    s_mov_b32 s31, 2
    s_branch L_at_3088
L_plan_3106:
    s_cmp_ge_u32 s95, 176
    s_cbranch_scc1 L_plan_3107
    s_sub_u32 s29, s95, 168
    s_mov_b32 s30, 1
    s_mov_b32 s31, 2
    s_branch L_at_3088
L_plan_3107:
    s_cmp_ge_u32 s95, 184
    s_cbranch_scc1 L_plan_3108
    s_sub_u32 s29, s95, 176
    s_mov_b32 s30, 0
    s_mov_b32 s31, 2
    s_branch L_ln23_3089
L_plan_3108:
    s_cmp_ge_u32 s95, 192
    s_cbranch_scc1 L_plan_3109
    s_sub_u32 s29, s95, 184
    s_mov_b32 s30, 1
    s_mov_b32 s31, 2
    s_branch L_ln23_3089
L_plan_3109:
L_op_3083:
    s_mov_b32 s63, s29
    s_mul_i32 s33, s30, 40
    s_add_u32 s29, s29, s33
    s_add_u32 s29, s29, 40
    s_load_dwordx2 s[20:21], s[0:1], 96
    s_load_dwordx2 s[22:23], s[0:1], 104
    s_load_dwordx2 s[26:27], s[0:1], 128
    v_lshrrev_b32 v1, 6, v0
    s_nop 0
    v_readfirstlane_b32 s28, v1
    s_waitcnt lgkmcnt(0)
    s_mov_b32 s4, s26
    s_and_b32 s5, s27, 0xffff
    s_mov_b32 s6, 268435456
    s_mov_b32 s7, 0x20000
    s_mov_b32 s8, s20
    s_and_b32 s9, s21, 0xffff
    s_mov_b32 s10, 1280
    s_mov_b32 s11, 0x20000
    s_mov_b32 s12, s22
    s_and_b32 s13, s23, 0xffff
    s_mov_b32 s14, 4915200
    s_mov_b32 s15, 0x20000
    v_lshrrev_b32 v2, 2, v0
    v_mul_u32_u24 v3, 20, v2
    buffer_load_dword v60, v3, s[8:11], 0 offen offset:0
    buffer_load_dword v62, v3, s[8:11], 0 offen offset:4
    buffer_load_dword v64, v3, s[8:11], 0 offen offset:8
    buffer_load_dword v66, v3, s[8:11], 0 offen offset:12
    buffer_load_dword v68, v3, s[8:11], 0 offen offset:16
    v_mul_u32_u24 v3, 76800, v2
    v_and_b32 v4, 3, v0
    v_lshl_add_u32 v3, v4, 4, v3
    s_lshl_b32 s33, s29, 6
    buffer_load_dwordx4 v[16:19], v3, s[12:15], s33 offen
    s_add_u32 s33, s33, 7680
    buffer_load_dwordx4 v[20:23], v3, s[12:15], s33 offen
    s_add_u32 s33, s33, 7680
    buffer_load_dwordx4 v[24:27], v3, s[12:15], s33 offen
    s_add_u32 s33, s33, 7680
    buffer_load_dwordx4 v[28:31], v3, s[12:15], s33 offen
    s_add_u32 s33, s33, 7680
    buffer_load_dwordx4 v[32:35], v3, s[12:15], s33 offen
    s_add_u32 s33, s33, 7680
    buffer_load_dwordx4 v[36:39], v3, s[12:15], s33 offen
    s_add_u32 s33, s33, 7680
    buffer_load_dwordx4 v[40:43], v3, s[12:15], s33 offen
    s_add_u32 s33, s33, 7680
    buffer_load_dwordx4 v[44:47], v3, s[12:15], s33 offen
    s_add_u32 s33, s33, 7680
    buffer_load_dwordx4 v[48:51], v3, s[12:15], s33 offen
    s_add_u32 s33, s33, 7680
    buffer_load_dwordx4 v[52:55], v3, s[12:15], s33 offen
    s_add_u32 s33, s33, 7680
    s_waitcnt vmcnt(10)
    s_mov_b32 s48, 0xbfb8aa3b
    v_and_b32 v61, 0xffff0000, v60
    v_lshlrev_b32 v60, 16, v60
    v_and_b32 v63, 0xffff0000, v62
    v_lshlrev_b32 v62, 16, v62
    v_and_b32 v65, 0xffff0000, v64
    v_lshlrev_b32 v64, 16, v64
    v_and_b32 v67, 0xffff0000, v66
    v_lshlrev_b32 v66, 16, v66
    v_and_b32 v69, 0xffff0000, v68
    v_lshlrev_b32 v68, 16, v68
    v_mul_f32 v4, s48, v60
    v_exp_f32 v4, v4
    s_nop 0
    v_add_f32 v4, 1.0, v4
    v_rcp_f32 v4, v4
    s_nop 0
    v_mul_f32 v60, v60, v4
    v_cvt_pk_bf16_f32 v60, v60, v60
    v_lshlrev_b32 v60, 16, v60
    v_mul_f32 v4, s48, v61
    v_exp_f32 v4, v4
    s_nop 0
    v_add_f32 v4, 1.0, v4
    v_rcp_f32 v4, v4
    s_nop 0
    v_mul_f32 v61, v61, v4
    v_cvt_pk_bf16_f32 v61, v61, v61
    v_lshlrev_b32 v61, 16, v61
    v_mul_f32 v4, s48, v62
    v_exp_f32 v4, v4
    s_nop 0
    v_add_f32 v4, 1.0, v4
    v_rcp_f32 v4, v4
    s_nop 0
    v_mul_f32 v62, v62, v4
    v_cvt_pk_bf16_f32 v62, v62, v62
    v_lshlrev_b32 v62, 16, v62
    v_mul_f32 v4, s48, v63
    v_exp_f32 v4, v4
    s_nop 0
    v_add_f32 v4, 1.0, v4
    v_rcp_f32 v4, v4
    s_nop 0
    v_mul_f32 v63, v63, v4
    v_cvt_pk_bf16_f32 v63, v63, v63
    v_lshlrev_b32 v63, 16, v63
    v_mul_f32 v4, s48, v64
    v_exp_f32 v4, v4
    s_nop 0
    v_add_f32 v4, 1.0, v4
    v_rcp_f32 v4, v4
    s_nop 0
    v_mul_f32 v64, v64, v4
    v_cvt_pk_bf16_f32 v64, v64, v64
    v_lshlrev_b32 v64, 16, v64
    v_mul_f32 v4, s48, v65
    v_exp_f32 v4, v4
    s_nop 0
    v_add_f32 v4, 1.0, v4
    v_rcp_f32 v4, v4
    s_nop 0
    v_mul_f32 v65, v65, v4
    v_cvt_pk_bf16_f32 v65, v65, v65
    v_lshlrev_b32 v65, 16, v65
    v_mul_f32 v4, s48, v66
    v_exp_f32 v4, v4
    s_nop 0
    v_add_f32 v4, 1.0, v4
    v_rcp_f32 v4, v4
    s_nop 0
    v_mul_f32 v66, v66, v4
    v_cvt_pk_bf16_f32 v66, v66, v66
    v_lshlrev_b32 v66, 16, v66
    v_mul_f32 v4, s48, v67
    v_exp_f32 v4, v4
    s_nop 0
    v_add_f32 v4, 1.0, v4
    v_rcp_f32 v4, v4
    s_nop 0
    v_mul_f32 v67, v67, v4
    v_cvt_pk_bf16_f32 v67, v67, v67
    v_lshlrev_b32 v67, 16, v67
    v_mul_f32 v4, s48, v68
    v_exp_f32 v4, v4
    s_nop 0
    v_add_f32 v4, 1.0, v4
    v_rcp_f32 v4, v4
    s_nop 0
    v_mul_f32 v68, v68, v4
    v_cvt_pk_bf16_f32 v68, v68, v68
    v_lshlrev_b32 v68, 16, v68
    v_mul_f32 v4, s48, v69
    v_exp_f32 v4, v4
    s_nop 0
    v_add_f32 v4, 1.0, v4
    v_rcp_f32 v4, v4
    s_nop 0
    v_mul_f32 v69, v69, v4
    v_cvt_pk_bf16_f32 v69, v69, v69
    v_lshlrev_b32 v69, 16, v69
    s_waitcnt vmcnt(9)
    v_and_b32 v5, 0xffff0000, v16
    v_lshlrev_b32 v4, 16, v16
    v_mul_f32 v72, v60, v4
    v_mul_f32 v73, v60, v5
    v_and_b32 v5, 0xffff0000, v17
    v_lshlrev_b32 v4, 16, v17
    v_mul_f32 v74, v60, v4
    v_mul_f32 v75, v60, v5
    v_and_b32 v5, 0xffff0000, v18
    v_lshlrev_b32 v4, 16, v18
    v_mul_f32 v76, v60, v4
    v_mul_f32 v77, v60, v5
    v_and_b32 v5, 0xffff0000, v19
    v_lshlrev_b32 v4, 16, v19
    v_mul_f32 v78, v60, v4
    v_mul_f32 v79, v60, v5
    s_waitcnt vmcnt(8)
    v_and_b32 v5, 0xffff0000, v20
    v_lshlrev_b32 v4, 16, v20
    v_fmac_f32 v72, v61, v4
    v_fmac_f32 v73, v61, v5
    v_and_b32 v5, 0xffff0000, v21
    v_lshlrev_b32 v4, 16, v21
    v_fmac_f32 v74, v61, v4
    v_fmac_f32 v75, v61, v5
    v_and_b32 v5, 0xffff0000, v22
    v_lshlrev_b32 v4, 16, v22
    v_fmac_f32 v76, v61, v4
    v_fmac_f32 v77, v61, v5
    v_and_b32 v5, 0xffff0000, v23
    v_lshlrev_b32 v4, 16, v23
    v_fmac_f32 v78, v61, v4
    v_fmac_f32 v79, v61, v5
    s_waitcnt vmcnt(7)
    v_and_b32 v5, 0xffff0000, v24
    v_lshlrev_b32 v4, 16, v24
    v_fmac_f32 v72, v62, v4
    v_fmac_f32 v73, v62, v5
    v_and_b32 v5, 0xffff0000, v25
    v_lshlrev_b32 v4, 16, v25
    v_fmac_f32 v74, v62, v4
    v_fmac_f32 v75, v62, v5
    v_and_b32 v5, 0xffff0000, v26
    v_lshlrev_b32 v4, 16, v26
    v_fmac_f32 v76, v62, v4
    v_fmac_f32 v77, v62, v5
    v_and_b32 v5, 0xffff0000, v27
    v_lshlrev_b32 v4, 16, v27
    v_fmac_f32 v78, v62, v4
    v_fmac_f32 v79, v62, v5
    s_waitcnt vmcnt(6)
    v_and_b32 v5, 0xffff0000, v28
    v_lshlrev_b32 v4, 16, v28
    v_fmac_f32 v72, v63, v4
    v_fmac_f32 v73, v63, v5
    v_and_b32 v5, 0xffff0000, v29
    v_lshlrev_b32 v4, 16, v29
    v_fmac_f32 v74, v63, v4
    v_fmac_f32 v75, v63, v5
    v_and_b32 v5, 0xffff0000, v30
    v_lshlrev_b32 v4, 16, v30
    v_fmac_f32 v76, v63, v4
    v_fmac_f32 v77, v63, v5
    v_and_b32 v5, 0xffff0000, v31
    v_lshlrev_b32 v4, 16, v31
    v_fmac_f32 v78, v63, v4
    v_fmac_f32 v79, v63, v5
    s_waitcnt vmcnt(5)
    v_and_b32 v5, 0xffff0000, v32
    v_lshlrev_b32 v4, 16, v32
    v_fmac_f32 v72, v64, v4
    v_fmac_f32 v73, v64, v5
    v_and_b32 v5, 0xffff0000, v33
    v_lshlrev_b32 v4, 16, v33
    v_fmac_f32 v74, v64, v4
    v_fmac_f32 v75, v64, v5
    v_and_b32 v5, 0xffff0000, v34
    v_lshlrev_b32 v4, 16, v34
    v_fmac_f32 v76, v64, v4
    v_fmac_f32 v77, v64, v5
    v_and_b32 v5, 0xffff0000, v35
    v_lshlrev_b32 v4, 16, v35
    v_fmac_f32 v78, v64, v4
    v_fmac_f32 v79, v64, v5
    s_waitcnt vmcnt(4)
    v_and_b32 v5, 0xffff0000, v36
    v_lshlrev_b32 v4, 16, v36
    v_fmac_f32 v72, v65, v4
    v_fmac_f32 v73, v65, v5
    v_and_b32 v5, 0xffff0000, v37
    v_lshlrev_b32 v4, 16, v37
    v_fmac_f32 v74, v65, v4
    v_fmac_f32 v75, v65, v5
    v_and_b32 v5, 0xffff0000, v38
    v_lshlrev_b32 v4, 16, v38
    v_fmac_f32 v76, v65, v4
    v_fmac_f32 v77, v65, v5
    v_and_b32 v5, 0xffff0000, v39
    v_lshlrev_b32 v4, 16, v39
    v_fmac_f32 v78, v65, v4
    v_fmac_f32 v79, v65, v5
    s_waitcnt vmcnt(3)
    v_and_b32 v5, 0xffff0000, v40
    v_lshlrev_b32 v4, 16, v40
    v_fmac_f32 v72, v66, v4
    v_fmac_f32 v73, v66, v5
    v_and_b32 v5, 0xffff0000, v41
    v_lshlrev_b32 v4, 16, v41
    v_fmac_f32 v74, v66, v4
    v_fmac_f32 v75, v66, v5
    v_and_b32 v5, 0xffff0000, v42
    v_lshlrev_b32 v4, 16, v42
    v_fmac_f32 v76, v66, v4
    v_fmac_f32 v77, v66, v5
    v_and_b32 v5, 0xffff0000, v43
    v_lshlrev_b32 v4, 16, v43
    v_fmac_f32 v78, v66, v4
    v_fmac_f32 v79, v66, v5
    s_waitcnt vmcnt(2)
    v_and_b32 v5, 0xffff0000, v44
    v_lshlrev_b32 v4, 16, v44
    v_fmac_f32 v72, v67, v4
    v_fmac_f32 v73, v67, v5
    v_and_b32 v5, 0xffff0000, v45
    v_lshlrev_b32 v4, 16, v45
    v_fmac_f32 v74, v67, v4
    v_fmac_f32 v75, v67, v5
    v_and_b32 v5, 0xffff0000, v46
    v_lshlrev_b32 v4, 16, v46
    v_fmac_f32 v76, v67, v4
    v_fmac_f32 v77, v67, v5
    v_and_b32 v5, 0xffff0000, v47
    v_lshlrev_b32 v4, 16, v47
    v_fmac_f32 v78, v67, v4
    v_fmac_f32 v79, v67, v5
    s_waitcnt vmcnt(1)
    v_and_b32 v5, 0xffff0000, v48
    v_lshlrev_b32 v4, 16, v48
    v_fmac_f32 v72, v68, v4
    v_fmac_f32 v73, v68, v5
    v_and_b32 v5, 0xffff0000, v49
    v_lshlrev_b32 v4, 16, v49
    v_fmac_f32 v74, v68, v4
    v_fmac_f32 v75, v68, v5
    v_and_b32 v5, 0xffff0000, v50
    v_lshlrev_b32 v4, 16, v50
    v_fmac_f32 v76, v68, v4
    v_fmac_f32 v77, v68, v5
    v_and_b32 v5, 0xffff0000, v51
    v_lshlrev_b32 v4, 16, v51
    v_fmac_f32 v78, v68, v4
    v_fmac_f32 v79, v68, v5
    s_waitcnt vmcnt(0)
    v_and_b32 v5, 0xffff0000, v52
    v_lshlrev_b32 v4, 16, v52
    v_fmac_f32 v72, v69, v4
    v_fmac_f32 v73, v69, v5
    v_and_b32 v5, 0xffff0000, v53
    v_lshlrev_b32 v4, 16, v53
    v_fmac_f32 v74, v69, v4
    v_fmac_f32 v75, v69, v5
    v_and_b32 v5, 0xffff0000, v54
    v_lshlrev_b32 v4, 16, v54
    v_fmac_f32 v76, v69, v4
    v_fmac_f32 v77, v69, v5
    v_and_b32 v5, 0xffff0000, v55
    v_lshlrev_b32 v4, 16, v55
    v_fmac_f32 v78, v69, v4
    v_fmac_f32 v79, v69, v5
    v_add_f32_dpp v72, v72, v72 row_ror:4 row_mask:0xf bank_mask:0xf
    v_add_f32_dpp v73, v73, v73 row_ror:4 row_mask:0xf bank_mask:0xf
    v_add_f32_dpp v74, v74, v74 row_ror:4 row_mask:0xf bank_mask:0xf
    v_add_f32_dpp v75, v75, v75 row_ror:4 row_mask:0xf bank_mask:0xf
    v_add_f32_dpp v76, v76, v76 row_ror:4 row_mask:0xf bank_mask:0xf
    v_add_f32_dpp v77, v77, v77 row_ror:4 row_mask:0xf bank_mask:0xf
    v_add_f32_dpp v78, v78, v78 row_ror:4 row_mask:0xf bank_mask:0xf
    v_add_f32_dpp v79, v79, v79 row_ror:4 row_mask:0xf bank_mask:0xf
    v_add_f32_dpp v72, v72, v72 row_ror:8 row_mask:0xf bank_mask:0xf
    v_add_f32_dpp v73, v73, v73 row_ror:8 row_mask:0xf bank_mask:0xf
    v_add_f32_dpp v74, v74, v74 row_ror:8 row_mask:0xf bank_mask:0xf
    v_add_f32_dpp v75, v75, v75 row_ror:8 row_mask:0xf bank_mask:0xf
    v_add_f32_dpp v76, v76, v76 row_ror:8 row_mask:0xf bank_mask:0xf
    v_add_f32_dpp v77, v77, v77 row_ror:8 row_mask:0xf bank_mask:0xf
    v_add_f32_dpp v78, v78, v78 row_ror:8 row_mask:0xf bank_mask:0xf
    v_add_f32_dpp v79, v79, v79 row_ror:8 row_mask:0xf bank_mask:0xf
    v_mov_b32 v16, v72
    v_mov_b32 v17, v73
    v_mov_b32 v18, v74
    v_mov_b32 v19, v75
    v_mov_b32 v20, v76
    v_mov_b32 v21, v77
    v_mov_b32 v22, v78
    v_mov_b32 v23, v79
    v_permlane16_swap_b32 v72, v16
    v_permlane16_swap_b32 v73, v17
    v_permlane16_swap_b32 v74, v18
    v_permlane16_swap_b32 v75, v19
    v_permlane16_swap_b32 v76, v20
    v_permlane16_swap_b32 v77, v21
    v_permlane16_swap_b32 v78, v22
    v_permlane16_swap_b32 v79, v23
    v_add_f32 v72, v72, v16
    v_add_f32 v73, v73, v17
    v_add_f32 v74, v74, v18
    v_add_f32 v75, v75, v19
    v_add_f32 v76, v76, v20
    v_add_f32 v77, v77, v21
    v_add_f32 v78, v78, v22
    v_add_f32 v79, v79, v23
    v_mov_b32 v16, v72
    v_mov_b32 v17, v73
    v_mov_b32 v18, v74
    v_mov_b32 v19, v75
    v_mov_b32 v20, v76
    v_mov_b32 v21, v77
    v_mov_b32 v22, v78
    v_mov_b32 v23, v79
    v_permlane32_swap_b32 v72, v16
    v_permlane32_swap_b32 v73, v17
    v_permlane32_swap_b32 v74, v18
    v_permlane32_swap_b32 v75, v19
    v_permlane32_swap_b32 v76, v20
    v_permlane32_swap_b32 v77, v21
    v_permlane32_swap_b32 v78, v22
    v_permlane32_swap_b32 v79, v23
    v_add_f32 v72, v72, v16
    v_add_f32 v73, v73, v17
    v_add_f32 v74, v74, v18
    v_add_f32 v75, v75, v19
    v_add_f32 v76, v76, v20
    v_add_f32 v77, v77, v21
    v_add_f32 v78, v78, v22
    v_add_f32 v79, v79, v23
    v_and_b32 v4, 3, v0
    v_lshlrev_b32 v4, 5, v4
    s_lshl_b32 s33, s28, 7
    v_add_u32 v4, s33, v4
    ds_write_b128 v4, v[72:75]
    ds_write_b128 v4, v[76:79] offset:16
    s_waitcnt lgkmcnt(0)
    s_barrier
    v_and_b32 v4, 31, v0
    v_lshlrev_b32 v4, 2, v4
    ds_read_b32 v16, v4 offset:0
    ds_read_b32 v17, v4 offset:128
    ds_read_b32 v18, v4 offset:256
    ds_read_b32 v19, v4 offset:384
    s_waitcnt lgkmcnt(0)
    v_add_f32 v16, v16, v17
    v_add_f32 v18, v18, v19
    v_add_f32 v16, v16, v18
    v_cvt_pk_bf16_f32 v16, v16, v16
    v_lshlrev_b32 v16, 16, v16
    s_lshl_b32 s33, s29, 7
    s_add_u32 s33, s33, 131072
    s_cmp_lg_u32 s28, 0
    s_cbranch_scc1 L_modst_3110
    buffer_store_dword v16, v4, s[4:7], s33 offen sc1
L_modst_3110:
    s_lshl_b32 s99, s29, 3
    s_add_u32 s99, s99, 4096
    s_waitcnt vmcnt(0)
    s_barrier
    s_cmp_lg_u32 s28, 0
    s_cbranch_scc1 L_sig_3111
    s_add_u32 s33, s96, 1
    v_mov_b32 v252, s33
    v_mov_b32 v253, s97
    s_mov_b64 exec, 1
    buffer_store_dwordx2 v[252:253], off, s[4:7], s99 sc1
    s_mov_b64 exec, -1
L_sig_3111:
    s_mov_b32 s29, s63
    s_mul_i32 s33, s30, 40
    s_add_u32 s33, s33, s29
    s_lshl_b32 s99, s33, 3
    s_add_u32 s99, s99, 14336
    s_load_dwordx2 s[20:21], s[0:1], 40
    s_load_dwordx2 s[22:23], s[0:1], 112
    s_load_dwordx2 s[26:27], s[0:1], 128
    v_lshrrev_b32 v1, 6, v0
    s_nop 0
    v_readfirstlane_b32 s28, v1
    s_waitcnt lgkmcnt(0)
    s_mov_b32 s4, s26
    s_and_b32 s5, s27, 0xffff
    s_mov_b32 s6, 268435456
    s_mov_b32 s7, 0x20000
    s_mul_hi_u32 s57, s29, 0x1999999a
    s_mul_i32 s33, s57, 10
    s_sub_u32 s56, s29, s33
    s_add_u32 s8, s26, 71303168
    s_addc_u32 s9, s27, 0
    s_and_b32 s9, s9, 0xffff
    s_mov_b32 s10, 16777216
    s_mov_b32 s11, 0x20000
    s_mov_b32 s12, s20
    s_and_b32 s13, s21, 0xffff
    s_mov_b32 s14, 5242880
    s_mov_b32 s15, 0x20000
    s_mov_b32 s16, s22
    s_and_b32 s17, s23, 0xffff
    s_mov_b32 s18, 2621440
    s_mov_b32 s19, 0x20000
    s_mov_b32 s40, 0
    s_mov_b32 s41, 4096
    s_mov_b32 s42, 8192
    s_mov_b32 s43, 12288
    s_mov_b32 s44, 16384
    s_mov_b32 s45, 20480
    s_mov_b32 s46, 24576
    v_and_b32 v1, 63, v0
    v_bfe_u32 v3, v0, 4, 2
    v_and_b32 v4, 1, v3
    v_lshlrev_b32 v4, 2, v4
    v_and_b32 v5, 7, v1
    v_xor_b32 v4, v4, v5
    v_lshrrev_b32 v5, 3, v1
    v_mul_u32_u24 v5, 1280, v5
    v_lshl_add_u32 v8, v4, 4, v5
    s_lshl_b32 s33, s57, 2
    s_add_u32 s33, s33, s28
    s_mul_i32 s35, s33, 16384
    s_mul_i32 s58, s33, 327680
    s_lshl_b32 s34, s56, 7
    s_add_u32 s58, s58, s34
    s_mul_i32 s59, s28, 40960
    s_add_u32 m0, s59, 0
    s_nop 0
    buffer_load_dwordx4 v8, s[12:15], s58 offen lds
    s_add_u32 s58, s58, 10240
    s_add_u32 m0, s59, 1024
    s_nop 0
    buffer_load_dwordx4 v8, s[12:15], s58 offen lds
    s_add_u32 s58, s58, 10240
    s_add_u32 m0, s59, 2048
    s_nop 0
    buffer_load_dwordx4 v8, s[12:15], s58 offen lds
    s_add_u32 s58, s58, 10240
    s_add_u32 m0, s59, 3072
    s_nop 0
    buffer_load_dwordx4 v8, s[12:15], s58 offen lds
    s_add_u32 s58, s58, 10240
    s_add_u32 m0, s59, 4096
    s_nop 0
    buffer_load_dwordx4 v8, s[12:15], s58 offen lds
    s_add_u32 s58, s58, 10240
    s_add_u32 m0, s59, 5120
    s_nop 0
    buffer_load_dwordx4 v8, s[12:15], s58 offen lds
    s_add_u32 s58, s58, 10240
    s_add_u32 m0, s59, 6144
    s_nop 0
    buffer_load_dwordx4 v8, s[12:15], s58 offen lds
    s_add_u32 s58, s58, 10240
    s_add_u32 m0, s59, 7168
    s_nop 0
    buffer_load_dwordx4 v8, s[12:15], s58 offen lds
    s_add_u32 s58, s58, 10240
    s_add_u32 m0, s59, 8192
    s_nop 0
    buffer_load_dwordx4 v8, s[12:15], s58 offen lds
    s_add_u32 s58, s58, 10240
    s_add_u32 m0, s59, 9216
    s_nop 0
    buffer_load_dwordx4 v8, s[12:15], s58 offen lds
    s_add_u32 s58, s58, 10240
    s_add_u32 m0, s59, 10240
    s_nop 0
    buffer_load_dwordx4 v8, s[12:15], s58 offen lds
    s_add_u32 s58, s58, 10240
    s_add_u32 m0, s59, 11264
    s_nop 0
    buffer_load_dwordx4 v8, s[12:15], s58 offen lds
    s_add_u32 s58, s58, 10240
    s_add_u32 m0, s59, 12288
    s_nop 0
    buffer_load_dwordx4 v8, s[12:15], s58 offen lds
    s_add_u32 s58, s58, 10240
    s_add_u32 m0, s59, 13312
    s_nop 0
    buffer_load_dwordx4 v8, s[12:15], s58 offen lds
    s_add_u32 s58, s58, 10240
    s_add_u32 m0, s59, 14336
    s_nop 0
    buffer_load_dwordx4 v8, s[12:15], s58 offen lds
    s_add_u32 s58, s58, 10240
    s_add_u32 m0, s59, 15360
    s_nop 0
    buffer_load_dwordx4 v8, s[12:15], s58 offen lds
    s_add_u32 s58, s58, 10240
    s_add_u32 m0, s59, 16384
    s_nop 0
    buffer_load_dwordx4 v8, s[12:15], s58 offen lds
    s_add_u32 s58, s58, 10240
    s_add_u32 m0, s59, 17408
    s_nop 0
    buffer_load_dwordx4 v8, s[12:15], s58 offen lds
    s_add_u32 s58, s58, 10240
    s_add_u32 m0, s59, 18432
    s_nop 0
    buffer_load_dwordx4 v8, s[12:15], s58 offen lds
    s_add_u32 s58, s58, 10240
    s_add_u32 m0, s59, 19456
    s_nop 0
    buffer_load_dwordx4 v8, s[12:15], s58 offen lds
    s_add_u32 s58, s58, 10240
    s_add_u32 m0, s59, 20480
    s_nop 0
    buffer_load_dwordx4 v8, s[12:15], s58 offen lds
    s_add_u32 s58, s58, 10240
    s_add_u32 m0, s59, 21504
    s_nop 0
    buffer_load_dwordx4 v8, s[12:15], s58 offen lds
    s_add_u32 s58, s58, 10240
    s_add_u32 m0, s59, 22528
    s_nop 0
    buffer_load_dwordx4 v8, s[12:15], s58 offen lds
    s_add_u32 s58, s58, 10240
    s_add_u32 m0, s59, 23552
    s_nop 0
    buffer_load_dwordx4 v8, s[12:15], s58 offen lds
    s_add_u32 s58, s58, 10240
    s_add_u32 m0, s59, 24576
    s_nop 0
    buffer_load_dwordx4 v8, s[12:15], s58 offen lds
    s_add_u32 s58, s58, 10240
    s_add_u32 m0, s59, 25600
    s_nop 0
    buffer_load_dwordx4 v8, s[12:15], s58 offen lds
    s_add_u32 s58, s58, 10240
    s_add_u32 m0, s59, 26624
    s_nop 0
    buffer_load_dwordx4 v8, s[12:15], s58 offen lds
    s_add_u32 s58, s58, 10240
    s_add_u32 m0, s59, 27648
    s_nop 0
    buffer_load_dwordx4 v8, s[12:15], s58 offen lds
    s_add_u32 s58, s58, 10240
    s_add_u32 m0, s59, 28672
    s_nop 0
    buffer_load_dwordx4 v8, s[12:15], s58 offen lds
    s_add_u32 s58, s58, 10240
    s_add_u32 m0, s59, 29696
    s_nop 0
    buffer_load_dwordx4 v8, s[12:15], s58 offen lds
    s_add_u32 s58, s58, 10240
    s_add_u32 m0, s59, 30720
    s_nop 0
    buffer_load_dwordx4 v8, s[12:15], s58 offen lds
    s_add_u32 s58, s58, 10240
    s_add_u32 m0, s59, 31744
    s_nop 0
    buffer_load_dwordx4 v8, s[12:15], s58 offen lds
    s_add_u32 s58, s58, 10240
    v_and_b32 v4, 31, v1
    v_lshlrev_b32 v7, 4, v1
    s_mul_i32 s33, s30, 262144
    s_add_u32 s33, s33, s35
    v_add_u32 v7, s33, v7
    v_bfe_u32 v4, v1, 2, 2
    v_lshlrev_b32 v5, 7, v4
    v_lshrrev_b32 v4, 1, v4
    v_lshl_add_u32 v5, v4, 6, v5
    v_lshrrev_b32 v4, 1, v3
    v_lshl_add_u32 v5, v4, 9, v5
    v_and_b32 v4, 1, v3
    v_lshl_add_u32 v5, v4, 5, v5
    v_and_b32 v4, 3, v1
    v_lshl_add_u32 v5, v4, 3, v5
    v_xor_b32 v6, 64, v5
    v_add_u32 v5, s59, v5
    v_add_u32 v6, s59, v6
    s_waitcnt vmcnt(28)
    ds_read_b64_tr_b16 a[0:1], v5 offset:0
    ds_read_b64_tr_b16 a[2:3], v5 offset:1024
    ds_read_b64_tr_b16 a[4:5], v6 offset:0
    ds_read_b64_tr_b16 a[6:7], v6 offset:1024
    ds_read_b64_tr_b16 a[8:9], v5 offset:2048
    ds_read_b64_tr_b16 a[10:11], v5 offset:3072
    ds_read_b64_tr_b16 a[12:13], v6 offset:2048
    ds_read_b64_tr_b16 a[14:15], v6 offset:3072
    s_waitcnt vmcnt(24)
    ds_read_b64_tr_b16 a[16:17], v5 offset:4096
    ds_read_b64_tr_b16 a[18:19], v5 offset:5120
    ds_read_b64_tr_b16 a[20:21], v6 offset:4096
    ds_read_b64_tr_b16 a[22:23], v6 offset:5120
    ds_read_b64_tr_b16 a[24:25], v5 offset:6144
    ds_read_b64_tr_b16 a[26:27], v5 offset:7168
    ds_read_b64_tr_b16 a[28:29], v6 offset:6144
    ds_read_b64_tr_b16 a[30:31], v6 offset:7168
    s_waitcnt vmcnt(20)
    ds_read_b64_tr_b16 a[32:33], v5 offset:8192
    ds_read_b64_tr_b16 a[34:35], v5 offset:9216
    ds_read_b64_tr_b16 a[36:37], v6 offset:8192
    ds_read_b64_tr_b16 a[38:39], v6 offset:9216
    ds_read_b64_tr_b16 a[40:41], v5 offset:10240
    ds_read_b64_tr_b16 a[42:43], v5 offset:11264
    ds_read_b64_tr_b16 a[44:45], v6 offset:10240
    ds_read_b64_tr_b16 a[46:47], v6 offset:11264
    s_waitcnt vmcnt(16)
    ds_read_b64_tr_b16 a[48:49], v5 offset:12288
    ds_read_b64_tr_b16 a[50:51], v5 offset:13312
    ds_read_b64_tr_b16 a[52:53], v6 offset:12288
    ds_read_b64_tr_b16 a[54:55], v6 offset:13312
    ds_read_b64_tr_b16 a[56:57], v5 offset:14336
    ds_read_b64_tr_b16 a[58:59], v5 offset:15360
    ds_read_b64_tr_b16 a[60:61], v6 offset:14336
    ds_read_b64_tr_b16 a[62:63], v6 offset:15360
    s_waitcnt vmcnt(12)
    ds_read_b64_tr_b16 a[64:65], v5 offset:16384
    ds_read_b64_tr_b16 a[66:67], v5 offset:17408
    ds_read_b64_tr_b16 a[68:69], v6 offset:16384
    ds_read_b64_tr_b16 a[70:71], v6 offset:17408
    ds_read_b64_tr_b16 a[72:73], v5 offset:18432
    ds_read_b64_tr_b16 a[74:75], v5 offset:19456
    ds_read_b64_tr_b16 a[76:77], v6 offset:18432
    ds_read_b64_tr_b16 a[78:79], v6 offset:19456
    s_waitcnt vmcnt(8)
    ds_read_b64_tr_b16 a[80:81], v5 offset:20480
    ds_read_b64_tr_b16 a[82:83], v5 offset:21504
    ds_read_b64_tr_b16 a[84:85], v6 offset:20480
    ds_read_b64_tr_b16 a[86:87], v6 offset:21504
    ds_read_b64_tr_b16 a[88:89], v5 offset:22528
    ds_read_b64_tr_b16 a[90:91], v5 offset:23552
    ds_read_b64_tr_b16 a[92:93], v6 offset:22528
    ds_read_b64_tr_b16 a[94:95], v6 offset:23552
    s_waitcnt vmcnt(4)
    ds_read_b64_tr_b16 a[96:97], v5 offset:24576
    ds_read_b64_tr_b16 a[98:99], v5 offset:25600
    ds_read_b64_tr_b16 a[100:101], v6 offset:24576
    ds_read_b64_tr_b16 a[102:103], v6 offset:25600
    ds_read_b64_tr_b16 a[104:105], v5 offset:26624
    ds_read_b64_tr_b16 a[106:107], v5 offset:27648
    ds_read_b64_tr_b16 a[108:109], v6 offset:26624
    ds_read_b64_tr_b16 a[110:111], v6 offset:27648
    s_waitcnt vmcnt(0)
    ds_read_b64_tr_b16 a[112:113], v5 offset:28672
    ds_read_b64_tr_b16 a[114:115], v5 offset:29696
    ds_read_b64_tr_b16 a[116:117], v6 offset:28672
    ds_read_b64_tr_b16 a[118:119], v6 offset:29696
    ds_read_b64_tr_b16 a[120:121], v5 offset:30720
    ds_read_b64_tr_b16 a[122:123], v5 offset:31744
    ds_read_b64_tr_b16 a[124:125], v6 offset:30720
    ds_read_b64_tr_b16 a[126:127], v6 offset:31744
    v_lshrrev_b32 v4, 5, v1
    v_mul_u32_u24 v4, 544, v4
    v_and_b32 v5, 31, v1
    v_lshl_add_u32 v4, v5, 4, v4
    s_mul_i32 s33, s28, 8704
    v_add_u32 v8, s33, v4
    v_and_b32 v4, 7, v1
    v_lshrrev_b32 v5, 3, v1
    s_lshl_b32 s33, s28, 3
    v_add_u32 v5, s33, v5
    v_mul_u32_u24 v9, 544, v4
    v_lshl_add_u32 v9, v5, 4, v9
    v_mul_u32_u24 v11, 1280, v5
    v_lshl_add_u32 v11, v4, 3, v11
    s_lshl_b32 s33, s56, 7
    v_add_u32 v11, s33, v11
    v_lshlrev_b32 v10, 1, v11
    s_mul_i32 s33, s57, 5242880
    v_add_u32 v10, s33, v10
    s_waitcnt lgkmcnt(0)
    s_barrier
    s_mov_b32 s60, 0
    s_mul_i32 s62, s31, 262144
    s_mov_b32 s37, 0
    s_waitcnt vmcnt(0)
L_op_3112:
    s_cmp_lg_u32 s37, 0
    s_cbranch_scc1 L_have_3113
    s_and_b32 s38, s30, 1
    s_mul_i32 s38, s38, 64
    s_add_u32 s38, s38, 12288
    s_lshl_b32 s39, s57, 4
    s_add_u32 s38, s38, s39
    s_add_u32 s39, s30, 1
    s_cmp_lg_u32 s28, 0
    s_cbranch_scc1 L_wf_3114
    v_and_b32 v254, 63, v0
    v_min_u32 v254, 1, v254
    v_lshlrev_b32 v254, 3, v254
L_poll_3115:
    buffer_load_dwordx2 v[252:253], v254, s[4:7], s38 offen sc1
    s_waitcnt vmcnt(0)
    v_subrev_u32 v252, s96, v252
    v_xor_b32 v253, s97, v253
    v_lshrrev_b32 v255, 8, v252
    v_or_b32 v253, v253, v255
    v_cmp_eq_u32 vcc, 0, v253
    s_nop 1
    v_cndmask_b32 v252, 0, v252, vcc
    v_cmp_gt_u32 vcc, s39, v252
    s_cbranch_vccz L_ok_3116
    s_sleep 2
    s_sub_u32 s98, s98, 1
    s_cbranch_scc0 L_poll_3115
    s_mov_b32 s98, 0
L_ok_3116:
L_wf_3114:
    s_barrier
    buffer_load_dwordx4 v[92:95], v7, s[8:11], s40 offen offset:0 sc1
    buffer_load_dwordx4 v[96:99], v7, s[8:11], s40 offen offset:1024 sc1
    buffer_load_dwordx4 v[100:103], v7, s[8:11], s40 offen offset:2048 sc1
    buffer_load_dwordx4 v[104:107], v7, s[8:11], s40 offen offset:3072 sc1
    buffer_load_dwordx4 v[108:111], v7, s[8:11], s41 offen offset:0 sc1
    buffer_load_dwordx4 v[112:115], v7, s[8:11], s41 offen offset:1024 sc1
    buffer_load_dwordx4 v[116:119], v7, s[8:11], s41 offen offset:2048 sc1
    buffer_load_dwordx4 v[120:123], v7, s[8:11], s41 offen offset:3072 sc1
    buffer_load_dwordx4 v[124:127], v7, s[8:11], s42 offen offset:0 sc1
    buffer_load_dwordx4 v[128:131], v7, s[8:11], s42 offen offset:1024 sc1
    buffer_load_dwordx4 v[132:135], v7, s[8:11], s42 offen offset:2048 sc1
    buffer_load_dwordx4 v[136:139], v7, s[8:11], s42 offen offset:3072 sc1
    buffer_load_dwordx4 v[140:143], v7, s[8:11], s43 offen offset:0 sc1
    buffer_load_dwordx4 v[144:147], v7, s[8:11], s43 offen offset:1024 sc1
    buffer_load_dwordx4 v[148:151], v7, s[8:11], s43 offen offset:2048 sc1
    buffer_load_dwordx4 v[152:155], v7, s[8:11], s43 offen offset:3072 sc1
L_have_3113:
    v_add_u32 v7, s62, v7
    s_mul_i32 s61, s30, 81920
    s_add_u32 s61, s61, 130023424
    s_add_u32 s37, s30, s31
    s_and_b32 s38, s37, 1
    s_mul_i32 s38, s38, 64
    s_add_u32 s38, s38, 12288
    s_lshl_b32 s39, s57, 4
    s_add_u32 s38, s38, s39
    s_add_u32 s39, s37, 1
    s_cmp_lt_u32 s37, s32
    s_cselect_b32 s39, s39, 256
    s_cmp_eq_u32 s28, 0
    s_cselect_b64 exec, -1, 0
    buffer_load_dwordx2 v[252:253], v254, s[4:7], s38 offen sc1
    s_mov_b64 exec, -1
    s_waitcnt vmcnt(16)
    v_mfma_f32_32x32x16_bf16 v[12:27], a[0:3], v[92:95], 0
    v_mfma_f32_32x32x16_bf16 v[28:43], a[4:7], v[92:95], 0
    s_waitcnt vmcnt(15)
    v_mfma_f32_32x32x16_bf16 v[12:27], a[8:11], v[96:99], v[12:27]
    v_mfma_f32_32x32x16_bf16 v[28:43], a[12:15], v[96:99], v[28:43]
    s_waitcnt vmcnt(14)
    v_mfma_f32_32x32x16_bf16 v[12:27], a[16:19], v[100:103], v[12:27]
    v_mfma_f32_32x32x16_bf16 v[28:43], a[20:23], v[100:103], v[28:43]
    s_waitcnt vmcnt(13)
    v_mfma_f32_32x32x16_bf16 v[12:27], a[24:27], v[104:107], v[12:27]
    v_mfma_f32_32x32x16_bf16 v[28:43], a[28:31], v[104:107], v[28:43]
    s_waitcnt vmcnt(12)
    v_mfma_f32_32x32x16_bf16 v[12:27], a[32:35], v[108:111], v[12:27]
    v_mfma_f32_32x32x16_bf16 v[28:43], a[36:39], v[108:111], v[28:43]
    s_waitcnt vmcnt(11)
    v_mfma_f32_32x32x16_bf16 v[12:27], a[40:43], v[112:115], v[12:27]
    v_mfma_f32_32x32x16_bf16 v[28:43], a[44:47], v[112:115], v[28:43]
    s_waitcnt vmcnt(10)
    v_mfma_f32_32x32x16_bf16 v[12:27], a[48:51], v[116:119], v[12:27]
    v_mfma_f32_32x32x16_bf16 v[28:43], a[52:55], v[116:119], v[28:43]
    s_waitcnt vmcnt(9)
    v_mfma_f32_32x32x16_bf16 v[12:27], a[56:59], v[120:123], v[12:27]
    v_mfma_f32_32x32x16_bf16 v[28:43], a[60:63], v[120:123], v[28:43]
    s_waitcnt vmcnt(8)
    v_mfma_f32_32x32x16_bf16 v[12:27], a[64:67], v[124:127], v[12:27]
    v_mfma_f32_32x32x16_bf16 v[28:43], a[68:71], v[124:127], v[28:43]
    s_waitcnt vmcnt(7)
    v_mfma_f32_32x32x16_bf16 v[12:27], a[72:75], v[128:131], v[12:27]
    v_mfma_f32_32x32x16_bf16 v[28:43], a[76:79], v[128:131], v[28:43]
    s_waitcnt vmcnt(6)
    v_mfma_f32_32x32x16_bf16 v[12:27], a[80:83], v[132:135], v[12:27]
    v_mfma_f32_32x32x16_bf16 v[28:43], a[84:87], v[132:135], v[28:43]
    s_waitcnt vmcnt(5)
    v_mfma_f32_32x32x16_bf16 v[12:27], a[88:91], v[136:139], v[12:27]
    v_mfma_f32_32x32x16_bf16 v[28:43], a[92:95], v[136:139], v[28:43]
    s_waitcnt vmcnt(4)
    v_mfma_f32_32x32x16_bf16 v[12:27], a[96:99], v[140:143], v[12:27]
    v_mfma_f32_32x32x16_bf16 v[28:43], a[100:103], v[140:143], v[28:43]
    s_waitcnt vmcnt(3)
    v_mfma_f32_32x32x16_bf16 v[12:27], a[104:107], v[144:147], v[12:27]
    v_mfma_f32_32x32x16_bf16 v[28:43], a[108:111], v[144:147], v[28:43]
    s_waitcnt vmcnt(2)
    v_mfma_f32_32x32x16_bf16 v[12:27], a[112:115], v[148:151], v[12:27]
    v_mfma_f32_32x32x16_bf16 v[28:43], a[116:119], v[148:151], v[28:43]
    s_waitcnt vmcnt(1)
    v_mfma_f32_32x32x16_bf16 v[12:27], a[120:123], v[152:155], v[12:27]
    v_mfma_f32_32x32x16_bf16 v[28:43], a[124:127], v[152:155], v[28:43]
    s_waitcnt vmcnt(0)
    s_cmp_lg_u32 s28, 0
    s_cbranch_scc1 L_verd_3117
    v_subrev_u32 v252, s96, v252
    v_xor_b32 v253, s97, v253
    v_lshrrev_b32 v255, 8, v252
    v_or_b32 v253, v253, v255
    v_cmp_eq_u32 vcc, 0, v253
    s_nop 1
    v_cndmask_b32 v252, 0, v252, vcc
    v_cmp_gt_u32 vcc, s39, v252
    s_nop 0
    s_cmp_eq_u64 vcc, 0
    s_cselect_b32 s37, 1, 0
    v_mov_b32 v252, s37
    v_mov_b32 v253, 81920
    ds_write_b32 v253, v252
L_verd_3117:
    v_add_u32 v4, s60, v8
    v_add_u32 v5, s60, v9
    s_nop 5
    ds_write_b128 v4, v[12:15] offset:0
    ds_write_b128 v4, v[16:19] offset:1088
    ds_write_b128 v4, v[20:23] offset:2176
    ds_write_b128 v4, v[24:27] offset:3264
    ds_write_b128 v4, v[28:31] offset:4352
    ds_write_b128 v4, v[32:35] offset:5440
    ds_write_b128 v4, v[36:39] offset:6528
    ds_write_b128 v4, v[40:43] offset:7616
    s_xor_b32 s60, s60, 34816
    s_waitcnt lgkmcnt(0)
    s_barrier
    v_mov_b32 v253, 81920
    ds_read_b32 v252, v253
    ds_read_b128 v[44:47], v5 offset:0
    ds_read_b128 v[48:51], v5 offset:4352
    ds_read_b128 v[52:55], v5 offset:8704
    ds_read_b128 v[56:59], v5 offset:13056
    ds_read_b128 v[60:63], v5 offset:17408
    ds_read_b128 v[64:67], v5 offset:21760
    ds_read_b128 v[68:71], v5 offset:26112
    ds_read_b128 v[72:75], v5 offset:30464
    s_waitcnt lgkmcnt(8)
    v_readfirstlane_b32 s37, v252
    s_nop 0
    s_cmp_eq_u32 s37, 0
    s_cbranch_scc1 L_noah_3118
    buffer_load_dwordx4 v[92:95], v7, s[8:11], s40 offen offset:0 sc1
    buffer_load_dwordx4 v[96:99], v7, s[8:11], s40 offen offset:1024 sc1
    buffer_load_dwordx4 v[100:103], v7, s[8:11], s40 offen offset:2048 sc1
    buffer_load_dwordx4 v[104:107], v7, s[8:11], s40 offen offset:3072 sc1
    buffer_load_dwordx4 v[108:111], v7, s[8:11], s41 offen offset:0 sc1
    buffer_load_dwordx4 v[112:115], v7, s[8:11], s41 offen offset:1024 sc1
    buffer_load_dwordx4 v[116:119], v7, s[8:11], s41 offen offset:2048 sc1
    buffer_load_dwordx4 v[120:123], v7, s[8:11], s41 offen offset:3072 sc1
    buffer_load_dwordx4 v[124:127], v7, s[8:11], s42 offen offset:0 sc1
    buffer_load_dwordx4 v[128:131], v7, s[8:11], s42 offen offset:1024 sc1
    buffer_load_dwordx4 v[132:135], v7, s[8:11], s42 offen offset:2048 sc1
    buffer_load_dwordx4 v[136:139], v7, s[8:11], s42 offen offset:3072 sc1
    buffer_load_dwordx4 v[140:143], v7, s[8:11], s43 offen offset:0 sc1
    buffer_load_dwordx4 v[144:147], v7, s[8:11], s43 offen offset:1024 sc1
    buffer_load_dwordx4 v[148:151], v7, s[8:11], s43 offen offset:2048 sc1
    buffer_load_dwordx4 v[152:155], v7, s[8:11], s43 offen offset:3072 sc1
L_noah_3118:
    s_waitcnt lgkmcnt(4)
    v_add_f32 v44, v44, v52
    v_add_f32 v45, v45, v53
    v_add_f32 v46, v46, v54
    v_add_f32 v47, v47, v55
    v_add_f32 v48, v48, v56
    v_add_f32 v49, v49, v57
    v_add_f32 v50, v50, v58
    v_add_f32 v51, v51, v59
    s_waitcnt lgkmcnt(0)
    v_add_f32 v60, v60, v68
    v_add_f32 v61, v61, v69
    v_add_f32 v62, v62, v70
    v_add_f32 v63, v63, v71
    v_add_f32 v64, v64, v72
    v_add_f32 v65, v65, v73
    v_add_f32 v66, v66, v74
    v_add_f32 v67, v67, v75
    v_add_f32 v44, v44, v60
    v_add_f32 v45, v45, v61
    v_add_f32 v46, v46, v62
    v_add_f32 v47, v47, v63
    v_add_f32 v48, v48, v64
    v_add_f32 v49, v49, v65
    v_add_f32 v50, v50, v66
    v_add_f32 v51, v51, v67
    buffer_store_dwordx4 v[44:47], v10, s[4:7], s61 offen offset:0 sc1
    buffer_store_dwordx4 v[48:51], v10, s[4:7], s61 offen offset:128 sc1
    s_add_u32 s34, s30, s31
    s_waitcnt vmcnt(0)
    s_barrier
    s_cmp_lg_u32 s28, 0
    s_cbranch_scc1 L_sig_3119
    s_add_u32 s33, s96, s34
    v_mov_b32 v252, s33
    v_mov_b32 v253, s97
    s_mov_b64 exec, 1
    buffer_store_dwordx2 v[252:253], off, s[4:7], s99 sc1
    s_mov_b64 exec, -1
L_sig_3119:
    s_add_u32 s30, s30, s31
    s_cmp_lt_u32 s30, s32
    s_cbranch_scc1 L_op_3112
    s_waitcnt vmcnt(0)
    s_branch L_fin_3091
L_m1_3084:
    s_mul_i32 s33, s30, 0
    s_add_u32 s33, s33, s29
    s_lshl_b32 s99, s33, 3
    s_add_u32 s99, s99, 18432
    s_load_dwordx2 s[20:21], s[0:1], 64
    s_load_dwordx2 s[22:23], s[0:1], 112
    s_load_dwordx2 s[26:27], s[0:1], 128
    v_lshrrev_b32 v1, 6, v0
    s_nop 0
    v_readfirstlane_b32 s28, v1
    s_waitcnt lgkmcnt(0)
    s_mov_b32 s4, s26
    s_and_b32 s5, s27, 0xffff
    s_mov_b32 s6, 268435456
    s_mov_b32 s7, 0x20000
    s_mov_b32 s57, 0
    s_mov_b32 s56, s29
    s_add_u32 s8, s26, 96468992
    s_addc_u32 s9, s27, 0
    s_and_b32 s9, s9, 0xffff
    s_mov_b32 s10, 2621440
    s_mov_b32 s11, 0x20000
    s_mov_b32 s12, s20
    s_and_b32 s13, s21, 0xffff
    s_mov_b32 s14, 819200
    s_mov_b32 s15, 0x20000
    s_mov_b32 s16, s22
    s_and_b32 s17, s23, 0xffff
    s_mov_b32 s18, 2621440
    s_mov_b32 s19, 0x20000
    s_mov_b32 s40, 0
    s_mov_b32 s41, 4096
    s_mov_b32 s42, 8192
    s_mov_b32 s43, 12288
    s_mov_b32 s44, 16384
    s_mov_b32 s45, 20480
    s_mov_b32 s46, 24576
    v_and_b32 v1, 63, v0
    v_bfe_u32 v3, v0, 4, 2
    v_and_b32 v4, 1, v3
    v_lshlrev_b32 v4, 2, v4
    v_and_b32 v5, 7, v1
    v_xor_b32 v4, v4, v5
    v_lshrrev_b32 v5, 3, v1
    v_mul_u32_u24 v5, 1280, v5
    v_lshl_add_u32 v8, v4, 4, v5
    s_lshl_b32 s33, s57, 2
    s_add_u32 s33, s33, s28
    s_mul_i32 s35, s33, 1280
    s_mul_i32 s58, s33, 204800
    s_lshl_b32 s34, s56, 7
    s_add_u32 s58, s58, s34
    s_mul_i32 s59, s28, 40960
    s_add_u32 m0, s59, 0
    s_nop 0
    buffer_load_dwordx4 v8, s[12:15], s58 offen lds
    s_add_u32 s58, s58, 10240
    s_add_u32 m0, s59, 1024
    s_nop 0
    buffer_load_dwordx4 v8, s[12:15], s58 offen lds
    s_add_u32 s58, s58, 10240
    s_add_u32 m0, s59, 2048
    s_nop 0
    buffer_load_dwordx4 v8, s[12:15], s58 offen lds
    s_add_u32 s58, s58, 10240
    s_add_u32 m0, s59, 3072
    s_nop 0
    buffer_load_dwordx4 v8, s[12:15], s58 offen lds
    s_add_u32 s58, s58, 10240
    s_add_u32 m0, s59, 4096
    s_nop 0
    buffer_load_dwordx4 v8, s[12:15], s58 offen lds
    s_add_u32 s58, s58, 10240
    s_add_u32 m0, s59, 5120
    s_nop 0
    buffer_load_dwordx4 v8, s[12:15], s58 offen lds
    s_add_u32 s58, s58, 10240
    s_add_u32 m0, s59, 6144
    s_nop 0
    buffer_load_dwordx4 v8, s[12:15], s58 offen lds
    s_add_u32 s58, s58, 10240
    s_add_u32 m0, s59, 7168
    s_nop 0
    buffer_load_dwordx4 v8, s[12:15], s58 offen lds
    s_add_u32 s58, s58, 10240
    s_add_u32 m0, s59, 8192
    s_nop 0
    buffer_load_dwordx4 v8, s[12:15], s58 offen lds
    s_add_u32 s58, s58, 10240
    s_add_u32 m0, s59, 9216
    s_nop 0
    buffer_load_dwordx4 v8, s[12:15], s58 offen lds
    s_add_u32 s58, s58, 10240
    s_add_u32 m0, s59, 10240
    s_nop 0
    buffer_load_dwordx4 v8, s[12:15], s58 offen lds
    s_add_u32 s58, s58, 10240
    s_add_u32 m0, s59, 11264
    s_nop 0
    buffer_load_dwordx4 v8, s[12:15], s58 offen lds
    s_add_u32 s58, s58, 10240
    s_add_u32 m0, s59, 12288
    s_nop 0
    buffer_load_dwordx4 v8, s[12:15], s58 offen lds
    s_add_u32 s58, s58, 10240
    s_add_u32 m0, s59, 13312
    s_nop 0
    buffer_load_dwordx4 v8, s[12:15], s58 offen lds
    s_add_u32 s58, s58, 10240
    s_add_u32 m0, s59, 14336
    s_nop 0
    buffer_load_dwordx4 v8, s[12:15], s58 offen lds
    s_add_u32 s58, s58, 10240
    s_add_u32 m0, s59, 15360
    s_nop 0
    buffer_load_dwordx4 v8, s[12:15], s58 offen lds
    s_add_u32 s58, s58, 10240
    s_add_u32 m0, s59, 16384
    s_nop 0
    buffer_load_dwordx4 v8, s[12:15], s58 offen lds
    s_add_u32 s58, s58, 10240
    s_add_u32 m0, s59, 17408
    s_nop 0
    buffer_load_dwordx4 v8, s[12:15], s58 offen lds
    s_add_u32 s58, s58, 10240
    s_add_u32 m0, s59, 18432
    s_nop 0
    buffer_load_dwordx4 v8, s[12:15], s58 offen lds
    s_add_u32 s58, s58, 10240
    s_add_u32 m0, s59, 19456
    s_nop 0
    buffer_load_dwordx4 v8, s[12:15], s58 offen lds
    s_add_u32 s58, s58, 10240
    v_and_b32 v4, 31, v1
    v_lshrrev_b32 v5, 2, v4
    v_mul_u32_u24 v7, 5120, v5
    v_and_b32 v4, 3, v4
    v_lshl_add_u32 v7, v4, 4, v7
    v_lshrrev_b32 v4, 5, v1
    v_lshl_add_u32 v7, v4, 6, v7
    s_mul_i32 s33, s30, 40960
    s_add_u32 s33, s33, s35
    v_add_u32 v7, s33, v7
    v_bfe_u32 v4, v1, 2, 2
    v_lshlrev_b32 v5, 7, v4
    v_lshrrev_b32 v4, 1, v4
    v_lshl_add_u32 v5, v4, 6, v5
    v_lshrrev_b32 v4, 1, v3
    v_lshl_add_u32 v5, v4, 9, v5
    v_and_b32 v4, 1, v3
    v_lshl_add_u32 v5, v4, 5, v5
    v_and_b32 v4, 3, v1
    v_lshl_add_u32 v5, v4, 3, v5
    v_xor_b32 v6, 64, v5
    v_add_u32 v5, s59, v5
    v_add_u32 v6, s59, v6
    s_waitcnt vmcnt(16)
    ds_read_b64_tr_b16 a[0:1], v5 offset:0
    ds_read_b64_tr_b16 a[2:3], v5 offset:1024
    ds_read_b64_tr_b16 a[4:5], v6 offset:0
    ds_read_b64_tr_b16 a[6:7], v6 offset:1024
    ds_read_b64_tr_b16 a[8:9], v5 offset:2048
    ds_read_b64_tr_b16 a[10:11], v5 offset:3072
    ds_read_b64_tr_b16 a[12:13], v6 offset:2048
    ds_read_b64_tr_b16 a[14:15], v6 offset:3072
    s_waitcnt vmcnt(12)
    ds_read_b64_tr_b16 a[16:17], v5 offset:4096
    ds_read_b64_tr_b16 a[18:19], v5 offset:5120
    ds_read_b64_tr_b16 a[20:21], v6 offset:4096
    ds_read_b64_tr_b16 a[22:23], v6 offset:5120
    ds_read_b64_tr_b16 a[24:25], v5 offset:6144
    ds_read_b64_tr_b16 a[26:27], v5 offset:7168
    ds_read_b64_tr_b16 a[28:29], v6 offset:6144
    ds_read_b64_tr_b16 a[30:31], v6 offset:7168
    s_waitcnt vmcnt(8)
    ds_read_b64_tr_b16 a[32:33], v5 offset:8192
    ds_read_b64_tr_b16 a[34:35], v5 offset:9216
    ds_read_b64_tr_b16 a[36:37], v6 offset:8192
    ds_read_b64_tr_b16 a[38:39], v6 offset:9216
    ds_read_b64_tr_b16 a[40:41], v5 offset:10240
    ds_read_b64_tr_b16 a[42:43], v5 offset:11264
    ds_read_b64_tr_b16 a[44:45], v6 offset:10240
    ds_read_b64_tr_b16 a[46:47], v6 offset:11264
    s_waitcnt vmcnt(4)
    ds_read_b64_tr_b16 a[48:49], v5 offset:12288
    ds_read_b64_tr_b16 a[50:51], v5 offset:13312
    ds_read_b64_tr_b16 a[52:53], v6 offset:12288
    ds_read_b64_tr_b16 a[54:55], v6 offset:13312
    ds_read_b64_tr_b16 a[56:57], v5 offset:14336
    ds_read_b64_tr_b16 a[58:59], v5 offset:15360
    ds_read_b64_tr_b16 a[60:61], v6 offset:14336
    ds_read_b64_tr_b16 a[62:63], v6 offset:15360
    s_waitcnt vmcnt(0)
    ds_read_b64_tr_b16 a[64:65], v5 offset:16384
    ds_read_b64_tr_b16 a[66:67], v5 offset:17408
    ds_read_b64_tr_b16 a[68:69], v6 offset:16384
    ds_read_b64_tr_b16 a[70:71], v6 offset:17408
    ds_read_b64_tr_b16 a[72:73], v5 offset:18432
    ds_read_b64_tr_b16 a[74:75], v5 offset:19456
    ds_read_b64_tr_b16 a[76:77], v6 offset:18432
    ds_read_b64_tr_b16 a[78:79], v6 offset:19456
    v_lshrrev_b32 v4, 5, v1
    v_mul_u32_u24 v4, 544, v4
    v_and_b32 v5, 31, v1
    v_lshl_add_u32 v4, v5, 4, v4
    s_mul_i32 s33, s28, 8704
    v_add_u32 v8, s33, v4
    s_lshr_b32 s33, s28, 1
    s_mul_i32 s33, s33, 4352
    s_and_b32 s34, s28, 1
    s_mul_i32 s34, s34, 2176
    s_add_u32 s33, s33, s34
    v_add_u32 v9, s33, v4
    s_lshl_b32 s33, s56, 2
    s_add_u32 s33, s33, s28
    s_lshl_b32 s33, s33, 10
    v_lshlrev_b32 v10, 4, v1
    v_add_u32 v10, s33, v10
    v_mov_b32 v2, 0xc0135761
    s_mov_b32 s49, 0xbdd2d3e8
    s_waitcnt lgkmcnt(0)
    s_barrier
    s_mov_b32 s60, 0
    s_mul_i32 s62, s31, 40960
    s_mov_b32 s37, 0
    s_waitcnt vmcnt(0)
L_m1_3120:
    s_cmp_lg_u32 s37, 0
    s_cbranch_scc1 L_have_3121
    s_and_b32 s38, s30, 1
    s_mul_i32 s38, s38, 64
    s_add_u32 s38, s38, 16384
    s_add_u32 s39, s30, 1
    s_cmp_lg_u32 s28, 0
    s_cbranch_scc1 L_wf_3122
    v_and_b32 v254, 63, v0
    v_min_u32 v254, 7, v254
    v_lshlrev_b32 v254, 3, v254
L_poll_3123:
    buffer_load_dwordx2 v[252:253], v254, s[4:7], s38 offen sc1
    s_waitcnt vmcnt(0)
    v_subrev_u32 v252, s96, v252
    v_xor_b32 v253, s97, v253
    v_lshrrev_b32 v255, 8, v252
    v_or_b32 v253, v253, v255
    v_cmp_eq_u32 vcc, 0, v253
    s_nop 1
    v_cndmask_b32 v252, 0, v252, vcc
    v_cmp_gt_u32 vcc, s39, v252
    s_cbranch_vccz L_ok_3124
    s_sleep 2
    s_sub_u32 s98, s98, 1
    s_cbranch_scc0 L_poll_3123
    s_mov_b32 s98, 0
L_ok_3124:
L_wf_3122:
    s_barrier
    buffer_load_dwordx4 v[92:95], v7, s[8:11], 0 offen offset:0 sc1
    buffer_load_dwordx4 v[96:99], v7, s[8:11], 0 offen offset:128 sc1
    buffer_load_dwordx4 v[100:103], v7, s[8:11], 0 offen offset:256 sc1
    buffer_load_dwordx4 v[104:107], v7, s[8:11], 0 offen offset:384 sc1
    buffer_load_dwordx4 v[108:111], v7, s[8:11], 0 offen offset:512 sc1
    buffer_load_dwordx4 v[112:115], v7, s[8:11], 0 offen offset:640 sc1
    buffer_load_dwordx4 v[116:119], v7, s[8:11], 0 offen offset:768 sc1
    buffer_load_dwordx4 v[120:123], v7, s[8:11], 0 offen offset:896 sc1
    buffer_load_dwordx4 v[124:127], v7, s[8:11], 0 offen offset:1024 sc1
    buffer_load_dwordx4 v[128:131], v7, s[8:11], 0 offen offset:1152 sc1
L_have_3121:
    v_add_u32 v7, s62, v7
    s_mul_i32 s61, s30, 40960
    s_add_u32 s61, s61, 100663296
    s_add_u32 s37, s30, s31
    s_and_b32 s38, s37, 1
    s_mul_i32 s38, s38, 64
    s_add_u32 s38, s38, 16384
    s_add_u32 s39, s37, 1
    s_cmp_lt_u32 s37, s32
    s_cselect_b32 s39, s39, 256
    s_cmp_eq_u32 s28, 0
    s_cselect_b64 exec, -1, 0
    buffer_load_dwordx2 v[252:253], v254, s[4:7], s38 offen sc1
    s_mov_b64 exec, -1
    s_waitcnt vmcnt(10)
    v_mfma_f32_32x32x16_bf16 v[12:27], a[0:3], v[92:95], 0
    v_mfma_f32_32x32x16_bf16 v[28:43], a[4:7], v[92:95], 0
    s_waitcnt vmcnt(9)
    v_mfma_f32_32x32x16_bf16 v[12:27], a[8:11], v[96:99], v[12:27]
    v_mfma_f32_32x32x16_bf16 v[28:43], a[12:15], v[96:99], v[28:43]
    s_waitcnt vmcnt(8)
    v_mfma_f32_32x32x16_bf16 v[12:27], a[16:19], v[100:103], v[12:27]
    v_mfma_f32_32x32x16_bf16 v[28:43], a[20:23], v[100:103], v[28:43]
    s_waitcnt vmcnt(7)
    v_mfma_f32_32x32x16_bf16 v[12:27], a[24:27], v[104:107], v[12:27]
    v_mfma_f32_32x32x16_bf16 v[28:43], a[28:31], v[104:107], v[28:43]
    s_waitcnt vmcnt(6)
    v_mfma_f32_32x32x16_bf16 v[12:27], a[32:35], v[108:111], v[12:27]
    v_mfma_f32_32x32x16_bf16 v[28:43], a[36:39], v[108:111], v[28:43]
    s_waitcnt vmcnt(5)
    v_mfma_f32_32x32x16_bf16 v[12:27], a[40:43], v[112:115], v[12:27]
    v_mfma_f32_32x32x16_bf16 v[28:43], a[44:47], v[112:115], v[28:43]
    s_waitcnt vmcnt(4)
    v_mfma_f32_32x32x16_bf16 v[12:27], a[48:51], v[116:119], v[12:27]
    v_mfma_f32_32x32x16_bf16 v[28:43], a[52:55], v[116:119], v[28:43]
    s_waitcnt vmcnt(3)
    v_mfma_f32_32x32x16_bf16 v[12:27], a[56:59], v[120:123], v[12:27]
    v_mfma_f32_32x32x16_bf16 v[28:43], a[60:63], v[120:123], v[28:43]
    s_waitcnt vmcnt(2)
    v_mfma_f32_32x32x16_bf16 v[12:27], a[64:67], v[124:127], v[12:27]
    v_mfma_f32_32x32x16_bf16 v[28:43], a[68:71], v[124:127], v[28:43]
    s_waitcnt vmcnt(1)
    v_mfma_f32_32x32x16_bf16 v[12:27], a[72:75], v[128:131], v[12:27]
    v_mfma_f32_32x32x16_bf16 v[28:43], a[76:79], v[128:131], v[28:43]
    s_waitcnt vmcnt(0)
    s_cmp_lg_u32 s28, 0
    s_cbranch_scc1 L_verd_3125
    v_subrev_u32 v252, s96, v252
    v_xor_b32 v253, s97, v253
    v_lshrrev_b32 v255, 8, v252
    v_or_b32 v253, v253, v255
    v_cmp_eq_u32 vcc, 0, v253
    s_nop 1
    v_cndmask_b32 v252, 0, v252, vcc
    v_cmp_gt_u32 vcc, s39, v252
    s_nop 0
    s_cmp_eq_u64 vcc, 0
    s_cselect_b32 s37, 1, 0
    v_mov_b32 v252, s37
    v_mov_b32 v253, 81920
    ds_write_b32 v253, v252
L_verd_3125:
    v_add_u32 v4, s60, v8
    v_add_u32 v5, s60, v9
    s_nop 5
    ds_write_b128 v4, v[12:15] offset:0
    ds_write_b128 v4, v[16:19] offset:1088
    ds_write_b128 v4, v[20:23] offset:2176
    ds_write_b128 v4, v[24:27] offset:3264
    ds_write_b128 v4, v[28:31] offset:4352
    ds_write_b128 v4, v[32:35] offset:5440
    ds_write_b128 v4, v[36:39] offset:6528
    ds_write_b128 v4, v[40:43] offset:7616
    s_xor_b32 s60, s60, 34816
    s_waitcnt lgkmcnt(0)
    s_barrier
    v_mov_b32 v253, 81920
    ds_read_b32 v252, v253
    ds_read_b128 v[44:47], v5 offset:0
    ds_read_b128 v[48:51], v5 offset:1088
    ds_read_b128 v[52:55], v5 offset:8704
    ds_read_b128 v[56:59], v5 offset:9792
    ds_read_b128 v[60:63], v5 offset:17408
    ds_read_b128 v[64:67], v5 offset:18496
    ds_read_b128 v[68:71], v5 offset:26112
    ds_read_b128 v[72:75], v5 offset:27200
    s_waitcnt lgkmcnt(8)
    v_readfirstlane_b32 s37, v252
    s_nop 0
    s_cmp_eq_u32 s37, 0
    s_cbranch_scc1 L_noah_3126
    buffer_load_dwordx4 v[92:95], v7, s[8:11], 0 offen offset:0 sc1
    buffer_load_dwordx4 v[96:99], v7, s[8:11], 0 offen offset:128 sc1
    buffer_load_dwordx4 v[100:103], v7, s[8:11], 0 offen offset:256 sc1
    buffer_load_dwordx4 v[104:107], v7, s[8:11], 0 offen offset:384 sc1
    buffer_load_dwordx4 v[108:111], v7, s[8:11], 0 offen offset:512 sc1
    buffer_load_dwordx4 v[112:115], v7, s[8:11], 0 offen offset:640 sc1
    buffer_load_dwordx4 v[116:119], v7, s[8:11], 0 offen offset:768 sc1
    buffer_load_dwordx4 v[120:123], v7, s[8:11], 0 offen offset:896 sc1
    buffer_load_dwordx4 v[124:127], v7, s[8:11], 0 offen offset:1024 sc1
    buffer_load_dwordx4 v[128:131], v7, s[8:11], 0 offen offset:1152 sc1
L_noah_3126:
    s_waitcnt lgkmcnt(4)
    v_add_f32 v44, v44, v52
    v_add_f32 v45, v45, v53
    v_add_f32 v46, v46, v54
    v_add_f32 v47, v47, v55
    v_add_f32 v48, v48, v56
    v_add_f32 v49, v49, v57
    v_add_f32 v50, v50, v58
    v_add_f32 v51, v51, v59
    s_waitcnt lgkmcnt(0)
    v_add_f32 v60, v60, v68
    v_add_f32 v61, v61, v69
    v_add_f32 v62, v62, v70
    v_add_f32 v63, v63, v71
    v_add_f32 v64, v64, v72
    v_add_f32 v65, v65, v73
    v_add_f32 v66, v66, v74
    v_add_f32 v67, v67, v75
    v_add_f32 v44, v44, v60
    v_add_f32 v45, v45, v61
    v_add_f32 v46, v46, v62
    v_add_f32 v47, v47, v63
    v_add_f32 v48, v48, v64
    v_add_f32 v49, v49, v65
    v_add_f32 v50, v50, v66
    v_add_f32 v51, v51, v67
    v_cvt_pk_bf16_f32 v52, v44, v45
    v_lshlrev_b32 v44, 16, v52
    v_and_b32 v45, 0xffff0000, v52
    v_cvt_pk_bf16_f32 v53, v46, v47
    v_lshlrev_b32 v46, 16, v53
    v_and_b32 v47, 0xffff0000, v53
    v_cvt_pk_bf16_f32 v54, v48, v49
    v_lshlrev_b32 v48, 16, v54
    v_and_b32 v49, 0xffff0000, v54
    v_cvt_pk_bf16_f32 v55, v50, v51
    v_lshlrev_b32 v50, 16, v55
    v_and_b32 v51, 0xffff0000, v55
    v_mul_f32 v60, v44, v44
    v_fma_f32 v60, v60, s49, v2
    v_mul_f32 v60, v60, v44
    v_exp_f32 v60, v60
    s_nop 0
    v_add_f32 v60, 1.0, v60
    v_rcp_f32 v60, v60
    s_nop 0
    v_mul_f32 v44, v44, v60
    v_mul_f32 v61, v45, v45
    v_fma_f32 v61, v61, s49, v2
    v_mul_f32 v61, v61, v45
    v_exp_f32 v61, v61
    s_nop 0
    v_add_f32 v61, 1.0, v61
    v_rcp_f32 v61, v61
    s_nop 0
    v_mul_f32 v45, v45, v61
    v_mul_f32 v62, v46, v46
    v_fma_f32 v62, v62, s49, v2
    v_mul_f32 v62, v62, v46
    v_exp_f32 v62, v62
    s_nop 0
    v_add_f32 v62, 1.0, v62
    v_rcp_f32 v62, v62
    s_nop 0
    v_mul_f32 v46, v46, v62
    v_mul_f32 v63, v47, v47
    v_fma_f32 v63, v63, s49, v2
    v_mul_f32 v63, v63, v47
    v_exp_f32 v63, v63
    s_nop 0
    v_add_f32 v63, 1.0, v63
    v_rcp_f32 v63, v63
    s_nop 0
    v_mul_f32 v47, v47, v63
    v_mul_f32 v64, v48, v48
    v_fma_f32 v64, v64, s49, v2
    v_mul_f32 v64, v64, v48
    v_exp_f32 v64, v64
    s_nop 0
    v_add_f32 v64, 1.0, v64
    v_rcp_f32 v64, v64
    s_nop 0
    v_mul_f32 v48, v48, v64
    v_mul_f32 v65, v49, v49
    v_fma_f32 v65, v65, s49, v2
    v_mul_f32 v65, v65, v49
    v_exp_f32 v65, v65
    s_nop 0
    v_add_f32 v65, 1.0, v65
    v_rcp_f32 v65, v65
    s_nop 0
    v_mul_f32 v49, v49, v65
    v_mul_f32 v66, v50, v50
    v_fma_f32 v66, v66, s49, v2
    v_mul_f32 v66, v66, v50
    v_exp_f32 v66, v66
    s_nop 0
    v_add_f32 v66, 1.0, v66
    v_rcp_f32 v66, v66
    s_nop 0
    v_mul_f32 v50, v50, v66
    v_mul_f32 v67, v51, v51
    v_fma_f32 v67, v67, s49, v2
    v_mul_f32 v67, v67, v51
    v_exp_f32 v67, v67
    s_nop 0
    v_add_f32 v67, 1.0, v67
    v_rcp_f32 v67, v67
    s_nop 0
    v_mul_f32 v51, v51, v67
    v_cvt_pk_bf16_f32 v52, v44, v45
    v_cvt_pk_bf16_f32 v53, v46, v47
    v_cvt_pk_bf16_f32 v54, v48, v49
    v_cvt_pk_bf16_f32 v55, v50, v51
    buffer_store_dwordx4 v[52:55], v10, s[4:7], s61 offen sc1
    s_add_u32 s34, s30, s31
    s_waitcnt vmcnt(0)
    s_barrier
    s_cmp_lg_u32 s28, 0
    s_cbranch_scc1 L_sig_3127
    s_add_u32 s33, s96, s34
    v_mov_b32 v252, s33
    v_mov_b32 v253, s97
    s_mov_b64 exec, 1
    buffer_store_dwordx2 v[252:253], off, s[4:7], s99 sc1
    s_mov_b64 exec, -1
L_sig_3127:
    s_add_u32 s30, s30, s31
    s_cmp_lt_u32 s30, s32
    s_cbranch_scc1 L_m1_3120
    s_waitcnt vmcnt(0)
    s_branch L_fin_3091
L_m2_3085:
    s_mul_i32 s33, s30, 0
    s_add_u32 s33, s33, s29
    s_lshl_b32 s99, s33, 3
    s_add_u32 s99, s99, 20480
    s_load_dwordx2 s[20:21], s[0:1], 72
    s_load_dwordx2 s[22:23], s[0:1], 112
    s_load_dwordx2 s[26:27], s[0:1], 128
    v_lshrrev_b32 v1, 6, v0
    s_nop 0
    v_readfirstlane_b32 s28, v1
    s_waitcnt lgkmcnt(0)
    s_mov_b32 s4, s26
    s_and_b32 s5, s27, 0xffff
    s_mov_b32 s6, 268435456
    s_mov_b32 s7, 0x20000
    s_mov_b32 s57, 0
    s_mov_b32 s56, s29
    s_add_u32 s8, s26, 100663296
    s_addc_u32 s9, s27, 0
    s_and_b32 s9, s9, 0xffff
    s_mov_b32 s10, 2621440
    s_mov_b32 s11, 0x20000
    s_mov_b32 s12, s20
    s_and_b32 s13, s21, 0xffff
    s_mov_b32 s14, 819200
    s_mov_b32 s15, 0x20000
    s_mov_b32 s16, s22
    s_and_b32 s17, s23, 0xffff
    s_mov_b32 s18, 2621440
    s_mov_b32 s19, 0x20000
    s_mov_b32 s40, 0
    s_mov_b32 s41, 4096
    s_mov_b32 s42, 8192
    s_mov_b32 s43, 12288
    s_mov_b32 s44, 16384
    s_mov_b32 s45, 20480
    s_mov_b32 s46, 24576
    v_and_b32 v1, 63, v0
    v_bfe_u32 v3, v0, 4, 2
    v_and_b32 v4, 1, v3
    v_lshlrev_b32 v4, 2, v4
    v_and_b32 v5, 7, v1
    v_xor_b32 v4, v4, v5
    v_lshrrev_b32 v5, 3, v1
    v_mul_u32_u24 v5, 1280, v5
    v_lshl_add_u32 v8, v4, 4, v5
    s_lshl_b32 s33, s57, 2
    s_add_u32 s33, s33, s28
    s_mul_i32 s35, s33, 10240
    s_mul_i32 s58, s33, 204800
    s_lshl_b32 s34, s56, 7
    s_add_u32 s58, s58, s34
    s_mul_i32 s59, s28, 40960
    s_add_u32 m0, s59, 0
    s_nop 0
    buffer_load_dwordx4 v8, s[12:15], s58 offen lds
    s_add_u32 s58, s58, 10240
    s_add_u32 m0, s59, 1024
    s_nop 0
    buffer_load_dwordx4 v8, s[12:15], s58 offen lds
    s_add_u32 s58, s58, 10240
    s_add_u32 m0, s59, 2048
    s_nop 0
    buffer_load_dwordx4 v8, s[12:15], s58 offen lds
    s_add_u32 s58, s58, 10240
    s_add_u32 m0, s59, 3072
    s_nop 0
    buffer_load_dwordx4 v8, s[12:15], s58 offen lds
    s_add_u32 s58, s58, 10240
    s_add_u32 m0, s59, 4096
    s_nop 0
    buffer_load_dwordx4 v8, s[12:15], s58 offen lds
    s_add_u32 s58, s58, 10240
    s_add_u32 m0, s59, 5120
    s_nop 0
    buffer_load_dwordx4 v8, s[12:15], s58 offen lds
    s_add_u32 s58, s58, 10240
    s_add_u32 m0, s59, 6144
    s_nop 0
    buffer_load_dwordx4 v8, s[12:15], s58 offen lds
    s_add_u32 s58, s58, 10240
    s_add_u32 m0, s59, 7168
    s_nop 0
    buffer_load_dwordx4 v8, s[12:15], s58 offen lds
    s_add_u32 s58, s58, 10240
    s_add_u32 m0, s59, 8192
    s_nop 0
    buffer_load_dwordx4 v8, s[12:15], s58 offen lds
    s_add_u32 s58, s58, 10240
    s_add_u32 m0, s59, 9216
    s_nop 0
    buffer_load_dwordx4 v8, s[12:15], s58 offen lds
    s_add_u32 s58, s58, 10240
    s_add_u32 m0, s59, 10240
    s_nop 0
    buffer_load_dwordx4 v8, s[12:15], s58 offen lds
    s_add_u32 s58, s58, 10240
    s_add_u32 m0, s59, 11264
    s_nop 0
    buffer_load_dwordx4 v8, s[12:15], s58 offen lds
    s_add_u32 s58, s58, 10240
    s_add_u32 m0, s59, 12288
    s_nop 0
    buffer_load_dwordx4 v8, s[12:15], s58 offen lds
    s_add_u32 s58, s58, 10240
    s_add_u32 m0, s59, 13312
    s_nop 0
    buffer_load_dwordx4 v8, s[12:15], s58 offen lds
    s_add_u32 s58, s58, 10240
    s_add_u32 m0, s59, 14336
    s_nop 0
    buffer_load_dwordx4 v8, s[12:15], s58 offen lds
    s_add_u32 s58, s58, 10240
    s_add_u32 m0, s59, 15360
    s_nop 0
    buffer_load_dwordx4 v8, s[12:15], s58 offen lds
    s_add_u32 s58, s58, 10240
    s_add_u32 m0, s59, 16384
    s_nop 0
    buffer_load_dwordx4 v8, s[12:15], s58 offen lds
    s_add_u32 s58, s58, 10240
    s_add_u32 m0, s59, 17408
    s_nop 0
    buffer_load_dwordx4 v8, s[12:15], s58 offen lds
    s_add_u32 s58, s58, 10240
    s_add_u32 m0, s59, 18432
    s_nop 0
    buffer_load_dwordx4 v8, s[12:15], s58 offen lds
    s_add_u32 s58, s58, 10240
    s_add_u32 m0, s59, 19456
    s_nop 0
    buffer_load_dwordx4 v8, s[12:15], s58 offen lds
    s_add_u32 s58, s58, 10240
    v_and_b32 v4, 31, v1
    s_lshr_b32 s33, s28, 1
    s_add_u32 s33, s33, 1
    s_sub_u32 s34, 0, s33
    s_bitcmp1_b32 s28, 0
    s_cselect_b32 s33, s33, s34
    v_add_u32 v4, s33, v4
    v_ashrrev_i32 v5, 5, v4
    v_mul_i32_i24 v5, 40960, v5
    v_and_b32 v4, 31, v4
    v_lshl_add_u32 v7, v4, 4, v5
    v_lshrrev_b32 v4, 5, v1
    v_lshl_add_u32 v7, v4, 9, v7
    s_mul_i32 s33, s30, 40960
    s_add_u32 s33, s33, s35
    v_add_u32 v7, s33, v7
    v_bfe_u32 v4, v1, 2, 2
    v_lshlrev_b32 v5, 7, v4
    v_lshrrev_b32 v4, 1, v4
    v_lshl_add_u32 v5, v4, 6, v5
    v_lshrrev_b32 v4, 1, v3
    v_lshl_add_u32 v5, v4, 9, v5
    v_and_b32 v4, 1, v3
    v_lshl_add_u32 v5, v4, 5, v5
    v_and_b32 v4, 3, v1
    v_lshl_add_u32 v5, v4, 3, v5
    v_xor_b32 v6, 64, v5
    v_add_u32 v5, s59, v5
    v_add_u32 v6, s59, v6
    s_waitcnt vmcnt(16)
    ds_read_b64_tr_b16 a[0:1], v5 offset:0
    ds_read_b64_tr_b16 a[2:3], v5 offset:1024
    ds_read_b64_tr_b16 a[4:5], v6 offset:0
    ds_read_b64_tr_b16 a[6:7], v6 offset:1024
    ds_read_b64_tr_b16 a[8:9], v5 offset:2048
    ds_read_b64_tr_b16 a[10:11], v5 offset:3072
    ds_read_b64_tr_b16 a[12:13], v6 offset:2048
    ds_read_b64_tr_b16 a[14:15], v6 offset:3072
    s_waitcnt vmcnt(12)
    ds_read_b64_tr_b16 a[16:17], v5 offset:4096
    ds_read_b64_tr_b16 a[18:19], v5 offset:5120
    ds_read_b64_tr_b16 a[20:21], v6 offset:4096
    ds_read_b64_tr_b16 a[22:23], v6 offset:5120
    ds_read_b64_tr_b16 a[24:25], v5 offset:6144
    ds_read_b64_tr_b16 a[26:27], v5 offset:7168
    ds_read_b64_tr_b16 a[28:29], v6 offset:6144
    ds_read_b64_tr_b16 a[30:31], v6 offset:7168
    s_waitcnt vmcnt(8)
    ds_read_b64_tr_b16 a[32:33], v5 offset:8192
    ds_read_b64_tr_b16 a[34:35], v5 offset:9216
    ds_read_b64_tr_b16 a[36:37], v6 offset:8192
    ds_read_b64_tr_b16 a[38:39], v6 offset:9216
    ds_read_b64_tr_b16 a[40:41], v5 offset:10240
    ds_read_b64_tr_b16 a[42:43], v5 offset:11264
    ds_read_b64_tr_b16 a[44:45], v6 offset:10240
    ds_read_b64_tr_b16 a[46:47], v6 offset:11264
    s_waitcnt vmcnt(4)
    ds_read_b64_tr_b16 a[48:49], v5 offset:12288
    ds_read_b64_tr_b16 a[50:51], v5 offset:13312
    ds_read_b64_tr_b16 a[52:53], v6 offset:12288
    ds_read_b64_tr_b16 a[54:55], v6 offset:13312
    ds_read_b64_tr_b16 a[56:57], v5 offset:14336
    ds_read_b64_tr_b16 a[58:59], v5 offset:15360
    ds_read_b64_tr_b16 a[60:61], v6 offset:14336
    ds_read_b64_tr_b16 a[62:63], v6 offset:15360
    s_waitcnt vmcnt(0)
    ds_read_b64_tr_b16 a[64:65], v5 offset:16384
    ds_read_b64_tr_b16 a[66:67], v5 offset:17408
    ds_read_b64_tr_b16 a[68:69], v6 offset:16384
    ds_read_b64_tr_b16 a[70:71], v6 offset:17408
    ds_read_b64_tr_b16 a[72:73], v5 offset:18432
    ds_read_b64_tr_b16 a[74:75], v5 offset:19456
    ds_read_b64_tr_b16 a[76:77], v6 offset:18432
    ds_read_b64_tr_b16 a[78:79], v6 offset:19456
    v_lshrrev_b32 v4, 5, v1
    v_mul_u32_u24 v4, 544, v4
    v_and_b32 v5, 31, v1
    v_lshl_add_u32 v4, v5, 4, v4
    s_mul_i32 s33, s28, 8704
    v_add_u32 v8, s33, v4
    v_and_b32 v4, 7, v1
    v_lshrrev_b32 v5, 3, v1
    s_lshl_b32 s33, s28, 3
    v_add_u32 v5, s33, v5
    v_mul_u32_u24 v9, 544, v4
    v_lshl_add_u32 v9, v5, 4, v9
    v_mul_u32_u24 v11, 1280, v5
    v_lshl_add_u32 v11, v4, 3, v11
    s_lshl_b32 s33, s56, 7
    v_add_u32 v11, s33, v11
    s_waitcnt lgkmcnt(0)
    s_barrier
    s_mov_b32 s60, 0
    s_mul_i32 s62, s31, 40960
    s_mov_b32 s37, 0
    s_waitcnt vmcnt(0)
L_m2_3128:
    s_cmp_lg_u32 s37, 0
    s_cbranch_scc1 L_have_3129
    s_mov_b32 s38, 18432
    s_add_u32 s39, s30, 2
    s_min_u32 s39, s39, 64
    s_cmp_lg_u32 s28, 0
    s_cbranch_scc1 L_wf_3130
    v_and_b32 v254, 63, v0
    v_min_u32 v254, 9, v254
    v_lshlrev_b32 v254, 3, v254
L_poll_3131:
    buffer_load_dwordx2 v[252:253], v254, s[4:7], s38 offen sc1
    s_waitcnt vmcnt(0)
    v_subrev_u32 v252, s96, v252
    v_xor_b32 v253, s97, v253
    v_lshrrev_b32 v255, 8, v252
    v_or_b32 v253, v253, v255
    v_cmp_eq_u32 vcc, 0, v253
    s_nop 1
    v_cndmask_b32 v252, 0, v252, vcc
    v_cmp_gt_u32 vcc, s39, v252
    s_cbranch_vccz L_ok_3132
    s_sleep 2
    s_sub_u32 s98, s98, 1
    s_cbranch_scc0 L_poll_3131
    s_mov_b32 s98, 0
L_ok_3132:
L_wf_3130:
    s_barrier
    buffer_load_dwordx4 v[92:95], v7, s[8:11], s40 offen offset:0 sc1
    buffer_load_dwordx4 v[96:99], v7, s[8:11], s40 offen offset:1024 sc1
    buffer_load_dwordx4 v[100:103], v7, s[8:11], s40 offen offset:2048 sc1
    buffer_load_dwordx4 v[104:107], v7, s[8:11], s40 offen offset:3072 sc1
    buffer_load_dwordx4 v[108:111], v7, s[8:11], s41 offen offset:0 sc1
    buffer_load_dwordx4 v[112:115], v7, s[8:11], s41 offen offset:1024 sc1
    buffer_load_dwordx4 v[116:119], v7, s[8:11], s41 offen offset:2048 sc1
    buffer_load_dwordx4 v[120:123], v7, s[8:11], s41 offen offset:3072 sc1
    buffer_load_dwordx4 v[124:127], v7, s[8:11], s42 offen offset:0 sc1
    buffer_load_dwordx4 v[128:131], v7, s[8:11], s42 offen offset:1024 sc1
L_have_3129:
    v_add_u32 v7, s62, v7
    s_mul_i32 s61, s30, 40960
    s_add_u32 s33, s61, 92274688
    buffer_load_dwordx2 v[76:77], v11, s[4:7], s33 offen offset:0 sc1
    buffer_load_dwordx2 v[78:79], v11, s[4:7], s33 offen offset:64 sc1
    s_add_u32 s61, s61, 104857600
    s_add_u32 s37, s30, s31
    s_mov_b32 s38, 18432
    s_add_u32 s39, s37, 2
    s_min_u32 s39, s39, 64
    s_cmp_lt_u32 s37, s32
    s_cselect_b32 s39, s39, 256
    s_cmp_eq_u32 s28, 0
    s_cselect_b64 exec, -1, 0
    buffer_load_dwordx2 v[252:253], v254, s[4:7], s38 offen sc1
    s_mov_b64 exec, -1
    s_waitcnt vmcnt(12)
    v_mfma_f32_32x32x16_bf16 v[12:27], a[0:3], v[92:95], 0
    v_mfma_f32_32x32x16_bf16 v[28:43], a[4:7], v[92:95], 0
    s_waitcnt vmcnt(11)
    v_mfma_f32_32x32x16_bf16 v[12:27], a[8:11], v[96:99], v[12:27]
    v_mfma_f32_32x32x16_bf16 v[28:43], a[12:15], v[96:99], v[28:43]
    s_waitcnt vmcnt(10)
    v_mfma_f32_32x32x16_bf16 v[12:27], a[16:19], v[100:103], v[12:27]
    v_mfma_f32_32x32x16_bf16 v[28:43], a[20:23], v[100:103], v[28:43]
    s_waitcnt vmcnt(9)
    v_mfma_f32_32x32x16_bf16 v[12:27], a[24:27], v[104:107], v[12:27]
    v_mfma_f32_32x32x16_bf16 v[28:43], a[28:31], v[104:107], v[28:43]
    s_waitcnt vmcnt(8)
    v_mfma_f32_32x32x16_bf16 v[12:27], a[32:35], v[108:111], v[12:27]
    v_mfma_f32_32x32x16_bf16 v[28:43], a[36:39], v[108:111], v[28:43]
    s_waitcnt vmcnt(7)
    v_mfma_f32_32x32x16_bf16 v[12:27], a[40:43], v[112:115], v[12:27]
    v_mfma_f32_32x32x16_bf16 v[28:43], a[44:47], v[112:115], v[28:43]
    s_waitcnt vmcnt(6)
    v_mfma_f32_32x32x16_bf16 v[12:27], a[48:51], v[116:119], v[12:27]
    v_mfma_f32_32x32x16_bf16 v[28:43], a[52:55], v[116:119], v[28:43]
    s_waitcnt vmcnt(5)
    v_mfma_f32_32x32x16_bf16 v[12:27], a[56:59], v[120:123], v[12:27]
    v_mfma_f32_32x32x16_bf16 v[28:43], a[60:63], v[120:123], v[28:43]
    s_waitcnt vmcnt(4)
    v_mfma_f32_32x32x16_bf16 v[12:27], a[64:67], v[124:127], v[12:27]
    v_mfma_f32_32x32x16_bf16 v[28:43], a[68:71], v[124:127], v[28:43]
    s_waitcnt vmcnt(3)
    v_mfma_f32_32x32x16_bf16 v[12:27], a[72:75], v[128:131], v[12:27]
    v_mfma_f32_32x32x16_bf16 v[28:43], a[76:79], v[128:131], v[28:43]
    s_waitcnt vmcnt(0)
    s_cmp_lg_u32 s28, 0
    s_cbranch_scc1 L_verd_3133
    v_subrev_u32 v252, s96, v252
    v_xor_b32 v253, s97, v253
    v_lshrrev_b32 v255, 8, v252
    v_or_b32 v253, v253, v255
    v_cmp_eq_u32 vcc, 0, v253
    s_nop 1
    v_cndmask_b32 v252, 0, v252, vcc
    v_cmp_gt_u32 vcc, s39, v252
    s_nop 0
    s_cmp_eq_u64 vcc, 0
    s_cselect_b32 s37, 1, 0
    v_mov_b32 v252, s37
    v_mov_b32 v253, 81920
    ds_write_b32 v253, v252
L_verd_3133:
    v_add_u32 v4, s60, v8
    v_add_u32 v5, s60, v9
    s_nop 5
    ds_write_b128 v4, v[12:15] offset:0
    ds_write_b128 v4, v[16:19] offset:1088
    ds_write_b128 v4, v[20:23] offset:2176
    ds_write_b128 v4, v[24:27] offset:3264
    ds_write_b128 v4, v[28:31] offset:4352
    ds_write_b128 v4, v[32:35] offset:5440
    ds_write_b128 v4, v[36:39] offset:6528
    ds_write_b128 v4, v[40:43] offset:7616
    s_xor_b32 s60, s60, 34816
    s_waitcnt lgkmcnt(0)
    s_barrier
    v_mov_b32 v253, 81920
    ds_read_b32 v252, v253
    ds_read_b128 v[44:47], v5 offset:0
    ds_read_b128 v[48:51], v5 offset:4352
    ds_read_b128 v[52:55], v5 offset:8704
    ds_read_b128 v[56:59], v5 offset:13056
    ds_read_b128 v[60:63], v5 offset:17408
    ds_read_b128 v[64:67], v5 offset:21760
    ds_read_b128 v[68:71], v5 offset:26112
    ds_read_b128 v[72:75], v5 offset:30464
    s_waitcnt lgkmcnt(8)
    v_readfirstlane_b32 s37, v252
    s_nop 0
    s_cmp_eq_u32 s37, 0
    s_cbranch_scc1 L_noah_3134
    buffer_load_dwordx4 v[92:95], v7, s[8:11], s40 offen offset:0 sc1
    buffer_load_dwordx4 v[96:99], v7, s[8:11], s40 offen offset:1024 sc1
    buffer_load_dwordx4 v[100:103], v7, s[8:11], s40 offen offset:2048 sc1
    buffer_load_dwordx4 v[104:107], v7, s[8:11], s40 offen offset:3072 sc1
    buffer_load_dwordx4 v[108:111], v7, s[8:11], s41 offen offset:0 sc1
    buffer_load_dwordx4 v[112:115], v7, s[8:11], s41 offen offset:1024 sc1
    buffer_load_dwordx4 v[116:119], v7, s[8:11], s41 offen offset:2048 sc1
    buffer_load_dwordx4 v[120:123], v7, s[8:11], s41 offen offset:3072 sc1
    buffer_load_dwordx4 v[124:127], v7, s[8:11], s42 offen offset:0 sc1
    buffer_load_dwordx4 v[128:131], v7, s[8:11], s42 offen offset:1024 sc1
L_noah_3134:
    s_waitcnt lgkmcnt(4)
    v_add_f32 v44, v44, v52
    v_add_f32 v45, v45, v53
    v_add_f32 v46, v46, v54
    v_add_f32 v47, v47, v55
    v_add_f32 v48, v48, v56
    v_add_f32 v49, v49, v57
    v_add_f32 v50, v50, v58
    v_add_f32 v51, v51, v59
    s_waitcnt lgkmcnt(0)
    v_add_f32 v60, v60, v68
    v_add_f32 v61, v61, v69
    v_add_f32 v62, v62, v70
    v_add_f32 v63, v63, v71
    v_add_f32 v64, v64, v72
    v_add_f32 v65, v65, v73
    v_add_f32 v66, v66, v74
    v_add_f32 v67, v67, v75
    v_add_f32 v44, v44, v60
    v_add_f32 v45, v45, v61
    v_add_f32 v46, v46, v62
    v_add_f32 v47, v47, v63
    v_add_f32 v48, v48, v64
    v_add_f32 v49, v49, v65
    v_add_f32 v50, v50, v66
    v_add_f32 v51, v51, v67
    v_cvt_pk_bf16_f32 v52, v44, v45
    v_lshlrev_b32 v44, 16, v52
    v_and_b32 v45, 0xffff0000, v52
    v_cvt_pk_bf16_f32 v53, v46, v47
    v_lshlrev_b32 v46, 16, v53
    v_and_b32 v47, 0xffff0000, v53
    v_cvt_pk_bf16_f32 v54, v48, v49
    v_lshlrev_b32 v48, 16, v54
    v_and_b32 v49, 0xffff0000, v54
    v_cvt_pk_bf16_f32 v55, v50, v51
    v_lshlrev_b32 v50, 16, v55
    v_and_b32 v51, 0xffff0000, v55
    v_and_b32 v61, 0xffff0000, v76
    v_lshlrev_b32 v60, 16, v76
    v_and_b32 v63, 0xffff0000, v77
    v_lshlrev_b32 v62, 16, v77
    v_and_b32 v65, 0xffff0000, v78
    v_lshlrev_b32 v64, 16, v78
    v_and_b32 v67, 0xffff0000, v79
    v_lshlrev_b32 v66, 16, v79
    v_add_f32 v44, v44, v60
    v_add_f32 v45, v45, v61
    v_add_f32 v46, v46, v62
    v_add_f32 v47, v47, v63
    v_add_f32 v48, v48, v64
    v_add_f32 v49, v49, v65
    v_add_f32 v50, v50, v66
    v_add_f32 v51, v51, v67
    v_cvt_pk_bf16_f32 v52, v44, v45
    v_cvt_pk_bf16_f32 v53, v46, v47
    v_cvt_pk_bf16_f32 v54, v48, v49
    v_cvt_pk_bf16_f32 v55, v50, v51
    buffer_store_dwordx2 v[52:53], v11, s[4:7], s61 offen offset:0 sc1
    buffer_store_dwordx2 v[54:55], v11, s[4:7], s61 offen offset:64 sc1
    s_add_u32 s34, s30, s31
    s_waitcnt vmcnt(0)
    s_barrier
    s_cmp_lg_u32 s28, 0
    s_cbranch_scc1 L_sig_3135
    s_add_u32 s33, s96, s34
    v_mov_b32 v252, s33
    v_mov_b32 v253, s97
    s_mov_b64 exec, 1
    buffer_store_dwordx2 v[252:253], off, s[4:7], s99 sc1
    s_mov_b64 exec, -1
L_sig_3135:
    s_add_u32 s30, s30, s31
    s_cmp_lt_u32 s30, s32
    s_cbranch_scc1 L_m2_3128
    s_waitcnt vmcnt(0)
    s_branch L_fin_3091
L_m3_3086:
    s_mul_i32 s33, s30, 0
    s_add_u32 s33, s33, s29
    s_lshl_b32 s99, s33, 3
    s_add_u32 s99, s99, 24576
    s_load_dwordx2 s[20:21], s[0:1], 80
    s_load_dwordx2 s[22:23], s[0:1], 112
    s_load_dwordx2 s[26:27], s[0:1], 128
    v_lshrrev_b32 v1, 6, v0
    s_nop 0
    v_readfirstlane_b32 s28, v1
    s_waitcnt lgkmcnt(0)
    s_mov_b32 s4, s26
    s_and_b32 s5, s27, 0xffff
    s_mov_b32 s6, 268435456
    s_mov_b32 s7, 0x20000
    s_mov_b32 s57, 0
    s_mov_b32 s56, s29
    s_add_u32 s8, s26, 109051904
    s_addc_u32 s9, s27, 0
    s_and_b32 s9, s9, 0xffff
    s_mov_b32 s10, 2621440
    s_mov_b32 s11, 0x20000
    s_mov_b32 s12, s20
    s_and_b32 s13, s21, 0xffff
    s_mov_b32 s14, 2211840
    s_mov_b32 s15, 0x20000
    s_mov_b32 s16, s22
    s_and_b32 s17, s23, 0xffff
    s_mov_b32 s18, 2621440
    s_mov_b32 s19, 0x20000
    s_mov_b32 s40, 0
    s_mov_b32 s41, 4096
    s_mov_b32 s42, 8192
    s_mov_b32 s43, 12288
    s_mov_b32 s44, 16384
    s_mov_b32 s45, 20480
    s_mov_b32 s46, 24576
    v_and_b32 v1, 63, v0
    v_bfe_u32 v3, v0, 4, 2
    v_and_b32 v4, 1, v3
    v_lshlrev_b32 v4, 2, v4
    v_and_b32 v5, 7, v1
    v_xor_b32 v4, v4, v5
    v_lshrrev_b32 v5, 3, v1
    v_mul_u32_u24 v5, 3456, v5
    v_lshl_add_u32 v8, v4, 4, v5
    s_lshl_b32 s33, s57, 2
    s_add_u32 s33, s33, s28
    s_mul_i32 s35, s33, 1280
    s_mul_i32 s58, s33, 552960
    s_lshl_b32 s34, s56, 7
    s_add_u32 s58, s58, s34
    s_mul_i32 s59, s28, 40960
    s_add_u32 m0, s59, 0
    s_nop 0
    buffer_load_dwordx4 v8, s[12:15], s58 offen lds
    s_add_u32 s58, s58, 27648
    s_add_u32 m0, s59, 1024
    s_nop 0
    buffer_load_dwordx4 v8, s[12:15], s58 offen lds
    s_add_u32 s58, s58, 27648
    s_add_u32 m0, s59, 2048
    s_nop 0
    buffer_load_dwordx4 v8, s[12:15], s58 offen lds
    s_add_u32 s58, s58, 27648
    s_add_u32 m0, s59, 3072
    s_nop 0
    buffer_load_dwordx4 v8, s[12:15], s58 offen lds
    s_add_u32 s58, s58, 27648
    s_add_u32 m0, s59, 4096
    s_nop 0
    buffer_load_dwordx4 v8, s[12:15], s58 offen lds
    s_add_u32 s58, s58, 27648
    s_add_u32 m0, s59, 5120
    s_nop 0
    buffer_load_dwordx4 v8, s[12:15], s58 offen lds
    s_add_u32 s58, s58, 27648
    s_add_u32 m0, s59, 6144
    s_nop 0
    buffer_load_dwordx4 v8, s[12:15], s58 offen lds
    s_add_u32 s58, s58, 27648
    s_add_u32 m0, s59, 7168
    s_nop 0
    buffer_load_dwordx4 v8, s[12:15], s58 offen lds
    s_add_u32 s58, s58, 27648
    s_add_u32 m0, s59, 8192
    s_nop 0
    buffer_load_dwordx4 v8, s[12:15], s58 offen lds
    s_add_u32 s58, s58, 27648
    s_add_u32 m0, s59, 9216
    s_nop 0
    buffer_load_dwordx4 v8, s[12:15], s58 offen lds
    s_add_u32 s58, s58, 27648
    s_add_u32 m0, s59, 10240
    s_nop 0
    buffer_load_dwordx4 v8, s[12:15], s58 offen lds
    s_add_u32 s58, s58, 27648
    s_add_u32 m0, s59, 11264
    s_nop 0
    buffer_load_dwordx4 v8, s[12:15], s58 offen lds
    s_add_u32 s58, s58, 27648
    s_add_u32 m0, s59, 12288
    s_nop 0
    buffer_load_dwordx4 v8, s[12:15], s58 offen lds
    s_add_u32 s58, s58, 27648
    s_add_u32 m0, s59, 13312
    s_nop 0
    buffer_load_dwordx4 v8, s[12:15], s58 offen lds
    s_add_u32 s58, s58, 27648
    s_add_u32 m0, s59, 14336
    s_nop 0
    buffer_load_dwordx4 v8, s[12:15], s58 offen lds
    s_add_u32 s58, s58, 27648
    s_add_u32 m0, s59, 15360
    s_nop 0
    buffer_load_dwordx4 v8, s[12:15], s58 offen lds
    s_add_u32 s58, s58, 27648
    s_add_u32 m0, s59, 16384
    s_nop 0
    buffer_load_dwordx4 v8, s[12:15], s58 offen lds
    s_add_u32 s58, s58, 27648
    s_add_u32 m0, s59, 17408
    s_nop 0
    buffer_load_dwordx4 v8, s[12:15], s58 offen lds
    s_add_u32 s58, s58, 27648
    s_add_u32 m0, s59, 18432
    s_nop 0
    buffer_load_dwordx4 v8, s[12:15], s58 offen lds
    s_add_u32 s58, s58, 27648
    s_add_u32 m0, s59, 19456
    s_nop 0
    buffer_load_dwordx4 v8, s[12:15], s58 offen lds
    s_add_u32 s58, s58, 27648
    v_and_b32 v4, 31, v1
    v_lshrrev_b32 v5, 2, v4
    v_mul_u32_u24 v7, 5120, v5
    v_and_b32 v4, 3, v4
    v_lshl_add_u32 v7, v4, 4, v7
    v_lshrrev_b32 v4, 5, v1
    v_lshl_add_u32 v7, v4, 6, v7
    s_mul_i32 s33, s30, 40960
    s_add_u32 s33, s33, s35
    v_add_u32 v7, s33, v7
    v_bfe_u32 v4, v1, 2, 2
    v_lshlrev_b32 v5, 7, v4
    v_lshrrev_b32 v4, 1, v4
    v_lshl_add_u32 v5, v4, 6, v5
    v_lshrrev_b32 v4, 1, v3
    v_lshl_add_u32 v5, v4, 9, v5
    v_and_b32 v4, 1, v3
    v_lshl_add_u32 v5, v4, 5, v5
    v_and_b32 v4, 3, v1
    v_lshl_add_u32 v5, v4, 3, v5
    v_xor_b32 v6, 64, v5
    v_add_u32 v5, s59, v5
    v_add_u32 v6, s59, v6
    s_waitcnt vmcnt(16)
    ds_read_b64_tr_b16 a[0:1], v5 offset:0
    ds_read_b64_tr_b16 a[2:3], v5 offset:1024
    ds_read_b64_tr_b16 a[4:5], v6 offset:0
    ds_read_b64_tr_b16 a[6:7], v6 offset:1024
    ds_read_b64_tr_b16 a[8:9], v5 offset:2048
    ds_read_b64_tr_b16 a[10:11], v5 offset:3072
    ds_read_b64_tr_b16 a[12:13], v6 offset:2048
    ds_read_b64_tr_b16 a[14:15], v6 offset:3072
    s_waitcnt vmcnt(12)
    ds_read_b64_tr_b16 a[16:17], v5 offset:4096
    ds_read_b64_tr_b16 a[18:19], v5 offset:5120
    ds_read_b64_tr_b16 a[20:21], v6 offset:4096
    ds_read_b64_tr_b16 a[22:23], v6 offset:5120
    ds_read_b64_tr_b16 a[24:25], v5 offset:6144
    ds_read_b64_tr_b16 a[26:27], v5 offset:7168
    ds_read_b64_tr_b16 a[28:29], v6 offset:6144
    ds_read_b64_tr_b16 a[30:31], v6 offset:7168
    s_waitcnt vmcnt(8)
    ds_read_b64_tr_b16 a[32:33], v5 offset:8192
    ds_read_b64_tr_b16 a[34:35], v5 offset:9216
    ds_read_b64_tr_b16 a[36:37], v6 offset:8192
    ds_read_b64_tr_b16 a[38:39], v6 offset:9216
    ds_read_b64_tr_b16 a[40:41], v5 offset:10240
    ds_read_b64_tr_b16 a[42:43], v5 offset:11264
    ds_read_b64_tr_b16 a[44:45], v6 offset:10240
    ds_read_b64_tr_b16 a[46:47], v6 offset:11264
    s_waitcnt vmcnt(4)
    ds_read_b64_tr_b16 a[48:49], v5 offset:12288
    ds_read_b64_tr_b16 a[50:51], v5 offset:13312
    ds_read_b64_tr_b16 a[52:53], v6 offset:12288
    ds_read_b64_tr_b16 a[54:55], v6 offset:13312
    ds_read_b64_tr_b16 a[56:57], v5 offset:14336
    ds_read_b64_tr_b16 a[58:59], v5 offset:15360
    ds_read_b64_tr_b16 a[60:61], v6 offset:14336
    ds_read_b64_tr_b16 a[62:63], v6 offset:15360
    s_waitcnt vmcnt(0)
    ds_read_b64_tr_b16 a[64:65], v5 offset:16384
    ds_read_b64_tr_b16 a[66:67], v5 offset:17408
    ds_read_b64_tr_b16 a[68:69], v6 offset:16384
    ds_read_b64_tr_b16 a[70:71], v6 offset:17408
    ds_read_b64_tr_b16 a[72:73], v5 offset:18432
    ds_read_b64_tr_b16 a[74:75], v5 offset:19456
    ds_read_b64_tr_b16 a[76:77], v6 offset:18432
    ds_read_b64_tr_b16 a[78:79], v6 offset:19456
    v_lshrrev_b32 v4, 5, v1
    v_mul_u32_u24 v4, 544, v4
    v_and_b32 v5, 31, v1
    v_lshl_add_u32 v4, v5, 4, v4
    s_mul_i32 s33, s28, 8704
    v_add_u32 v8, s33, v4
    s_lshr_b32 s33, s28, 1
    s_mul_i32 s33, s33, 4352
    s_and_b32 s34, s28, 1
    s_mul_i32 s34, s34, 2176
    s_add_u32 s33, s33, s34
    v_add_u32 v9, s33, v4
    s_lshl_b32 s33, s56, 2
    s_add_u32 s33, s33, s28
    s_lshl_b32 s33, s33, 10
    v_lshlrev_b32 v10, 4, v1
    v_add_u32 v10, s33, v10
    v_mov_b32 v2, 0xc0135761
    s_mov_b32 s49, 0xbdd2d3e8
    s_waitcnt lgkmcnt(0)
    s_barrier
    s_mov_b32 s60, 0
    s_mul_i32 s62, s31, 40960
    s_mov_b32 s37, 0
    s_waitcnt vmcnt(0)
L_m3_3136:
    s_cmp_lg_u32 s37, 0
    s_cbranch_scc1 L_have_3137
    s_mov_b32 s38, 22528
    s_add_u32 s39, s30, 1
    s_cmp_lg_u32 s28, 0
    s_cbranch_scc1 L_wf_3138
    v_and_b32 v254, 63, v0
    v_min_u32 v254, 7, v254
    v_lshlrev_b32 v254, 3, v254
L_poll_3139:
    buffer_load_dwordx2 v[252:253], v254, s[4:7], s38 offen sc1
    s_waitcnt vmcnt(0)
    v_subrev_u32 v252, s96, v252
    v_xor_b32 v253, s97, v253
    v_lshrrev_b32 v255, 8, v252
    v_or_b32 v253, v253, v255
    v_cmp_eq_u32 vcc, 0, v253
    s_nop 1
    v_cndmask_b32 v252, 0, v252, vcc
    v_cmp_gt_u32 vcc, s39, v252
    s_cbranch_vccz L_ok_3140
    s_sleep 2
    s_sub_u32 s98, s98, 1
    s_cbranch_scc0 L_poll_3139
    s_mov_b32 s98, 0
L_ok_3140:
L_wf_3138:
    s_barrier
    buffer_load_dwordx4 v[92:95], v7, s[8:11], 0 offen offset:0 sc1
    buffer_load_dwordx4 v[96:99], v7, s[8:11], 0 offen offset:128 sc1
    buffer_load_dwordx4 v[100:103], v7, s[8:11], 0 offen offset:256 sc1
    buffer_load_dwordx4 v[104:107], v7, s[8:11], 0 offen offset:384 sc1
    buffer_load_dwordx4 v[108:111], v7, s[8:11], 0 offen offset:512 sc1
    buffer_load_dwordx4 v[112:115], v7, s[8:11], 0 offen offset:640 sc1
    buffer_load_dwordx4 v[116:119], v7, s[8:11], 0 offen offset:768 sc1
    buffer_load_dwordx4 v[120:123], v7, s[8:11], 0 offen offset:896 sc1
    buffer_load_dwordx4 v[124:127], v7, s[8:11], 0 offen offset:1024 sc1
    buffer_load_dwordx4 v[128:131], v7, s[8:11], 0 offen offset:1152 sc1
L_have_3137:
    v_add_u32 v7, s62, v7
    s_mul_i32 s61, s30, 110592
    s_add_u32 s61, s61, 113246208
    s_add_u32 s37, s30, s31
    s_mov_b32 s38, 22528
    s_add_u32 s39, s37, 1
    s_cmp_lt_u32 s37, s32
    s_cselect_b32 s39, s39, 256
    s_cmp_eq_u32 s28, 0
    s_cselect_b64 exec, -1, 0
    buffer_load_dwordx2 v[252:253], v254, s[4:7], s38 offen sc1
    s_mov_b64 exec, -1
    s_waitcnt vmcnt(10)
    v_mfma_f32_32x32x16_bf16 v[12:27], a[0:3], v[92:95], 0
    v_mfma_f32_32x32x16_bf16 v[28:43], a[4:7], v[92:95], 0
    s_waitcnt vmcnt(9)
    v_mfma_f32_32x32x16_bf16 v[12:27], a[8:11], v[96:99], v[12:27]
    v_mfma_f32_32x32x16_bf16 v[28:43], a[12:15], v[96:99], v[28:43]
    s_waitcnt vmcnt(8)
    v_mfma_f32_32x32x16_bf16 v[12:27], a[16:19], v[100:103], v[12:27]
    v_mfma_f32_32x32x16_bf16 v[28:43], a[20:23], v[100:103], v[28:43]
    s_waitcnt vmcnt(7)
    v_mfma_f32_32x32x16_bf16 v[12:27], a[24:27], v[104:107], v[12:27]
    v_mfma_f32_32x32x16_bf16 v[28:43], a[28:31], v[104:107], v[28:43]
    s_waitcnt vmcnt(6)
    v_mfma_f32_32x32x16_bf16 v[12:27], a[32:35], v[108:111], v[12:27]
    v_mfma_f32_32x32x16_bf16 v[28:43], a[36:39], v[108:111], v[28:43]
    s_waitcnt vmcnt(5)
    v_mfma_f32_32x32x16_bf16 v[12:27], a[40:43], v[112:115], v[12:27]
    v_mfma_f32_32x32x16_bf16 v[28:43], a[44:47], v[112:115], v[28:43]
    s_waitcnt vmcnt(4)
    v_mfma_f32_32x32x16_bf16 v[12:27], a[48:51], v[116:119], v[12:27]
    v_mfma_f32_32x32x16_bf16 v[28:43], a[52:55], v[116:119], v[28:43]
    s_waitcnt vmcnt(3)
    v_mfma_f32_32x32x16_bf16 v[12:27], a[56:59], v[120:123], v[12:27]
    v_mfma_f32_32x32x16_bf16 v[28:43], a[60:63], v[120:123], v[28:43]
    s_waitcnt vmcnt(2)
    v_mfma_f32_32x32x16_bf16 v[12:27], a[64:67], v[124:127], v[12:27]
    v_mfma_f32_32x32x16_bf16 v[28:43], a[68:71], v[124:127], v[28:43]
    s_waitcnt vmcnt(1)
    v_mfma_f32_32x32x16_bf16 v[12:27], a[72:75], v[128:131], v[12:27]
    v_mfma_f32_32x32x16_bf16 v[28:43], a[76:79], v[128:131], v[28:43]
    s_waitcnt vmcnt(0)
    s_cmp_lg_u32 s28, 0
    s_cbranch_scc1 L_verd_3141
    v_subrev_u32 v252, s96, v252
    v_xor_b32 v253, s97, v253
    v_lshrrev_b32 v255, 8, v252
    v_or_b32 v253, v253, v255
    v_cmp_eq_u32 vcc, 0, v253
    s_nop 1
    v_cndmask_b32 v252, 0, v252, vcc
    v_cmp_gt_u32 vcc, s39, v252
    s_nop 0
    s_cmp_eq_u64 vcc, 0
    s_cselect_b32 s37, 1, 0
    v_mov_b32 v252, s37
    v_mov_b32 v253, 81920
    ds_write_b32 v253, v252
L_verd_3141:
    v_add_u32 v4, s60, v8
    v_add_u32 v5, s60, v9
    s_nop 5
    ds_write_b128 v4, v[12:15] offset:0
    ds_write_b128 v4, v[16:19] offset:1088
    ds_write_b128 v4, v[20:23] offset:2176
    ds_write_b128 v4, v[24:27] offset:3264
    ds_write_b128 v4, v[28:31] offset:4352
    ds_write_b128 v4, v[32:35] offset:5440
    ds_write_b128 v4, v[36:39] offset:6528
    ds_write_b128 v4, v[40:43] offset:7616
    s_xor_b32 s60, s60, 34816
    s_waitcnt lgkmcnt(0)
    s_barrier
    v_mov_b32 v253, 81920
    ds_read_b32 v252, v253
    ds_read_b128 v[44:47], v5 offset:0
    ds_read_b128 v[48:51], v5 offset:1088
    ds_read_b128 v[52:55], v5 offset:8704
    ds_read_b128 v[56:59], v5 offset:9792
    ds_read_b128 v[60:63], v5 offset:17408
    ds_read_b128 v[64:67], v5 offset:18496
    ds_read_b128 v[68:71], v5 offset:26112
    ds_read_b128 v[72:75], v5 offset:27200
    s_waitcnt lgkmcnt(8)
    v_readfirstlane_b32 s37, v252
    s_nop 0
    s_cmp_eq_u32 s37, 0
    s_cbranch_scc1 L_noah_3142
    buffer_load_dwordx4 v[92:95], v7, s[8:11], 0 offen offset:0 sc1
    buffer_load_dwordx4 v[96:99], v7, s[8:11], 0 offen offset:128 sc1
    buffer_load_dwordx4 v[100:103], v7, s[8:11], 0 offen offset:256 sc1
    buffer_load_dwordx4 v[104:107], v7, s[8:11], 0 offen offset:384 sc1
    buffer_load_dwordx4 v[108:111], v7, s[8:11], 0 offen offset:512 sc1
    buffer_load_dwordx4 v[112:115], v7, s[8:11], 0 offen offset:640 sc1
    buffer_load_dwordx4 v[116:119], v7, s[8:11], 0 offen offset:768 sc1
    buffer_load_dwordx4 v[120:123], v7, s[8:11], 0 offen offset:896 sc1
    buffer_load_dwordx4 v[124:127], v7, s[8:11], 0 offen offset:1024 sc1
    buffer_load_dwordx4 v[128:131], v7, s[8:11], 0 offen offset:1152 sc1
L_noah_3142:
    s_waitcnt lgkmcnt(4)
    v_add_f32 v44, v44, v52
    v_add_f32 v45, v45, v53
    v_add_f32 v46, v46, v54
    v_add_f32 v47, v47, v55
    v_add_f32 v48, v48, v56
    v_add_f32 v49, v49, v57
    v_add_f32 v50, v50, v58
    v_add_f32 v51, v51, v59
    s_waitcnt lgkmcnt(0)
    v_add_f32 v60, v60, v68
    v_add_f32 v61, v61, v69
    v_add_f32 v62, v62, v70
    v_add_f32 v63, v63, v71
    v_add_f32 v64, v64, v72
    v_add_f32 v65, v65, v73
    v_add_f32 v66, v66, v74
    v_add_f32 v67, v67, v75
    v_add_f32 v44, v44, v60
    v_add_f32 v45, v45, v61
    v_add_f32 v46, v46, v62
    v_add_f32 v47, v47, v63
    v_add_f32 v48, v48, v64
    v_add_f32 v49, v49, v65
    v_add_f32 v50, v50, v66
    v_add_f32 v51, v51, v67
    v_cvt_pk_bf16_f32 v52, v44, v45
    v_lshlrev_b32 v44, 16, v52
    v_and_b32 v45, 0xffff0000, v52
    v_cvt_pk_bf16_f32 v53, v46, v47
    v_lshlrev_b32 v46, 16, v53
    v_and_b32 v47, 0xffff0000, v53
    v_cvt_pk_bf16_f32 v54, v48, v49
    v_lshlrev_b32 v48, 16, v54
    v_and_b32 v49, 0xffff0000, v54
    v_cvt_pk_bf16_f32 v55, v50, v51
    v_lshlrev_b32 v50, 16, v55
    v_and_b32 v51, 0xffff0000, v55
    v_mul_f32 v60, v44, v44
    v_fma_f32 v60, v60, s49, v2
    v_mul_f32 v60, v60, v44
    v_exp_f32 v60, v60
    s_nop 0
    v_add_f32 v60, 1.0, v60
    v_rcp_f32 v60, v60
    s_nop 0
    v_mul_f32 v44, v44, v60
    v_mul_f32 v61, v45, v45
    v_fma_f32 v61, v61, s49, v2
    v_mul_f32 v61, v61, v45
    v_exp_f32 v61, v61
    s_nop 0
    v_add_f32 v61, 1.0, v61
    v_rcp_f32 v61, v61
    s_nop 0
    v_mul_f32 v45, v45, v61
    v_mul_f32 v62, v46, v46
    v_fma_f32 v62, v62, s49, v2
    v_mul_f32 v62, v62, v46
    v_exp_f32 v62, v62
    s_nop 0
    v_add_f32 v62, 1.0, v62
    v_rcp_f32 v62, v62
    s_nop 0
    v_mul_f32 v46, v46, v62
    v_mul_f32 v63, v47, v47
    v_fma_f32 v63, v63, s49, v2
    v_mul_f32 v63, v63, v47
    v_exp_f32 v63, v63
    s_nop 0
    v_add_f32 v63, 1.0, v63
    v_rcp_f32 v63, v63
    s_nop 0
    v_mul_f32 v47, v47, v63
    v_mul_f32 v64, v48, v48
    v_fma_f32 v64, v64, s49, v2
    v_mul_f32 v64, v64, v48
    v_exp_f32 v64, v64
    s_nop 0
    v_add_f32 v64, 1.0, v64
    v_rcp_f32 v64, v64
    s_nop 0
    v_mul_f32 v48, v48, v64
    v_mul_f32 v65, v49, v49
    v_fma_f32 v65, v65, s49, v2
    v_mul_f32 v65, v65, v49
    v_exp_f32 v65, v65
    s_nop 0
    v_add_f32 v65, 1.0, v65
    v_rcp_f32 v65, v65
    s_nop 0
    v_mul_f32 v49, v49, v65
    v_mul_f32 v66, v50, v50
    v_fma_f32 v66, v66, s49, v2
    v_mul_f32 v66, v66, v50
    v_exp_f32 v66, v66
    s_nop 0
    v_add_f32 v66, 1.0, v66
    v_rcp_f32 v66, v66
    s_nop 0
    v_mul_f32 v50, v50, v66
    v_mul_f32 v67, v51, v51
    v_fma_f32 v67, v67, s49, v2
    v_mul_f32 v67, v67, v51
    v_exp_f32 v67, v67
    s_nop 0
    v_add_f32 v67, 1.0, v67
    v_rcp_f32 v67, v67
    s_nop 0
    v_mul_f32 v51, v51, v67
    v_cvt_pk_bf16_f32 v52, v44, v45
    v_cvt_pk_bf16_f32 v53, v46, v47
    v_cvt_pk_bf16_f32 v54, v48, v49
    v_cvt_pk_bf16_f32 v55, v50, v51
    buffer_store_dwordx4 v[52:55], v10, s[4:7], s61 offen sc1
    s_add_u32 s34, s30, s31
    s_waitcnt vmcnt(0)
    s_barrier
    s_cmp_lg_u32 s28, 0
    s_cbranch_scc1 L_sig_3143
    s_add_u32 s33, s96, s34
    v_mov_b32 v252, s33
    v_mov_b32 v253, s97
    s_mov_b64 exec, 1
    buffer_store_dwordx2 v[252:253], off, s[4:7], s99 sc1
    s_mov_b64 exec, -1
L_sig_3143:
    s_add_u32 s30, s30, s31
    s_cmp_lt_u32 s30, s32
    s_cbranch_scc1 L_m3_3136
    s_waitcnt vmcnt(0)
    s_branch L_fin_3091
L_m4_3087:
    s_mov_b32 s35, 4896
    s_cmp_lg_u32 s28, 0
    s_cbranch_scc1 L_wf_3144
    v_and_b32 v254, 63, v0
    v_min_u32 v254, 19, v254
    v_lshlrev_b32 v254, 3, v254
L_poll_3145:
    buffer_load_dwordx2 v[252:253], v254, s[4:7], s35 offen sc1
    s_waitcnt vmcnt(0)
    v_subrev_u32 v252, s96, v252
    v_xor_b32 v253, s97, v253
    v_lshrrev_b32 v255, 8, v252
    v_or_b32 v253, v253, v255
    v_cmp_eq_u32 vcc, 0, v253
    s_nop 1
    v_cndmask_b32 v252, 0, v252, vcc
    v_cmp_gt_u32 vcc, 1, v252
    s_cbranch_vccz L_ok_3146
    s_sleep 2
    s_sub_u32 s98, s98, 1
    s_cbranch_scc0 L_poll_3145
    s_mov_b32 s98, 0
L_ok_3146:
L_wf_3144:
    s_barrier
    s_load_dwordx2 s[20:21], s[0:1], 88
    s_load_dwordx2 s[22:23], s[0:1], 112
    s_load_dwordx2 s[26:27], s[0:1], 128
    v_lshrrev_b32 v1, 6, v0
    s_nop 0
    v_readfirstlane_b32 s28, v1
    s_waitcnt lgkmcnt(0)
    s_mov_b32 s4, s26
    s_and_b32 s5, s27, 0xffff
    s_mov_b32 s6, 268435456
    s_mov_b32 s7, 0x20000
    s_mov_b32 s57, 0
    s_mov_b32 s56, s29
    s_add_u32 s8, s26, 113246208
    s_addc_u32 s9, s27, 0
    s_and_b32 s9, s9, 0xffff
    s_mov_b32 s10, 7077888
    s_mov_b32 s11, 0x20000
    s_mov_b32 s12, s20
    s_and_b32 s13, s21, 0xffff
    s_mov_b32 s14, 2211840
    s_mov_b32 s15, 0x20000
    s_mov_b32 s16, s22
    s_and_b32 s17, s23, 0xffff
    s_mov_b32 s18, 2621440
    s_mov_b32 s19, 0x20000
    s_mov_b32 s40, 0
    s_mov_b32 s41, 4096
    s_mov_b32 s42, 8192
    s_mov_b32 s43, 12288
    s_mov_b32 s44, 16384
    s_mov_b32 s45, 20480
    s_mov_b32 s46, 24576
    v_and_b32 v1, 63, v0
    v_bfe_u32 v3, v0, 4, 2
    v_and_b32 v4, 1, v3
    v_lshlrev_b32 v4, 2, v4
    v_and_b32 v5, 7, v1
    v_xor_b32 v4, v4, v5
    v_lshrrev_b32 v5, 3, v1
    v_mul_u32_u24 v5, 1280, v5
    v_lshl_add_u32 v8, v4, 4, v5
    s_lshl_b32 s33, s57, 2
    s_add_u32 s33, s33, s28
    s_mul_i32 s35, s33, 27648
    s_mul_i32 s58, s33, 552960
    s_lshl_b32 s34, s56, 7
    s_add_u32 s58, s58, s34
    s_mul_i32 s59, s28, 40960
    s_add_u32 m0, s59, 0
    s_nop 0
    buffer_load_dwordx4 v8, s[12:15], s58 offen lds
    s_add_u32 s58, s58, 10240
    s_add_u32 m0, s59, 1024
    s_nop 0
    buffer_load_dwordx4 v8, s[12:15], s58 offen lds
    s_add_u32 s58, s58, 10240
    s_add_u32 m0, s59, 2048
    s_nop 0
    buffer_load_dwordx4 v8, s[12:15], s58 offen lds
    s_add_u32 s58, s58, 10240
    s_add_u32 m0, s59, 3072
    s_nop 0
    buffer_load_dwordx4 v8, s[12:15], s58 offen lds
    s_add_u32 s58, s58, 10240
    s_add_u32 m0, s59, 4096
    s_nop 0
    buffer_load_dwordx4 v8, s[12:15], s58 offen lds
    s_add_u32 s58, s58, 10240
    s_add_u32 m0, s59, 5120
    s_nop 0
    buffer_load_dwordx4 v8, s[12:15], s58 offen lds
    s_add_u32 s58, s58, 10240
    s_add_u32 m0, s59, 6144
    s_nop 0
    buffer_load_dwordx4 v8, s[12:15], s58 offen lds
    s_add_u32 s58, s58, 10240
    s_add_u32 m0, s59, 7168
    s_nop 0
    buffer_load_dwordx4 v8, s[12:15], s58 offen lds
    s_add_u32 s58, s58, 10240
    s_add_u32 m0, s59, 8192
    s_nop 0
    buffer_load_dwordx4 v8, s[12:15], s58 offen lds
    s_add_u32 s58, s58, 10240
    s_add_u32 m0, s59, 9216
    s_nop 0
    buffer_load_dwordx4 v8, s[12:15], s58 offen lds
    s_add_u32 s58, s58, 10240
    s_add_u32 m0, s59, 10240
    s_nop 0
    buffer_load_dwordx4 v8, s[12:15], s58 offen lds
    s_add_u32 s58, s58, 10240
    s_add_u32 m0, s59, 11264
    s_nop 0
    buffer_load_dwordx4 v8, s[12:15], s58 offen lds
    s_add_u32 s58, s58, 10240
    s_add_u32 m0, s59, 12288
    s_nop 0
    buffer_load_dwordx4 v8, s[12:15], s58 offen lds
    s_add_u32 s58, s58, 10240
    s_add_u32 m0, s59, 13312
    s_nop 0
    buffer_load_dwordx4 v8, s[12:15], s58 offen lds
    s_add_u32 s58, s58, 10240
    s_add_u32 m0, s59, 14336
    s_nop 0
    buffer_load_dwordx4 v8, s[12:15], s58 offen lds
    s_add_u32 s58, s58, 10240
    s_add_u32 m0, s59, 15360
    s_nop 0
    buffer_load_dwordx4 v8, s[12:15], s58 offen lds
    s_add_u32 s58, s58, 10240
    s_add_u32 m0, s59, 16384
    s_nop 0
    buffer_load_dwordx4 v8, s[12:15], s58 offen lds
    s_add_u32 s58, s58, 10240
    s_add_u32 m0, s59, 17408
    s_nop 0
    buffer_load_dwordx4 v8, s[12:15], s58 offen lds
    s_add_u32 s58, s58, 10240
    s_add_u32 m0, s59, 18432
    s_nop 0
    buffer_load_dwordx4 v8, s[12:15], s58 offen lds
    s_add_u32 s58, s58, 10240
    s_add_u32 m0, s59, 19456
    s_nop 0
    buffer_load_dwordx4 v8, s[12:15], s58 offen lds
    s_add_u32 s58, s58, 10240
    s_add_u32 m0, s59, 20480
    s_nop 0
    buffer_load_dwordx4 v8, s[12:15], s58 offen lds
    s_add_u32 s58, s58, 10240
    s_add_u32 m0, s59, 21504
    s_nop 0
    buffer_load_dwordx4 v8, s[12:15], s58 offen lds
    s_add_u32 s58, s58, 10240
    s_add_u32 m0, s59, 22528
    s_nop 0
    buffer_load_dwordx4 v8, s[12:15], s58 offen lds
    s_add_u32 s58, s58, 10240
    s_add_u32 m0, s59, 23552
    s_nop 0
    buffer_load_dwordx4 v8, s[12:15], s58 offen lds
    s_add_u32 s58, s58, 10240
    s_add_u32 m0, s59, 24576
    s_nop 0
    buffer_load_dwordx4 v8, s[12:15], s58 offen lds
    s_add_u32 s58, s58, 10240
    s_add_u32 m0, s59, 25600
    s_nop 0
    buffer_load_dwordx4 v8, s[12:15], s58 offen lds
    s_add_u32 s58, s58, 10240
    s_add_u32 m0, s59, 26624
    s_nop 0
    buffer_load_dwordx4 v8, s[12:15], s58 offen lds
    s_add_u32 s58, s58, 10240
    s_add_u32 m0, s59, 27648
    s_nop 0
    buffer_load_dwordx4 v8, s[12:15], s58 offen lds
    s_add_u32 s58, s58, 10240
    v_and_b32 v4, 31, v1
    v_lshlrev_b32 v7, 4, v1
    s_mul_i32 s33, s30, 110592
    s_add_u32 s33, s33, s35
    v_add_u32 v7, s33, v7
    v_bfe_u32 v4, v1, 2, 2
    v_lshlrev_b32 v5, 7, v4
    v_lshrrev_b32 v4, 1, v4
    v_lshl_add_u32 v5, v4, 6, v5
    v_lshrrev_b32 v4, 1, v3
    v_lshl_add_u32 v5, v4, 9, v5
    v_and_b32 v4, 1, v3
    v_lshl_add_u32 v5, v4, 5, v5
    v_and_b32 v4, 3, v1
    v_lshl_add_u32 v5, v4, 3, v5
    v_xor_b32 v6, 64, v5
    v_add_u32 v5, s59, v5
    v_add_u32 v6, s59, v6
    s_waitcnt vmcnt(24)
    ds_read_b64_tr_b16 a[0:1], v5 offset:0
    ds_read_b64_tr_b16 a[2:3], v5 offset:1024
    ds_read_b64_tr_b16 a[4:5], v6 offset:0
    ds_read_b64_tr_b16 a[6:7], v6 offset:1024
    ds_read_b64_tr_b16 a[8:9], v5 offset:2048
    ds_read_b64_tr_b16 a[10:11], v5 offset:3072
    ds_read_b64_tr_b16 a[12:13], v6 offset:2048
    ds_read_b64_tr_b16 a[14:15], v6 offset:3072
    s_waitcnt vmcnt(20)
    ds_read_b64_tr_b16 a[16:17], v5 offset:4096
    ds_read_b64_tr_b16 a[18:19], v5 offset:5120
    ds_read_b64_tr_b16 a[20:21], v6 offset:4096
    ds_read_b64_tr_b16 a[22:23], v6 offset:5120
    ds_read_b64_tr_b16 a[24:25], v5 offset:6144
    ds_read_b64_tr_b16 a[26:27], v5 offset:7168
    ds_read_b64_tr_b16 a[28:29], v6 offset:6144
    ds_read_b64_tr_b16 a[30:31], v6 offset:7168
    s_waitcnt vmcnt(16)
    ds_read_b64_tr_b16 a[32:33], v5 offset:8192
    ds_read_b64_tr_b16 a[34:35], v5 offset:9216
    ds_read_b64_tr_b16 a[36:37], v6 offset:8192
    ds_read_b64_tr_b16 a[38:39], v6 offset:9216
    ds_read_b64_tr_b16 a[40:41], v5 offset:10240
    ds_read_b64_tr_b16 a[42:43], v5 offset:11264
    ds_read_b64_tr_b16 a[44:45], v6 offset:10240
    ds_read_b64_tr_b16 a[46:47], v6 offset:11264
    s_waitcnt vmcnt(12)
    ds_read_b64_tr_b16 a[48:49], v5 offset:12288
    ds_read_b64_tr_b16 a[50:51], v5 offset:13312
    ds_read_b64_tr_b16 a[52:53], v6 offset:12288
    ds_read_b64_tr_b16 a[54:55], v6 offset:13312
    ds_read_b64_tr_b16 a[56:57], v5 offset:14336
    ds_read_b64_tr_b16 a[58:59], v5 offset:15360
    ds_read_b64_tr_b16 a[60:61], v6 offset:14336
    ds_read_b64_tr_b16 a[62:63], v6 offset:15360
    s_waitcnt vmcnt(8)
    ds_read_b64_tr_b16 a[64:65], v5 offset:16384
    ds_read_b64_tr_b16 a[66:67], v5 offset:17408
    ds_read_b64_tr_b16 a[68:69], v6 offset:16384
    ds_read_b64_tr_b16 a[70:71], v6 offset:17408
    ds_read_b64_tr_b16 a[72:73], v5 offset:18432
    ds_read_b64_tr_b16 a[74:75], v5 offset:19456
    ds_read_b64_tr_b16 a[76:77], v6 offset:18432
    ds_read_b64_tr_b16 a[78:79], v6 offset:19456
    s_waitcnt vmcnt(4)
    ds_read_b64_tr_b16 a[80:81], v5 offset:20480
    ds_read_b64_tr_b16 a[82:83], v5 offset:21504
    ds_read_b64_tr_b16 a[84:85], v6 offset:20480
    ds_read_b64_tr_b16 a[86:87], v6 offset:21504
    ds_read_b64_tr_b16 a[88:89], v5 offset:22528
    ds_read_b64_tr_b16 a[90:91], v5 offset:23552
    ds_read_b64_tr_b16 a[92:93], v6 offset:22528
    ds_read_b64_tr_b16 a[94:95], v6 offset:23552
    s_waitcnt vmcnt(0)
    ds_read_b64_tr_b16 a[96:97], v5 offset:24576
    ds_read_b64_tr_b16 a[98:99], v5 offset:25600
    ds_read_b64_tr_b16 a[100:101], v6 offset:24576
    ds_read_b64_tr_b16 a[102:103], v6 offset:25600
    ds_read_b64_tr_b16 a[104:105], v5 offset:26624
    ds_read_b64_tr_b16 a[106:107], v5 offset:27648
    ds_read_b64_tr_b16 a[108:109], v6 offset:26624
    ds_read_b64_tr_b16 a[110:111], v6 offset:27648
    s_waitcnt lgkmcnt(0)
    s_add_u32 m0, s59, 0
    s_nop 0
    buffer_load_dwordx4 v8, s[12:15], s58 offen lds
    s_add_u32 s58, s58, 10240
    s_add_u32 m0, s59, 1024
    s_nop 0
    buffer_load_dwordx4 v8, s[12:15], s58 offen lds
    s_add_u32 s58, s58, 10240
    s_add_u32 m0, s59, 2048
    s_nop 0
    buffer_load_dwordx4 v8, s[12:15], s58 offen lds
    s_add_u32 s58, s58, 10240
    s_add_u32 m0, s59, 3072
    s_nop 0
    buffer_load_dwordx4 v8, s[12:15], s58 offen lds
    s_add_u32 s58, s58, 10240
    s_add_u32 m0, s59, 4096
    s_nop 0
    buffer_load_dwordx4 v8, s[12:15], s58 offen lds
    s_add_u32 s58, s58, 10240
    s_add_u32 m0, s59, 5120
    s_nop 0
    buffer_load_dwordx4 v8, s[12:15], s58 offen lds
    s_add_u32 s58, s58, 10240
    s_add_u32 m0, s59, 6144
    s_nop 0
    buffer_load_dwordx4 v8, s[12:15], s58 offen lds
    s_add_u32 s58, s58, 10240
    s_add_u32 m0, s59, 7168
    s_nop 0
    buffer_load_dwordx4 v8, s[12:15], s58 offen lds
    s_add_u32 s58, s58, 10240
    s_add_u32 m0, s59, 8192
    s_nop 0
    buffer_load_dwordx4 v8, s[12:15], s58 offen lds
    s_add_u32 s58, s58, 10240
    s_add_u32 m0, s59, 9216
    s_nop 0
    buffer_load_dwordx4 v8, s[12:15], s58 offen lds
    s_add_u32 s58, s58, 10240
    s_add_u32 m0, s59, 10240
    s_nop 0
    buffer_load_dwordx4 v8, s[12:15], s58 offen lds
    s_add_u32 s58, s58, 10240
    s_add_u32 m0, s59, 11264
    s_nop 0
    buffer_load_dwordx4 v8, s[12:15], s58 offen lds
    s_add_u32 s58, s58, 10240
    s_add_u32 m0, s59, 12288
    s_nop 0
    buffer_load_dwordx4 v8, s[12:15], s58 offen lds
    s_add_u32 s58, s58, 10240
    s_add_u32 m0, s59, 13312
    s_nop 0
    buffer_load_dwordx4 v8, s[12:15], s58 offen lds
    s_add_u32 s58, s58, 10240
    s_add_u32 m0, s59, 14336
    s_nop 0
    buffer_load_dwordx4 v8, s[12:15], s58 offen lds
    s_add_u32 s58, s58, 10240
    s_add_u32 m0, s59, 15360
    s_nop 0
    buffer_load_dwordx4 v8, s[12:15], s58 offen lds
    s_add_u32 s58, s58, 10240
    s_add_u32 m0, s59, 16384
    s_nop 0
    buffer_load_dwordx4 v8, s[12:15], s58 offen lds
    s_add_u32 s58, s58, 10240
    s_add_u32 m0, s59, 17408
    s_nop 0
    buffer_load_dwordx4 v8, s[12:15], s58 offen lds
    s_add_u32 s58, s58, 10240
    s_add_u32 m0, s59, 18432
    s_nop 0
    buffer_load_dwordx4 v8, s[12:15], s58 offen lds
    s_add_u32 s58, s58, 10240
    s_add_u32 m0, s59, 19456
    s_nop 0
    buffer_load_dwordx4 v8, s[12:15], s58 offen lds
    s_add_u32 s58, s58, 10240
    s_add_u32 m0, s59, 20480
    s_nop 0
    buffer_load_dwordx4 v8, s[12:15], s58 offen lds
    s_add_u32 s58, s58, 10240
    s_add_u32 m0, s59, 21504
    s_nop 0
    buffer_load_dwordx4 v8, s[12:15], s58 offen lds
    s_add_u32 s58, s58, 10240
    s_add_u32 m0, s59, 22528
    s_nop 0
    buffer_load_dwordx4 v8, s[12:15], s58 offen lds
    s_add_u32 s58, s58, 10240
    s_add_u32 m0, s59, 23552
    s_nop 0
    buffer_load_dwordx4 v8, s[12:15], s58 offen lds
    s_add_u32 s58, s58, 10240
    s_add_u32 m0, s59, 24576
    s_nop 0
    buffer_load_dwordx4 v8, s[12:15], s58 offen lds
    s_add_u32 s58, s58, 10240
    s_add_u32 m0, s59, 25600
    s_nop 0
    buffer_load_dwordx4 v8, s[12:15], s58 offen lds
    s_add_u32 s58, s58, 10240
    s_waitcnt vmcnt(22)
    ds_read_b64_tr_b16 a[112:113], v5 offset:0
    ds_read_b64_tr_b16 a[114:115], v5 offset:1024
    ds_read_b64_tr_b16 a[116:117], v6 offset:0
    ds_read_b64_tr_b16 a[118:119], v6 offset:1024
    ds_read_b64_tr_b16 a[120:121], v5 offset:2048
    ds_read_b64_tr_b16 a[122:123], v5 offset:3072
    ds_read_b64_tr_b16 a[124:125], v6 offset:2048
    ds_read_b64_tr_b16 a[126:127], v6 offset:3072
    s_waitcnt vmcnt(18)
    ds_read_b64_tr_b16 a[128:129], v5 offset:4096
    ds_read_b64_tr_b16 a[130:131], v5 offset:5120
    ds_read_b64_tr_b16 a[132:133], v6 offset:4096
    ds_read_b64_tr_b16 a[134:135], v6 offset:5120
    ds_read_b64_tr_b16 a[136:137], v5 offset:6144
    ds_read_b64_tr_b16 a[138:139], v5 offset:7168
    ds_read_b64_tr_b16 a[140:141], v6 offset:6144
    ds_read_b64_tr_b16 a[142:143], v6 offset:7168
    s_waitcnt vmcnt(14)
    ds_read_b64_tr_b16 a[144:145], v5 offset:8192
    ds_read_b64_tr_b16 a[146:147], v5 offset:9216
    ds_read_b64_tr_b16 a[148:149], v6 offset:8192
    ds_read_b64_tr_b16 a[150:151], v6 offset:9216
    ds_read_b64_tr_b16 a[152:153], v5 offset:10240
    ds_read_b64_tr_b16 a[154:155], v5 offset:11264
    ds_read_b64_tr_b16 a[156:157], v6 offset:10240
    ds_read_b64_tr_b16 a[158:159], v6 offset:11264
    s_waitcnt vmcnt(10)
    ds_read_b64_tr_b16 a[160:161], v5 offset:12288
    ds_read_b64_tr_b16 a[162:163], v5 offset:13312
    ds_read_b64_tr_b16 a[164:165], v6 offset:12288
    ds_read_b64_tr_b16 a[166:167], v6 offset:13312
    ds_read_b64_tr_b16 a[168:169], v5 offset:14336
    ds_read_b64_tr_b16 a[170:171], v5 offset:15360
    ds_read_b64_tr_b16 a[172:173], v6 offset:14336
    ds_read_b64_tr_b16 a[174:175], v6 offset:15360
    s_waitcnt vmcnt(6)
    ds_read_b64_tr_b16 a[176:177], v5 offset:16384
    ds_read_b64_tr_b16 a[178:179], v5 offset:17408
    ds_read_b64_tr_b16 a[180:181], v6 offset:16384
    ds_read_b64_tr_b16 a[182:183], v6 offset:17408
    ds_read_b64_tr_b16 a[184:185], v5 offset:18432
    ds_read_b64_tr_b16 a[186:187], v5 offset:19456
    ds_read_b64_tr_b16 a[188:189], v6 offset:18432
    ds_read_b64_tr_b16 a[190:191], v6 offset:19456
    s_waitcnt vmcnt(2)
    ds_read_b64_tr_b16 a[192:193], v5 offset:20480
    ds_read_b64_tr_b16 a[194:195], v5 offset:21504
    ds_read_b64_tr_b16 a[196:197], v6 offset:20480
    ds_read_b64_tr_b16 a[198:199], v6 offset:21504
    ds_read_b64_tr_b16 a[200:201], v5 offset:22528
    ds_read_b64_tr_b16 a[202:203], v5 offset:23552
    ds_read_b64_tr_b16 a[204:205], v6 offset:22528
    ds_read_b64_tr_b16 a[206:207], v6 offset:23552
    s_waitcnt vmcnt(0)
    ds_read_b64_tr_b16 a[208:209], v5 offset:24576
    ds_read_b64_tr_b16 a[210:211], v5 offset:25600
    ds_read_b64_tr_b16 a[212:213], v6 offset:24576
    ds_read_b64_tr_b16 a[214:215], v6 offset:25600
    v_lshrrev_b32 v4, 5, v1
    v_mul_u32_u24 v4, 544, v4
    v_and_b32 v5, 31, v1
    v_lshl_add_u32 v4, v5, 4, v4
    s_mul_i32 s33, s28, 8704
    v_add_u32 v8, s33, v4
    v_and_b32 v4, 7, v1
    v_lshrrev_b32 v5, 3, v1
    s_lshl_b32 s33, s28, 3
    v_add_u32 v5, s33, v5
    v_mul_u32_u24 v9, 544, v4
    v_lshl_add_u32 v9, v5, 4, v9
    v_mul_u32_u24 v11, 1280, v5
    v_lshl_add_u32 v11, v4, 3, v11
    s_lshl_b32 s33, s56, 7
    v_add_u32 v11, s33, v11
    v_lshlrev_b32 v4, 4, v4
    s_lshl_b32 s33, s56, 8
    s_add_u32 s33, s33, 143872
    buffer_load_dwordx4 v[84:87], v4, s[4:7], s33 offen offset:0 sc1
    buffer_load_dwordx4 v[88:91], v4, s[4:7], s33 offen offset:128 sc1
    s_waitcnt lgkmcnt(0)
    s_barrier
    s_mov_b32 s60, 0
    s_mul_i32 s62, s31, 110592
    s_mov_b32 s37, 0
    s_waitcnt vmcnt(0)
L_m4_3147:
    s_cmp_lg_u32 s37, 0
    s_cbranch_scc1 L_have_3148
    s_mov_b32 s38, 24576
    s_add_u32 s39, s30, 1
    s_cmp_lg_u32 s28, 0
    s_cbranch_scc1 L_wf_3149
    v_and_b32 v254, 63, v0
    v_min_u32 v254, 26, v254
    v_lshlrev_b32 v254, 3, v254
L_poll_3150:
    buffer_load_dwordx2 v[252:253], v254, s[4:7], s38 offen sc1
    s_waitcnt vmcnt(0)
    v_subrev_u32 v252, s96, v252
    v_xor_b32 v253, s97, v253
    v_lshrrev_b32 v255, 8, v252
    v_or_b32 v253, v253, v255
    v_cmp_eq_u32 vcc, 0, v253
    s_nop 1
    v_cndmask_b32 v252, 0, v252, vcc
    v_cmp_gt_u32 vcc, s39, v252
    s_cbranch_vccz L_ok_3151
    s_sleep 2
    s_sub_u32 s98, s98, 1
    s_cbranch_scc0 L_poll_3150
    s_mov_b32 s98, 0
L_ok_3151:
L_wf_3149:
    s_barrier
    buffer_load_dwordx4 v[92:95], v7, s[8:11], s40 offen offset:0 sc1
    buffer_load_dwordx4 v[96:99], v7, s[8:11], s40 offen offset:1024 sc1
    buffer_load_dwordx4 v[100:103], v7, s[8:11], s40 offen offset:2048 sc1
    buffer_load_dwordx4 v[104:107], v7, s[8:11], s40 offen offset:3072 sc1
    buffer_load_dwordx4 v[108:111], v7, s[8:11], s41 offen offset:0 sc1
    buffer_load_dwordx4 v[112:115], v7, s[8:11], s41 offen offset:1024 sc1
    buffer_load_dwordx4 v[116:119], v7, s[8:11], s41 offen offset:2048 sc1
    buffer_load_dwordx4 v[120:123], v7, s[8:11], s41 offen offset:3072 sc1
    buffer_load_dwordx4 v[124:127], v7, s[8:11], s42 offen offset:0 sc1
    buffer_load_dwordx4 v[128:131], v7, s[8:11], s42 offen offset:1024 sc1
    buffer_load_dwordx4 v[132:135], v7, s[8:11], s42 offen offset:2048 sc1
    buffer_load_dwordx4 v[136:139], v7, s[8:11], s42 offen offset:3072 sc1
    buffer_load_dwordx4 v[140:143], v7, s[8:11], s43 offen offset:0 sc1
    buffer_load_dwordx4 v[144:147], v7, s[8:11], s43 offen offset:1024 sc1
    buffer_load_dwordx4 v[148:151], v7, s[8:11], s43 offen offset:2048 sc1
    buffer_load_dwordx4 v[152:155], v7, s[8:11], s43 offen offset:3072 sc1
    buffer_load_dwordx4 v[156:159], v7, s[8:11], s44 offen offset:0 sc1
    buffer_load_dwordx4 v[160:163], v7, s[8:11], s44 offen offset:1024 sc1
    buffer_load_dwordx4 v[164:167], v7, s[8:11], s44 offen offset:2048 sc1
    buffer_load_dwordx4 v[168:171], v7, s[8:11], s44 offen offset:3072 sc1
    buffer_load_dwordx4 v[172:175], v7, s[8:11], s45 offen offset:0 sc1
    buffer_load_dwordx4 v[176:179], v7, s[8:11], s45 offen offset:1024 sc1
    buffer_load_dwordx4 v[180:183], v7, s[8:11], s45 offen offset:2048 sc1
    buffer_load_dwordx4 v[184:187], v7, s[8:11], s45 offen offset:3072 sc1
    buffer_load_dwordx4 v[188:191], v7, s[8:11], s46 offen offset:0 sc1
    buffer_load_dwordx4 v[192:195], v7, s[8:11], s46 offen offset:1024 sc1
    buffer_load_dwordx4 v[196:199], v7, s[8:11], s46 offen offset:2048 sc1
L_have_3148:
    v_add_u32 v7, s62, v7
    s_mul_i32 s61, s30, 40960
    s_add_u32 s33, s61, 104857600
    buffer_load_dwordx2 v[76:77], v11, s[4:7], s33 offen offset:0 sc1
    buffer_load_dwordx2 v[78:79], v11, s[4:7], s33 offen offset:64 sc1
    s_add_u32 s33, s61, 88080384
    buffer_load_dwordx2 v[80:81], v11, s[4:7], s33 offen offset:0 sc1
    buffer_load_dwordx2 v[82:83], v11, s[4:7], s33 offen offset:64 sc1
    s_add_u32 s37, s30, s31
    s_mov_b32 s38, 24576
    s_add_u32 s39, s37, 1
    s_cmp_lt_u32 s37, s32
    s_cselect_b32 s39, s39, 256
    s_cmp_eq_u32 s28, 0
    s_cselect_b64 exec, -1, 0
    buffer_load_dwordx2 v[252:253], v254, s[4:7], s38 offen sc1
    s_mov_b64 exec, -1
    s_waitcnt vmcnt(31)
    v_mfma_f32_32x32x16_bf16 v[12:27], a[0:3], v[92:95], 0
    v_mfma_f32_32x32x16_bf16 v[28:43], a[4:7], v[92:95], 0
    s_waitcnt vmcnt(30)
    v_mfma_f32_32x32x16_bf16 v[12:27], a[8:11], v[96:99], v[12:27]
    v_mfma_f32_32x32x16_bf16 v[28:43], a[12:15], v[96:99], v[28:43]
    s_waitcnt vmcnt(29)
    v_mfma_f32_32x32x16_bf16 v[12:27], a[16:19], v[100:103], v[12:27]
    v_mfma_f32_32x32x16_bf16 v[28:43], a[20:23], v[100:103], v[28:43]
    s_waitcnt vmcnt(28)
    v_mfma_f32_32x32x16_bf16 v[12:27], a[24:27], v[104:107], v[12:27]
    v_mfma_f32_32x32x16_bf16 v[28:43], a[28:31], v[104:107], v[28:43]
    s_waitcnt vmcnt(27)
    v_mfma_f32_32x32x16_bf16 v[12:27], a[32:35], v[108:111], v[12:27]
    v_mfma_f32_32x32x16_bf16 v[28:43], a[36:39], v[108:111], v[28:43]
    s_waitcnt vmcnt(26)
    v_mfma_f32_32x32x16_bf16 v[12:27], a[40:43], v[112:115], v[12:27]
    v_mfma_f32_32x32x16_bf16 v[28:43], a[44:47], v[112:115], v[28:43]
    s_waitcnt vmcnt(25)
    v_mfma_f32_32x32x16_bf16 v[12:27], a[48:51], v[116:119], v[12:27]
    v_mfma_f32_32x32x16_bf16 v[28:43], a[52:55], v[116:119], v[28:43]
    s_waitcnt vmcnt(24)
    v_mfma_f32_32x32x16_bf16 v[12:27], a[56:59], v[120:123], v[12:27]
    v_mfma_f32_32x32x16_bf16 v[28:43], a[60:63], v[120:123], v[28:43]
    s_waitcnt vmcnt(23)
    v_mfma_f32_32x32x16_bf16 v[12:27], a[64:67], v[124:127], v[12:27]
    v_mfma_f32_32x32x16_bf16 v[28:43], a[68:71], v[124:127], v[28:43]
    s_waitcnt vmcnt(22)
    v_mfma_f32_32x32x16_bf16 v[12:27], a[72:75], v[128:131], v[12:27]
    v_mfma_f32_32x32x16_bf16 v[28:43], a[76:79], v[128:131], v[28:43]
    s_waitcnt vmcnt(21)
    v_mfma_f32_32x32x16_bf16 v[12:27], a[80:83], v[132:135], v[12:27]
    v_mfma_f32_32x32x16_bf16 v[28:43], a[84:87], v[132:135], v[28:43]
    s_waitcnt vmcnt(20)
    v_mfma_f32_32x32x16_bf16 v[12:27], a[88:91], v[136:139], v[12:27]
    v_mfma_f32_32x32x16_bf16 v[28:43], a[92:95], v[136:139], v[28:43]
    s_waitcnt vmcnt(19)
    v_mfma_f32_32x32x16_bf16 v[12:27], a[96:99], v[140:143], v[12:27]
    v_mfma_f32_32x32x16_bf16 v[28:43], a[100:103], v[140:143], v[28:43]
    s_waitcnt vmcnt(18)
    v_mfma_f32_32x32x16_bf16 v[12:27], a[104:107], v[144:147], v[12:27]
    v_mfma_f32_32x32x16_bf16 v[28:43], a[108:111], v[144:147], v[28:43]
    s_waitcnt vmcnt(17)
    v_mfma_f32_32x32x16_bf16 v[12:27], a[112:115], v[148:151], v[12:27]
    v_mfma_f32_32x32x16_bf16 v[28:43], a[116:119], v[148:151], v[28:43]
    s_waitcnt vmcnt(16)
    v_mfma_f32_32x32x16_bf16 v[12:27], a[120:123], v[152:155], v[12:27]
    v_mfma_f32_32x32x16_bf16 v[28:43], a[124:127], v[152:155], v[28:43]
    s_waitcnt vmcnt(15)
    v_mfma_f32_32x32x16_bf16 v[12:27], a[128:131], v[156:159], v[12:27]
    v_mfma_f32_32x32x16_bf16 v[28:43], a[132:135], v[156:159], v[28:43]
    s_waitcnt vmcnt(14)
    v_mfma_f32_32x32x16_bf16 v[12:27], a[136:139], v[160:163], v[12:27]
    v_mfma_f32_32x32x16_bf16 v[28:43], a[140:143], v[160:163], v[28:43]
    s_waitcnt vmcnt(13)
    v_mfma_f32_32x32x16_bf16 v[12:27], a[144:147], v[164:167], v[12:27]
    v_mfma_f32_32x32x16_bf16 v[28:43], a[148:151], v[164:167], v[28:43]
    s_waitcnt vmcnt(12)
    v_mfma_f32_32x32x16_bf16 v[12:27], a[152:155], v[168:171], v[12:27]
    v_mfma_f32_32x32x16_bf16 v[28:43], a[156:159], v[168:171], v[28:43]
    s_waitcnt vmcnt(11)
    v_mfma_f32_32x32x16_bf16 v[12:27], a[160:163], v[172:175], v[12:27]
    v_mfma_f32_32x32x16_bf16 v[28:43], a[164:167], v[172:175], v[28:43]
    s_waitcnt vmcnt(10)
    v_mfma_f32_32x32x16_bf16 v[12:27], a[168:171], v[176:179], v[12:27]
    v_mfma_f32_32x32x16_bf16 v[28:43], a[172:175], v[176:179], v[28:43]
    s_waitcnt vmcnt(9)
    v_mfma_f32_32x32x16_bf16 v[12:27], a[176:179], v[180:183], v[12:27]
    v_mfma_f32_32x32x16_bf16 v[28:43], a[180:183], v[180:183], v[28:43]
    s_waitcnt vmcnt(8)
    v_mfma_f32_32x32x16_bf16 v[12:27], a[184:187], v[184:187], v[12:27]
    v_mfma_f32_32x32x16_bf16 v[28:43], a[188:191], v[184:187], v[28:43]
    s_waitcnt vmcnt(7)
    v_mfma_f32_32x32x16_bf16 v[12:27], a[192:195], v[188:191], v[12:27]
    v_mfma_f32_32x32x16_bf16 v[28:43], a[196:199], v[188:191], v[28:43]
    s_waitcnt vmcnt(6)
    v_mfma_f32_32x32x16_bf16 v[12:27], a[200:203], v[192:195], v[12:27]
    v_mfma_f32_32x32x16_bf16 v[28:43], a[204:207], v[192:195], v[28:43]
    s_waitcnt vmcnt(5)
    v_mfma_f32_32x32x16_bf16 v[12:27], a[208:211], v[196:199], v[12:27]
    v_mfma_f32_32x32x16_bf16 v[28:43], a[212:215], v[196:199], v[28:43]
    s_waitcnt vmcnt(0)
    s_cmp_lg_u32 s28, 0
    s_cbranch_scc1 L_verd_3152
    v_subrev_u32 v252, s96, v252
    v_xor_b32 v253, s97, v253
    v_lshrrev_b32 v255, 8, v252
    v_or_b32 v253, v253, v255
    v_cmp_eq_u32 vcc, 0, v253
    s_nop 1
    v_cndmask_b32 v252, 0, v252, vcc
    v_cmp_gt_u32 vcc, s39, v252
    s_nop 0
    s_cmp_eq_u64 vcc, 0
    s_cselect_b32 s37, 1, 0
    v_mov_b32 v252, s37
    v_mov_b32 v253, 81920
    ds_write_b32 v253, v252
L_verd_3152:
    v_add_u32 v4, s60, v8
    v_add_u32 v5, s60, v9
    s_nop 5
    ds_write_b128 v4, v[12:15] offset:0
    ds_write_b128 v4, v[16:19] offset:1088
    ds_write_b128 v4, v[20:23] offset:2176
    ds_write_b128 v4, v[24:27] offset:3264
    ds_write_b128 v4, v[28:31] offset:4352
    ds_write_b128 v4, v[32:35] offset:5440
    ds_write_b128 v4, v[36:39] offset:6528
    ds_write_b128 v4, v[40:43] offset:7616
    s_xor_b32 s60, s60, 34816
    s_waitcnt lgkmcnt(0)
    s_barrier
    v_mov_b32 v253, 81920
    ds_read_b32 v252, v253
    ds_read_b128 v[44:47], v5 offset:0
    ds_read_b128 v[48:51], v5 offset:4352
    ds_read_b128 v[52:55], v5 offset:8704
    ds_read_b128 v[56:59], v5 offset:13056
    ds_read_b128 v[60:63], v5 offset:17408
    ds_read_b128 v[64:67], v5 offset:21760
    ds_read_b128 v[68:71], v5 offset:26112
    ds_read_b128 v[72:75], v5 offset:30464
    s_waitcnt lgkmcnt(8)
    v_readfirstlane_b32 s37, v252
    s_nop 0
    s_cmp_eq_u32 s37, 0
    s_cbranch_scc1 L_noah_3153
    buffer_load_dwordx4 v[92:95], v7, s[8:11], s40 offen offset:0 sc1
    buffer_load_dwordx4 v[96:99], v7, s[8:11], s40 offen offset:1024 sc1
    buffer_load_dwordx4 v[100:103], v7, s[8:11], s40 offen offset:2048 sc1
    buffer_load_dwordx4 v[104:107], v7, s[8:11], s40 offen offset:3072 sc1
    buffer_load_dwordx4 v[108:111], v7, s[8:11], s41 offen offset:0 sc1
    buffer_load_dwordx4 v[112:115], v7, s[8:11], s41 offen offset:1024 sc1
    buffer_load_dwordx4 v[116:119], v7, s[8:11], s41 offen offset:2048 sc1
    buffer_load_dwordx4 v[120:123], v7, s[8:11], s41 offen offset:3072 sc1
    buffer_load_dwordx4 v[124:127], v7, s[8:11], s42 offen offset:0 sc1
    buffer_load_dwordx4 v[128:131], v7, s[8:11], s42 offen offset:1024 sc1
    buffer_load_dwordx4 v[132:135], v7, s[8:11], s42 offen offset:2048 sc1
    buffer_load_dwordx4 v[136:139], v7, s[8:11], s42 offen offset:3072 sc1
    buffer_load_dwordx4 v[140:143], v7, s[8:11], s43 offen offset:0 sc1
    buffer_load_dwordx4 v[144:147], v7, s[8:11], s43 offen offset:1024 sc1
    buffer_load_dwordx4 v[148:151], v7, s[8:11], s43 offen offset:2048 sc1
    buffer_load_dwordx4 v[152:155], v7, s[8:11], s43 offen offset:3072 sc1
    buffer_load_dwordx4 v[156:159], v7, s[8:11], s44 offen offset:0 sc1
    buffer_load_dwordx4 v[160:163], v7, s[8:11], s44 offen offset:1024 sc1
    buffer_load_dwordx4 v[164:167], v7, s[8:11], s44 offen offset:2048 sc1
    buffer_load_dwordx4 v[168:171], v7, s[8:11], s44 offen offset:3072 sc1
    buffer_load_dwordx4 v[172:175], v7, s[8:11], s45 offen offset:0 sc1
    buffer_load_dwordx4 v[176:179], v7, s[8:11], s45 offen offset:1024 sc1
    buffer_load_dwordx4 v[180:183], v7, s[8:11], s45 offen offset:2048 sc1
    buffer_load_dwordx4 v[184:187], v7, s[8:11], s45 offen offset:3072 sc1
    buffer_load_dwordx4 v[188:191], v7, s[8:11], s46 offen offset:0 sc1
    buffer_load_dwordx4 v[192:195], v7, s[8:11], s46 offen offset:1024 sc1
    buffer_load_dwordx4 v[196:199], v7, s[8:11], s46 offen offset:2048 sc1
L_noah_3153:
    s_waitcnt lgkmcnt(4)
    v_add_f32 v44, v44, v52
    v_add_f32 v45, v45, v53
    v_add_f32 v46, v46, v54
    v_add_f32 v47, v47, v55
    v_add_f32 v48, v48, v56
    v_add_f32 v49, v49, v57
    v_add_f32 v50, v50, v58
    v_add_f32 v51, v51, v59
    s_waitcnt lgkmcnt(0)
    v_add_f32 v60, v60, v68
    v_add_f32 v61, v61, v69
    v_add_f32 v62, v62, v70
    v_add_f32 v63, v63, v71
    v_add_f32 v64, v64, v72
    v_add_f32 v65, v65, v73
    v_add_f32 v66, v66, v74
    v_add_f32 v67, v67, v75
    v_add_f32 v44, v44, v60
    v_add_f32 v45, v45, v61
    v_add_f32 v46, v46, v62
    v_add_f32 v47, v47, v63
    v_add_f32 v48, v48, v64
    v_add_f32 v49, v49, v65
    v_add_f32 v50, v50, v66
    v_add_f32 v51, v51, v67
    v_cvt_pk_bf16_f32 v52, v44, v45
    v_lshlrev_b32 v44, 16, v52
    v_and_b32 v45, 0xffff0000, v52
    v_cvt_pk_bf16_f32 v53, v46, v47
    v_lshlrev_b32 v46, 16, v53
    v_and_b32 v47, 0xffff0000, v53
    v_cvt_pk_bf16_f32 v54, v48, v49
    v_lshlrev_b32 v48, 16, v54
    v_and_b32 v49, 0xffff0000, v54
    v_cvt_pk_bf16_f32 v55, v50, v51
    v_lshlrev_b32 v50, 16, v55
    v_and_b32 v51, 0xffff0000, v55
    v_and_b32 v61, 0xffff0000, v76
    v_lshlrev_b32 v60, 16, v76
    v_and_b32 v63, 0xffff0000, v77
    v_lshlrev_b32 v62, 16, v77
    v_and_b32 v65, 0xffff0000, v78
    v_lshlrev_b32 v64, 16, v78
    v_and_b32 v67, 0xffff0000, v79
    v_lshlrev_b32 v66, 16, v79
    v_add_f32 v44, v44, v60
    v_add_f32 v45, v45, v61
    v_add_f32 v46, v46, v62
    v_add_f32 v47, v47, v63
    v_add_f32 v48, v48, v64
    v_add_f32 v49, v49, v65
    v_add_f32 v50, v50, v66
    v_add_f32 v51, v51, v67
    v_cvt_pk_bf16_f32 v52, v44, v45
    v_lshlrev_b32 v44, 16, v52
    v_and_b32 v45, 0xffff0000, v52
    v_cvt_pk_bf16_f32 v53, v46, v47
    v_lshlrev_b32 v46, 16, v53
    v_and_b32 v47, 0xffff0000, v53
    v_cvt_pk_bf16_f32 v54, v48, v49
    v_lshlrev_b32 v48, 16, v54
    v_and_b32 v49, 0xffff0000, v54
    v_cvt_pk_bf16_f32 v55, v50, v51
    v_lshlrev_b32 v50, 16, v55
    v_and_b32 v51, 0xffff0000, v55
    v_mul_f32 v44, v44, v84
    v_mul_f32 v45, v45, v85
    v_mul_f32 v46, v46, v86
    v_mul_f32 v47, v47, v87
    v_mul_f32 v48, v48, v88
    v_mul_f32 v49, v49, v89
    v_mul_f32 v50, v50, v90
    v_mul_f32 v51, v51, v91
    v_cvt_pk_bf16_f32 v52, v44, v45
    v_lshlrev_b32 v44, 16, v52
    v_and_b32 v45, 0xffff0000, v52
    v_cvt_pk_bf16_f32 v53, v46, v47
    v_lshlrev_b32 v46, 16, v53
    v_and_b32 v47, 0xffff0000, v53
    v_cvt_pk_bf16_f32 v54, v48, v49
    v_lshlrev_b32 v48, 16, v54
    v_and_b32 v49, 0xffff0000, v54
    v_cvt_pk_bf16_f32 v55, v50, v51
    v_lshlrev_b32 v50, 16, v55
    v_and_b32 v51, 0xffff0000, v55
    v_and_b32 v61, 0xffff0000, v80
    v_lshlrev_b32 v60, 16, v80
    v_and_b32 v63, 0xffff0000, v81
    v_lshlrev_b32 v62, 16, v81
    v_and_b32 v65, 0xffff0000, v82
    v_lshlrev_b32 v64, 16, v82
    v_and_b32 v67, 0xffff0000, v83
    v_lshlrev_b32 v66, 16, v83
    v_add_f32 v44, v44, v60
    v_add_f32 v45, v45, v61
    v_add_f32 v46, v46, v62
    v_add_f32 v47, v47, v63
    v_add_f32 v48, v48, v64
    v_add_f32 v49, v49, v65
    v_add_f32 v50, v50, v66
    v_add_f32 v51, v51, v67
    v_cvt_pk_bf16_f32 v52, v44, v45
    v_cvt_pk_bf16_f32 v53, v46, v47
    v_cvt_pk_bf16_f32 v54, v48, v49
    v_cvt_pk_bf16_f32 v55, v50, v51
    buffer_store_dwordx2 v[52:53], v11, s[16:19], s61 offen offset:0
    buffer_store_dwordx2 v[54:55], v11, s[16:19], s61 offen offset:64
    s_add_u32 s30, s30, s31
    s_cmp_lt_u32 s30, s32
    s_cbranch_scc1 L_m4_3147
    s_waitcnt vmcnt(0)
    s_branch L_fin_3091
L_at_3088:
    s_mul_i32 s33, s30, 8
    s_add_u32 s33, s33, s29
    s_lshl_b32 s99, s33, 3
    s_add_u32 s99, s99, 12288
    s_cmp_ge_u32 s28, 3
    s_cbranch_scc1 L_wm_3154
    s_lshl_b32 s33, s28, 9
    s_add_u32 s33, s33, 8192
    v_and_b32 v254, 63, v0
    v_min_u32 v254, 63, v254
    v_lshlrev_b32 v254, 3, v254
L_poll_3155:
    buffer_load_dwordx2 v[252:253], v254, s[4:7], s33 offen sc1
    s_waitcnt vmcnt(0)
    v_subrev_u32 v252, s96, v252
    v_xor_b32 v253, s97, v253
    v_lshrrev_b32 v255, 8, v252
    v_or_b32 v253, v253, v255
    v_cmp_eq_u32 vcc, 0, v253
    s_nop 1
    v_cndmask_b32 v252, 0, v252, vcc
    v_cmp_gt_u32 vcc, 255, v252
    s_cbranch_vccz L_ok_3156
    s_sleep 2
    s_sub_u32 s98, s98, 1
    s_cbranch_scc0 L_poll_3155
    s_mov_b32 s98, 0
L_ok_3156:
L_wm_3154:
    s_barrier
    s_load_dwordx2 s[26:27], s[0:1], 128
    v_lshrrev_b32 v1, 6, v0
    s_nop 0
    v_readfirstlane_b32 s28, v1
    s_waitcnt lgkmcnt(0)
    s_mov_b32 s4, s26
    s_and_b32 s5, s27, 0xffff
    s_mov_b32 s6, 268435456
    s_mov_b32 s7, 0x20000
    s_lshl_b32 s56, s29, 2
    s_add_u32 s56, s56, s28
    s_lshl_b32 s59, s28, 11
    v_and_b32 v1, 63, v0
    v_bfe_u32 v2, v0, 4, 2
    v_lshlrev_b32 v8, 4, v1
    v_and_b32 v3, 1, v2
    v_lshlrev_b32 v5, 10, v3
    v_lshrrev_b32 v3, 1, v2
    v_lshl_add_u32 v5, v3, 8, v5
    v_and_b32 v4, 15, v1
    v_lshl_add_u32 v5, v4, 4, v5
    v_lshlrev_b32 v7, 3, v3
    v_and_b32 v4, 31, v1
    v_lshl_add_u32 v7, v4, 4, v7
    v_lshlrev_b32 v6, 6, v3
    v_bfe_u32 v10, v1, 2, 2
    v_lshl_add_u32 v6, v10, 4, v6
    v_and_b32 v10, 1, v1
    v_lshl_add_u32 v6, v10, 3, v6
    v_add_u32 v6, s59, v6
    v_lshlrev_b32 v3, 2, v3
    v_sub_u32 v4, v4, v3
    v_cmp_le_i32 s[60:61], 0, v4
    v_cmp_le_i32 s[62:63], 1, v4
    v_cmp_le_i32 s[64:65], 2, v4
    v_cmp_le_i32 s[66:67], 3, v4
    v_cmp_le_i32 s[68:69], 8, v4
    v_cmp_le_i32 s[70:71], 9, v4
    v_cmp_le_i32 s[72:73], 10, v4
    v_cmp_le_i32 s[74:75], 11, v4
    v_cmp_le_i32 s[76:77], 16, v4
    v_cmp_le_i32 s[78:79], 17, v4
    v_cmp_le_i32 s[80:81], 18, v4
    v_cmp_le_i32 s[82:83], 19, v4
    v_cmp_le_i32 s[84:85], 24, v4
    v_cmp_le_i32 s[86:87], 25, v4
    v_cmp_le_i32 s[88:89], 26, v4
    v_cmp_le_i32 s[90:91], 27, v4
    s_mov_b32 s48, 0x3db504f3
    s_mov_b32 s49, 0x3fb8aa3b
    v_mov_b32 v11, 0xce6e0000
L_attn_3157:
    s_lshl_b32 s33, s30, 5
    s_add_u32 s33, s33, s56
    s_lshl_b32 s58, s33, 11
    s_lshl_b32 s57, s33, 13
    s_add_u32 s33, s57, 37748736
    buffer_load_dwordx4 v[48:51], v5, s[4:7], s33 offen offset:0 sc1
    buffer_load_dwordx4 v[52:55], v5, s[4:7], s33 offen offset:512 sc1
    buffer_load_dwordx4 v[56:59], v5, s[4:7], s33 offen offset:2048 sc1
    buffer_load_dwordx4 v[60:63], v5, s[4:7], s33 offen offset:2560 sc1
    s_add_u32 s33, s57, 37752832
    buffer_load_dwordx4 v[64:67], v5, s[4:7], s33 offen offset:0 sc1
    buffer_load_dwordx4 v[68:71], v5, s[4:7], s33 offen offset:512 sc1
    buffer_load_dwordx4 v[72:75], v5, s[4:7], s33 offen offset:2048 sc1
    buffer_load_dwordx4 v[76:79], v5, s[4:7], s33 offen offset:2560 sc1
    s_add_u32 s33, s57, 20971520
    buffer_load_dwordx4 v[16:19], v5, s[4:7], s33 offen offset:0 sc1
    buffer_load_dwordx4 v[20:23], v5, s[4:7], s33 offen offset:512 sc1
    buffer_load_dwordx4 v[24:27], v5, s[4:7], s33 offen offset:2048 sc1
    buffer_load_dwordx4 v[28:31], v5, s[4:7], s33 offen offset:2560 sc1
    s_add_u32 s33, s57, 20975616
    buffer_load_dwordx4 v[32:35], v5, s[4:7], s33 offen offset:0 sc1
    buffer_load_dwordx4 v[36:39], v5, s[4:7], s33 offen offset:512 sc1
    buffer_load_dwordx4 v[40:43], v5, s[4:7], s33 offen offset:2048 sc1
    buffer_load_dwordx4 v[44:47], v5, s[4:7], s33 offen offset:2560 sc1
    s_add_u32 s33, s57, 54525952
    buffer_load_dwordx4 v[80:83], v5, s[4:7], s33 offen offset:0 sc1
    buffer_load_dwordx4 v[84:87], v5, s[4:7], s33 offen offset:512 sc1
    buffer_load_dwordx4 v[88:91], v5, s[4:7], s33 offen offset:2048 sc1
    buffer_load_dwordx4 v[92:95], v5, s[4:7], s33 offen offset:2560 sc1
    s_add_u32 s33, s57, 54530048
    buffer_load_dwordx4 v[96:99], v5, s[4:7], s33 offen offset:0 sc1
    buffer_load_dwordx4 v[100:103], v5, s[4:7], s33 offen offset:512 sc1
    buffer_load_dwordx4 v[104:107], v5, s[4:7], s33 offen offset:2048 sc1
    buffer_load_dwordx4 v[108:111], v5, s[4:7], s33 offen offset:2560 sc1
    s_waitcnt vmcnt(15)
    v_mfma_f32_32x32x16_bf16 v[152:167], v[48:51], v[16:19], 0
    s_waitcnt vmcnt(14)
    v_mfma_f32_32x32x16_bf16 v[152:167], v[52:55], v[20:23], v[152:167]
    s_waitcnt vmcnt(13)
    v_mfma_f32_32x32x16_bf16 v[152:167], v[56:59], v[24:27], v[152:167]
    s_waitcnt vmcnt(12)
    v_mfma_f32_32x32x16_bf16 v[152:167], v[60:63], v[28:31], v[152:167]
    s_waitcnt vmcnt(11)
    v_mfma_f32_32x32x16_bf16 v[152:167], v[64:67], v[32:35], v[152:167]
    s_waitcnt vmcnt(10)
    v_mfma_f32_32x32x16_bf16 v[152:167], v[68:71], v[36:39], v[152:167]
    s_waitcnt vmcnt(9)
    v_mfma_f32_32x32x16_bf16 v[152:167], v[72:75], v[40:43], v[152:167]
    s_waitcnt vmcnt(8)
    v_mfma_f32_32x32x16_bf16 v[152:167], v[76:79], v[44:47], v[152:167]
    s_nop 11
    v_cvt_pk_bf16_f32 v10, v152, v153
    v_lshlrev_b32 v152, 16, v10
    v_and_b32 v153, 0xffff0000, v10
    v_cvt_pk_bf16_f32 v10, v154, v155
    v_lshlrev_b32 v154, 16, v10
    v_and_b32 v155, 0xffff0000, v10
    v_cvt_pk_bf16_f32 v10, v156, v157
    v_lshlrev_b32 v156, 16, v10
    v_and_b32 v157, 0xffff0000, v10
    v_cvt_pk_bf16_f32 v10, v158, v159
    v_lshlrev_b32 v158, 16, v10
    v_and_b32 v159, 0xffff0000, v10
    v_cvt_pk_bf16_f32 v10, v160, v161
    v_lshlrev_b32 v160, 16, v10
    v_and_b32 v161, 0xffff0000, v10
    v_cvt_pk_bf16_f32 v10, v162, v163
    v_lshlrev_b32 v162, 16, v10
    v_and_b32 v163, 0xffff0000, v10
    v_cvt_pk_bf16_f32 v10, v164, v165
    v_lshlrev_b32 v164, 16, v10
    v_and_b32 v165, 0xffff0000, v10
    v_cvt_pk_bf16_f32 v10, v166, v167
    v_lshlrev_b32 v166, 16, v10
    v_and_b32 v167, 0xffff0000, v10
    v_mul_f32 v152, s48, v152
    v_mul_f32 v153, s48, v153
    v_mul_f32 v154, s48, v154
    v_mul_f32 v155, s48, v155
    v_mul_f32 v156, s48, v156
    v_mul_f32 v157, s48, v157
    v_mul_f32 v158, s48, v158
    v_mul_f32 v159, s48, v159
    v_mul_f32 v160, s48, v160
    v_mul_f32 v161, s48, v161
    v_mul_f32 v162, s48, v162
    v_mul_f32 v163, s48, v163
    v_mul_f32 v164, s48, v164
    v_mul_f32 v165, s48, v165
    v_mul_f32 v166, s48, v166
    v_mul_f32 v167, s48, v167
    v_cvt_pk_bf16_f32 v10, v152, v153
    v_lshlrev_b32 v152, 16, v10
    v_and_b32 v153, 0xffff0000, v10
    v_cvt_pk_bf16_f32 v10, v154, v155
    v_lshlrev_b32 v154, 16, v10
    v_and_b32 v155, 0xffff0000, v10
    v_cvt_pk_bf16_f32 v10, v156, v157
    v_lshlrev_b32 v156, 16, v10
    v_and_b32 v157, 0xffff0000, v10
    v_cvt_pk_bf16_f32 v10, v158, v159
    v_lshlrev_b32 v158, 16, v10
    v_and_b32 v159, 0xffff0000, v10
    v_cvt_pk_bf16_f32 v10, v160, v161
    v_lshlrev_b32 v160, 16, v10
    v_and_b32 v161, 0xffff0000, v10
    v_cvt_pk_bf16_f32 v10, v162, v163
    v_lshlrev_b32 v162, 16, v10
    v_and_b32 v163, 0xffff0000, v10
    v_cvt_pk_bf16_f32 v10, v164, v165
    v_lshlrev_b32 v164, 16, v10
    v_and_b32 v165, 0xffff0000, v10
    v_cvt_pk_bf16_f32 v10, v166, v167
    v_lshlrev_b32 v166, 16, v10
    v_and_b32 v167, 0xffff0000, v10
    v_cndmask_b32 v152, v11, v152, s[60:61]
    v_cndmask_b32 v153, v11, v153, s[62:63]
    v_cndmask_b32 v154, v11, v154, s[64:65]
    v_cndmask_b32 v155, v11, v155, s[66:67]
    v_cndmask_b32 v156, v11, v156, s[68:69]
    v_cndmask_b32 v157, v11, v157, s[70:71]
    v_cndmask_b32 v158, v11, v158, s[72:73]
    v_cndmask_b32 v159, v11, v159, s[74:75]
    v_cndmask_b32 v160, v11, v160, s[76:77]
    v_cndmask_b32 v161, v11, v161, s[78:79]
    v_cndmask_b32 v162, v11, v162, s[80:81]
    v_cndmask_b32 v163, v11, v163, s[82:83]
    v_cndmask_b32 v164, v11, v164, s[84:85]
    v_cndmask_b32 v165, v11, v165, s[86:87]
    v_cndmask_b32 v166, v11, v166, s[88:89]
    v_cndmask_b32 v167, v11, v167, s[90:91]
    s_mov_b32 s38, 10240
    s_lshl_b32 s39, s29, 6
    s_add_u32 s38, s38, s39
    s_add_u32 s39, s30, 1
    s_cmp_lg_u32 s28, 0
    s_cbranch_scc1 L_wf_3158
    v_and_b32 v254, 63, v0
    v_min_u32 v254, 7, v254
    v_lshlrev_b32 v254, 3, v254
L_poll_3159:
    buffer_load_dwordx2 v[252:253], v254, s[4:7], s38 offen sc1
    s_waitcnt vmcnt(0)
    v_subrev_u32 v252, s96, v252
    v_xor_b32 v253, s97, v253
    v_lshrrev_b32 v255, 8, v252
    v_or_b32 v253, v253, v255
    v_cmp_eq_u32 vcc, 0, v253
    s_nop 1
    v_cndmask_b32 v252, 0, v252, vcc
    v_cmp_gt_u32 vcc, s39, v252
    s_cbranch_vccz L_ok_3160
    s_sleep 2
    s_sub_u32 s98, s98, 1
    s_cbranch_scc0 L_poll_3159
    s_mov_b32 s98, 0
L_ok_3160:
L_wf_3158:
    s_barrier
    s_add_u32 s33, s58, 12582912
    s_add_u32 m0, s59, 0
    s_nop 0
    buffer_load_dwordx4 v8, s[4:7], s33 offen sc1 lds
    s_add_u32 s33, s33, 1024
    s_add_u32 m0, s59, 1024
    s_nop 0
    buffer_load_dwordx4 v8, s[4:7], s33 offen sc1 lds
    s_add_u32 s33, s33, 1024
    s_add_u32 s33, s58, 16777216
    buffer_load_dwordx2 v[144:145], v7, s[4:7], s33 offen offset:0 sc1
    buffer_load_dwordx2 v[146:147], v7, s[4:7], s33 offen offset:512 sc1
    buffer_load_dwordx2 v[148:149], v7, s[4:7], s33 offen offset:1024 sc1
    buffer_load_dwordx2 v[150:151], v7, s[4:7], s33 offen offset:1536 sc1
    s_waitcnt vmcnt(4)
    ds_read_b64_tr_b16 v[112:113], v6 offset:0
    ds_read_b64_tr_b16 v[114:115], v6 offset:128
    ds_read_b64_tr_b16 v[116:117], v6 offset:256
    ds_read_b64_tr_b16 v[118:119], v6 offset:384
    ds_read_b64_tr_b16 v[120:121], v6 offset:512
    ds_read_b64_tr_b16 v[122:123], v6 offset:640
    ds_read_b64_tr_b16 v[124:125], v6 offset:768
    ds_read_b64_tr_b16 v[126:127], v6 offset:896
    ds_read_b64_tr_b16 v[128:129], v6 offset:1024
    ds_read_b64_tr_b16 v[130:131], v6 offset:1152
    ds_read_b64_tr_b16 v[132:133], v6 offset:1280
    ds_read_b64_tr_b16 v[134:135], v6 offset:1408
    ds_read_b64_tr_b16 v[136:137], v6 offset:1536
    ds_read_b64_tr_b16 v[138:139], v6 offset:1664
    ds_read_b64_tr_b16 v[140:141], v6 offset:1792
    ds_read_b64_tr_b16 v[142:143], v6 offset:1920
    s_waitcnt lgkmcnt(14)
    v_mfma_f32_32x32x16_bf16 v[168:183], v[112:115], v[16:19], 0
    s_waitcnt lgkmcnt(12)
    v_mfma_f32_32x32x16_bf16 v[168:183], v[116:119], v[20:23], v[168:183]
    s_waitcnt lgkmcnt(10)
    v_mfma_f32_32x32x16_bf16 v[168:183], v[120:123], v[24:27], v[168:183]
    s_waitcnt lgkmcnt(8)
    v_mfma_f32_32x32x16_bf16 v[168:183], v[124:127], v[28:31], v[168:183]
    s_waitcnt lgkmcnt(6)
    v_mfma_f32_32x32x16_bf16 v[168:183], v[128:131], v[32:35], v[168:183]
    s_waitcnt lgkmcnt(4)
    v_mfma_f32_32x32x16_bf16 v[168:183], v[132:135], v[36:39], v[168:183]
    s_waitcnt lgkmcnt(2)
    v_mfma_f32_32x32x16_bf16 v[168:183], v[136:139], v[40:43], v[168:183]
    s_waitcnt lgkmcnt(0)
    v_mfma_f32_32x32x16_bf16 v[168:183], v[140:143], v[44:47], v[168:183]
    s_nop 11
    v_cvt_pk_bf16_f32 v10, v168, v169
    v_lshlrev_b32 v168, 16, v10
    v_and_b32 v169, 0xffff0000, v10
    v_cvt_pk_bf16_f32 v10, v170, v171
    v_lshlrev_b32 v170, 16, v10
    v_and_b32 v171, 0xffff0000, v10
    v_mul_f32 v168, s48, v168
    v_mul_f32 v169, s48, v169
    v_mul_f32 v170, s48, v170
    v_mul_f32 v171, s48, v171
    v_cvt_pk_bf16_f32 v10, v168, v169
    v_lshlrev_b32 v168, 16, v10
    v_and_b32 v169, 0xffff0000, v10
    v_cvt_pk_bf16_f32 v10, v170, v171
    v_lshlrev_b32 v170, 16, v10
    v_and_b32 v171, 0xffff0000, v10
    v_max3_f32 v9, v152, v153, v154
    v_max3_f32 v9, v9, v155, v156
    v_max3_f32 v9, v9, v157, v158
    v_max3_f32 v9, v9, v159, v160
    v_max3_f32 v9, v9, v161, v162
    v_max3_f32 v9, v9, v163, v164
    v_max3_f32 v9, v9, v165, v166
    v_max3_f32 v9, v9, v167, v168
    v_max3_f32 v9, v9, v169, v170
    v_max_f32 v9, v9, v171
    v_mov_b32 v10, v9
    s_nop 1
    v_permlane32_swap_b32 v9, v10
    v_max_f32 v9, v9, v10
    v_sub_f32 v152, v152, v9
    v_sub_f32 v153, v153, v9
    v_sub_f32 v154, v154, v9
    v_sub_f32 v155, v155, v9
    v_sub_f32 v156, v156, v9
    v_sub_f32 v157, v157, v9
    v_sub_f32 v158, v158, v9
    v_sub_f32 v159, v159, v9
    v_sub_f32 v160, v160, v9
    v_sub_f32 v161, v161, v9
    v_sub_f32 v162, v162, v9
    v_sub_f32 v163, v163, v9
    v_sub_f32 v164, v164, v9
    v_sub_f32 v165, v165, v9
    v_sub_f32 v166, v166, v9
    v_sub_f32 v167, v167, v9
    v_sub_f32 v168, v168, v9
    v_sub_f32 v169, v169, v9
    v_sub_f32 v170, v170, v9
    v_sub_f32 v171, v171, v9
    v_mul_f32 v152, s49, v152
    v_mul_f32 v153, s49, v153
    v_mul_f32 v154, s49, v154
    v_mul_f32 v155, s49, v155
    v_mul_f32 v156, s49, v156
    v_mul_f32 v157, s49, v157
    v_mul_f32 v158, s49, v158
    v_mul_f32 v159, s49, v159
    v_mul_f32 v160, s49, v160
    v_mul_f32 v161, s49, v161
    v_mul_f32 v162, s49, v162
    v_mul_f32 v163, s49, v163
    v_mul_f32 v164, s49, v164
    v_mul_f32 v165, s49, v165
    v_mul_f32 v166, s49, v166
    v_mul_f32 v167, s49, v167
    v_mul_f32 v168, s49, v168
    v_mul_f32 v169, s49, v169
    v_mul_f32 v170, s49, v170
    v_mul_f32 v171, s49, v171
    v_exp_f32 v152, v152
    v_exp_f32 v153, v153
    v_exp_f32 v154, v154
    v_exp_f32 v155, v155
    v_exp_f32 v156, v156
    v_exp_f32 v157, v157
    v_exp_f32 v158, v158
    v_exp_f32 v159, v159
    v_exp_f32 v160, v160
    v_exp_f32 v161, v161
    v_exp_f32 v162, v162
    v_exp_f32 v163, v163
    v_exp_f32 v164, v164
    v_exp_f32 v165, v165
    v_exp_f32 v166, v166
    v_exp_f32 v167, v167
    v_exp_f32 v168, v168
    v_exp_f32 v169, v169
    v_exp_f32 v170, v170
    v_exp_f32 v171, v171
    v_add_f32 v9, v152, v153
    v_add_f32 v10, v154, v155
    v_add_f32 v9, v9, v156
    v_add_f32 v10, v10, v157
    v_add_f32 v9, v9, v158
    v_add_f32 v10, v10, v159
    v_add_f32 v9, v9, v160
    v_add_f32 v10, v10, v161
    v_add_f32 v9, v9, v162
    v_add_f32 v10, v10, v163
    v_add_f32 v9, v9, v164
    v_add_f32 v10, v10, v165
    v_add_f32 v9, v9, v166
    v_add_f32 v10, v10, v167
    v_add_f32 v9, v9, v168
    v_add_f32 v10, v10, v169
    v_add_f32 v9, v9, v170
    v_add_f32 v10, v10, v171
    v_add_f32 v9, v9, v10
    v_mov_b32 v10, v9
    s_nop 1
    v_permlane32_swap_b32 v9, v10
    v_add_f32 v9, v9, v10
    v_rcp_f32 v9, v9
    s_nop 0
    v_mul_f32 v152, v152, v9
    v_mul_f32 v153, v153, v9
    v_mul_f32 v154, v154, v9
    v_mul_f32 v155, v155, v9
    v_mul_f32 v156, v156, v9
    v_mul_f32 v157, v157, v9
    v_mul_f32 v158, v158, v9
    v_mul_f32 v159, v159, v9
    v_mul_f32 v160, v160, v9
    v_mul_f32 v161, v161, v9
    v_mul_f32 v162, v162, v9
    v_mul_f32 v163, v163, v9
    v_mul_f32 v164, v164, v9
    v_mul_f32 v165, v165, v9
    v_mul_f32 v166, v166, v9
    v_mul_f32 v167, v167, v9
    v_mul_f32 v168, v168, v9
    v_mul_f32 v169, v169, v9
    v_mul_f32 v170, v170, v9
    v_mul_f32 v171, v171, v9
    v_cvt_pk_bf16_f32 v184, v152, v153
    v_cvt_pk_bf16_f32 v185, v154, v155
    v_cvt_pk_bf16_f32 v186, v160, v161
    v_cvt_pk_bf16_f32 v187, v162, v163
    v_cvt_pk_bf16_f32 v188, v156, v157
    v_cvt_pk_bf16_f32 v189, v158, v159
    v_cvt_pk_bf16_f32 v190, v164, v165
    v_cvt_pk_bf16_f32 v191, v166, v167
    v_cvt_pk_bf16_f32 v192, v168, v169
    v_cvt_pk_bf16_f32 v193, v170, v171
    s_waitcnt vmcnt(0)
    s_nop 0
    v_mfma_f32_32x32x8_bf16 v[16:31], v[144:145], v[192:193], 0
    v_mfma_f32_32x32x8_bf16 v[32:47], v[146:147], v[192:193], 0
    v_mfma_f32_32x32x8_bf16 v[48:63], v[148:149], v[192:193], 0
    v_mfma_f32_32x32x8_bf16 v[64:79], v[150:151], v[192:193], 0
    s_nop 6
    v_mfma_f32_32x32x16_bf16 v[16:31], v[80:83], v[184:187], v[16:31]
    v_mfma_f32_32x32x16_bf16 v[32:47], v[88:91], v[184:187], v[32:47]
    v_mfma_f32_32x32x16_bf16 v[48:63], v[96:99], v[184:187], v[48:63]
    v_mfma_f32_32x32x16_bf16 v[64:79], v[104:107], v[184:187], v[64:79]
    v_mfma_f32_32x32x16_bf16 v[16:31], v[84:87], v[188:191], v[16:31]
    v_mfma_f32_32x32x16_bf16 v[32:47], v[92:95], v[188:191], v[32:47]
    v_mfma_f32_32x32x16_bf16 v[48:63], v[100:103], v[188:191], v[48:63]
    v_mfma_f32_32x32x16_bf16 v[64:79], v[108:111], v[188:191], v[64:79]
    s_add_u32 s33, s57, 71303168
    s_add_u32 s34, s33, 4096
    s_nop 6
    v_cvt_pk_bf16_f32 v112, v16, v17
    v_cvt_pk_bf16_f32 v113, v18, v19
    v_cvt_pk_bf16_f32 v114, v20, v21
    v_cvt_pk_bf16_f32 v115, v22, v23
    v_cvt_pk_bf16_f32 v116, v24, v25
    v_cvt_pk_bf16_f32 v117, v26, v27
    v_cvt_pk_bf16_f32 v118, v28, v29
    v_cvt_pk_bf16_f32 v119, v30, v31
    buffer_store_dwordx4 v[112:115], v8, s[4:7], s33 offen offset:0 sc1
    buffer_store_dwordx4 v[116:119], v8, s[4:7], s33 offen offset:1024 sc1
    v_cvt_pk_bf16_f32 v120, v32, v33
    v_cvt_pk_bf16_f32 v121, v34, v35
    v_cvt_pk_bf16_f32 v122, v36, v37
    v_cvt_pk_bf16_f32 v123, v38, v39
    v_cvt_pk_bf16_f32 v124, v40, v41
    v_cvt_pk_bf16_f32 v125, v42, v43
    v_cvt_pk_bf16_f32 v126, v44, v45
    v_cvt_pk_bf16_f32 v127, v46, v47
    buffer_store_dwordx4 v[120:123], v8, s[4:7], s33 offen offset:2048 sc1
    buffer_store_dwordx4 v[124:127], v8, s[4:7], s33 offen offset:3072 sc1
    v_cvt_pk_bf16_f32 v128, v48, v49
    v_cvt_pk_bf16_f32 v129, v50, v51
    v_cvt_pk_bf16_f32 v130, v52, v53
    v_cvt_pk_bf16_f32 v131, v54, v55
    v_cvt_pk_bf16_f32 v132, v56, v57
    v_cvt_pk_bf16_f32 v133, v58, v59
    v_cvt_pk_bf16_f32 v134, v60, v61
    v_cvt_pk_bf16_f32 v135, v62, v63
    buffer_store_dwordx4 v[128:131], v8, s[4:7], s34 offen offset:0 sc1
    buffer_store_dwordx4 v[132:135], v8, s[4:7], s34 offen offset:1024 sc1
    v_cvt_pk_bf16_f32 v136, v64, v65
    v_cvt_pk_bf16_f32 v137, v66, v67
    v_cvt_pk_bf16_f32 v138, v68, v69
    v_cvt_pk_bf16_f32 v139, v70, v71
    v_cvt_pk_bf16_f32 v140, v72, v73
    v_cvt_pk_bf16_f32 v141, v74, v75
    v_cvt_pk_bf16_f32 v142, v76, v77
    v_cvt_pk_bf16_f32 v143, v78, v79
    buffer_store_dwordx4 v[136:139], v8, s[4:7], s34 offen offset:2048 sc1
    buffer_store_dwordx4 v[140:143], v8, s[4:7], s34 offen offset:3072 sc1
    s_add_u32 s34, s30, s31
    s_waitcnt vmcnt(0)
    s_barrier
    s_cmp_lg_u32 s28, 0
    s_cbranch_scc1 L_sig_3161
    s_add_u32 s33, s96, s34
    v_mov_b32 v252, s33
    v_mov_b32 v253, s97
    s_mov_b64 exec, 1
    buffer_store_dwordx2 v[252:253], off, s[4:7], s99 sc1
    s_mov_b64 exec, -1
L_sig_3161:
    s_add_u32 s30, s30, s31
    s_cmp_lt_u32 s30, s32
    s_cbranch_scc1 L_attn_3157
    s_waitcnt vmcnt(0)
    s_branch L_fin_3091
L_ln23_3089:
    s_mul_i32 s33, s30, 8
    s_add_u32 s33, s33, s29
    s_lshl_b32 s99, s33, 3
    s_add_u32 s99, s99, 16384
    s_mov_b32 s35, 4416
    s_cmp_lg_u32 s28, 0
    s_cbranch_scc1 L_wf_3162
    v_and_b32 v254, 63, v0
    v_min_u32 v254, 59, v254
    v_lshlrev_b32 v254, 3, v254
L_poll_3163:
    buffer_load_dwordx2 v[252:253], v254, s[4:7], s35 offen sc1
    s_waitcnt vmcnt(0)
    v_subrev_u32 v252, s96, v252
    v_xor_b32 v253, s97, v253
    v_lshrrev_b32 v255, 8, v252
    v_or_b32 v253, v253, v255
    v_cmp_eq_u32 vcc, 0, v253
    s_nop 1
    v_cndmask_b32 v252, 0, v252, vcc
    v_cmp_gt_u32 vcc, 1, v252
    s_cbranch_vccz L_ok_3164
    s_sleep 2
    s_sub_u32 s98, s98, 1
    s_cbranch_scc0 L_poll_3163
    s_mov_b32 s98, 0
L_ok_3164:
L_wf_3162:
    s_barrier
    s_load_dwordx2 s[20:21], s[0:1], 0
    s_load_dwordx2 s[26:27], s[0:1], 128
    v_lshrrev_b32 v1, 6, v0
    s_nop 0
    v_readfirstlane_b32 s28, v1
    s_waitcnt lgkmcnt(0)
    s_mov_b32 s4, s26
    s_and_b32 s5, s27, 0xffff
    s_mov_b32 s6, 268435456
    s_mov_b32 s7, 0x20000
    s_mov_b32 s8, s20
    s_and_b32 s9, s21, 0xffff
    s_mov_b32 s10, 2621440
    s_mov_b32 s11, 0x20000
    v_and_b32 v1, 63, v0
    v_lshlrev_b32 v2, 4, v1
    v_lshlrev_b32 v3, 3, v1
    v_lshlrev_b32 v4, 2, v1
    v_lshrrev_b32 v7, 2, v1
    v_lshlrev_b32 v5, 7, v7
    v_bfe_u32 v7, v1, 0, 1
    v_lshl_add_u32 v5, v7, 6, v5
    v_bfe_u32 v7, v1, 1, 1
    v_lshl_add_u32 v5, v7, 3, v5
    v_lshrrev_b32 v7, 3, v1
    v_lshlrev_b32 v6, 7, v7
    v_bfe_u32 v7, v1, 1, 1
    v_lshl_add_u32 v6, v7, 6, v6
    v_bfe_u32 v7, v1, 2, 1
    v_lshl_add_u32 v6, v7, 3, v6
    v_and_b32 v7, 1, v1
    v_lshl_add_u32 v6, v7, 2, v6
    s_mov_b32 s48, 0x3acccccd
    s_mov_b32 s49, 0x3727c5ac
    s_lshl_b32 s33, s28, 4
    v_add_u32 v5, s33, v5
    v_add_u32 v6, s33, v6
    s_mov_b32 s33, 136192
    buffer_load_dwordx4 v[56:59], v2, s[4:7], s33 offen sc1
    buffer_load_dwordx4 v[60:63], v2, s[4:7], s33 offen offset:1024 sc1
    buffer_load_dwordx2 v[64:65], v3, s[4:7], s33 offen offset:2048 sc1
    s_mov_b32 s33, 138752
    buffer_load_dwordx4 v[46:49], v2, s[4:7], s33 offen sc1
    buffer_load_dwordx4 v[50:53], v2, s[4:7], s33 offen offset:1024 sc1
    buffer_load_dwordx2 v[54:55], v3, s[4:7], s33 offen offset:2048 sc1
    s_mov_b32 s33, 141312
    buffer_load_dwordx4 v[36:39], v2, s[4:7], s33 offen sc1
    buffer_load_dwordx4 v[40:43], v2, s[4:7], s33 offen offset:1024 sc1
    buffer_load_dwordx2 v[44:45], v3, s[4:7], s33 offen offset:2048 sc1
    s_waitcnt vmcnt(0)
    v_add_f32 v36, 1.0, v36
    v_add_f32 v37, 1.0, v37
    v_add_f32 v38, 1.0, v38
    v_add_f32 v39, 1.0, v39
    v_add_f32 v40, 1.0, v40
    v_add_f32 v41, 1.0, v41
    v_add_f32 v42, 1.0, v42
    v_add_f32 v43, 1.0, v43
    v_add_f32 v44, 1.0, v44
    v_add_f32 v45, 1.0, v45
    v_cvt_pk_bf16_f32 v30, v36, v37
    v_lshlrev_b32 v36, 16, v30
    v_and_b32 v37, 0xffff0000, v30
    v_cvt_pk_bf16_f32 v31, v38, v39
    v_lshlrev_b32 v38, 16, v31
    v_and_b32 v39, 0xffff0000, v31
    v_cvt_pk_bf16_f32 v32, v40, v41
    v_lshlrev_b32 v40, 16, v32
    v_and_b32 v41, 0xffff0000, v32
    v_cvt_pk_bf16_f32 v33, v42, v43
    v_lshlrev_b32 v42, 16, v33
    v_and_b32 v43, 0xffff0000, v33
    v_cvt_pk_bf16_f32 v34, v44, v45
    v_lshlrev_b32 v44, 16, v34
    v_and_b32 v45, 0xffff0000, v34
L_segrow_3165:
    s_lshl_b32 s56, s30, 3
    s_add_u32 s56, s56, s29
    s_lshl_b32 s56, s56, 2
    s_add_u32 s56, s56, s28
    s_mul_i32 s35, s56, 1280
    buffer_load_dwordx2 v[66:67], v3, s[8:11], s35 offen
    buffer_load_dwordx2 v[68:69], v3, s[8:11], s35 offen offset:512
    buffer_load_dword v70, v4, s[8:11], s35 offen offset:1024
    s_and_b32 s38, s30, 1
    s_mul_i32 s38, s38, 320
    s_add_u32 s38, s38, 14336
    s_add_u32 s39, s30, 1
    s_cmp_lg_u32 s28, 0
    s_cbranch_scc1 L_wf_3166
    v_and_b32 v254, 63, v0
    v_min_u32 v254, 39, v254
    v_lshlrev_b32 v254, 3, v254
L_poll_3167:
    buffer_load_dwordx2 v[252:253], v254, s[4:7], s38 offen sc1
    s_waitcnt vmcnt(0)
    v_subrev_u32 v252, s96, v252
    v_xor_b32 v253, s97, v253
    v_lshrrev_b32 v255, 8, v252
    v_or_b32 v253, v253, v255
    v_cmp_eq_u32 vcc, 0, v253
    s_nop 1
    v_cndmask_b32 v252, 0, v252, vcc
    v_cmp_gt_u32 vcc, s39, v252
    s_cbranch_vccz L_ok_3168
    s_sleep 2
    s_sub_u32 s98, s98, 1
    s_cbranch_scc0 L_poll_3167
    s_mov_b32 s98, 0
L_ok_3168:
L_wf_3166:
    s_barrier
    s_lshl_b32 s36, s35, 1
    s_add_u32 s36, s36, 130023424
    buffer_load_dwordx4 v[72:75], v2, s[4:7], s36 offen sc1
    buffer_load_dwordx4 v[76:79], v2, s[4:7], s36 offen offset:1024 sc1
    buffer_load_dwordx2 v[80:81], v3, s[4:7], s36 offen offset:2048 sc1
    s_add_u32 s36, s36, 5242880
    buffer_load_dwordx4 v[82:85], v2, s[4:7], s36 offen sc1
    buffer_load_dwordx4 v[86:89], v2, s[4:7], s36 offen offset:1024 sc1
    buffer_load_dwordx2 v[90:91], v3, s[4:7], s36 offen offset:2048 sc1
    s_add_u32 s36, s36, 5242880
    buffer_load_dwordx4 v[92:95], v2, s[4:7], s36 offen sc1
    buffer_load_dwordx4 v[96:99], v2, s[4:7], s36 offen offset:1024 sc1
    buffer_load_dwordx2 v[100:101], v3, s[4:7], s36 offen offset:2048 sc1
    s_add_u32 s36, s36, 5242880
    buffer_load_dwordx4 v[102:105], v2, s[4:7], s36 offen sc1
    buffer_load_dwordx4 v[106:109], v2, s[4:7], s36 offen offset:1024 sc1
    buffer_load_dwordx2 v[110:111], v3, s[4:7], s36 offen offset:2048 sc1
    s_add_u32 s36, s36, 5242880
    s_waitcnt vmcnt(6)
    v_and_b32 v11, 0xffff0000, v66
    v_lshlrev_b32 v10, 16, v66
    v_and_b32 v13, 0xffff0000, v67
    v_lshlrev_b32 v12, 16, v67
    v_and_b32 v15, 0xffff0000, v68
    v_lshlrev_b32 v14, 16, v68
    v_and_b32 v17, 0xffff0000, v69
    v_lshlrev_b32 v16, 16, v69
    v_and_b32 v19, 0xffff0000, v70
    v_lshlrev_b32 v18, 16, v70
    v_add_f32 v72, v72, v82
    v_add_f32 v73, v73, v83
    v_add_f32 v74, v74, v84
    v_add_f32 v75, v75, v85
    v_add_f32 v76, v76, v86
    v_add_f32 v77, v77, v87
    v_add_f32 v78, v78, v88
    v_add_f32 v79, v79, v89
    v_add_f32 v80, v80, v90
    v_add_f32 v81, v81, v91
    s_waitcnt vmcnt(0)
    v_add_f32 v92, v92, v102
    v_add_f32 v93, v93, v103
    v_add_f32 v94, v94, v104
    v_add_f32 v95, v95, v105
    v_add_f32 v96, v96, v106
    v_add_f32 v97, v97, v107
    v_add_f32 v98, v98, v108
    v_add_f32 v99, v99, v109
    v_add_f32 v100, v100, v110
    v_add_f32 v101, v101, v111
    v_add_f32 v20, v72, v92
    v_add_f32 v21, v73, v93
    v_add_f32 v22, v74, v94
    v_add_f32 v23, v75, v95
    v_add_f32 v24, v76, v96
    v_add_f32 v25, v77, v97
    v_add_f32 v26, v78, v98
    v_add_f32 v27, v79, v99
    v_add_f32 v28, v80, v100
    v_add_f32 v29, v81, v101
    v_cvt_pk_bf16_f32 v30, v20, v21
    v_lshlrev_b32 v20, 16, v30
    v_and_b32 v21, 0xffff0000, v30
    v_cvt_pk_bf16_f32 v31, v22, v23
    v_lshlrev_b32 v22, 16, v31
    v_and_b32 v23, 0xffff0000, v31
    v_cvt_pk_bf16_f32 v32, v24, v25
    v_lshlrev_b32 v24, 16, v32
    v_and_b32 v25, 0xffff0000, v32
    v_cvt_pk_bf16_f32 v33, v26, v27
    v_lshlrev_b32 v26, 16, v33
    v_and_b32 v27, 0xffff0000, v33
    v_cvt_pk_bf16_f32 v34, v28, v29
    v_lshlrev_b32 v28, 16, v34
    v_and_b32 v29, 0xffff0000, v34
    v_mul_f32 v20, v20, v56
    v_mul_f32 v21, v21, v57
    v_mul_f32 v22, v22, v58
    v_mul_f32 v23, v23, v59
    v_mul_f32 v24, v24, v60
    v_mul_f32 v25, v25, v61
    v_mul_f32 v26, v26, v62
    v_mul_f32 v27, v27, v63
    v_mul_f32 v28, v28, v64
    v_mul_f32 v29, v29, v65
    v_cvt_pk_bf16_f32 v30, v20, v21
    v_lshlrev_b32 v20, 16, v30
    v_and_b32 v21, 0xffff0000, v30
    v_cvt_pk_bf16_f32 v31, v22, v23
    v_lshlrev_b32 v22, 16, v31
    v_and_b32 v23, 0xffff0000, v31
    v_cvt_pk_bf16_f32 v32, v24, v25
    v_lshlrev_b32 v24, 16, v32
    v_and_b32 v25, 0xffff0000, v32
    v_cvt_pk_bf16_f32 v33, v26, v27
    v_lshlrev_b32 v26, 16, v33
    v_and_b32 v27, 0xffff0000, v33
    v_cvt_pk_bf16_f32 v34, v28, v29
    v_lshlrev_b32 v28, 16, v34
    v_and_b32 v29, 0xffff0000, v34
    v_add_f32 v10, v10, v20
    v_add_f32 v11, v11, v21
    v_add_f32 v12, v12, v22
    v_add_f32 v13, v13, v23
    v_add_f32 v14, v14, v24
    v_add_f32 v15, v15, v25
    v_add_f32 v16, v16, v26
    v_add_f32 v17, v17, v27
    v_add_f32 v18, v18, v28
    v_add_f32 v19, v19, v29
    v_cvt_pk_bf16_f32 v66, v10, v11
    v_lshlrev_b32 v10, 16, v66
    v_and_b32 v11, 0xffff0000, v66
    v_cvt_pk_bf16_f32 v67, v12, v13
    v_lshlrev_b32 v12, 16, v67
    v_and_b32 v13, 0xffff0000, v67
    v_cvt_pk_bf16_f32 v68, v14, v15
    v_lshlrev_b32 v14, 16, v68
    v_and_b32 v15, 0xffff0000, v68
    v_cvt_pk_bf16_f32 v69, v16, v17
    v_lshlrev_b32 v16, 16, v69
    v_and_b32 v17, 0xffff0000, v69
    v_cvt_pk_bf16_f32 v70, v18, v19
    v_lshlrev_b32 v18, 16, v70
    v_and_b32 v19, 0xffff0000, v70
    s_add_u32 s36, s35, 88080384
    buffer_store_dwordx2 v[66:67], v3, s[4:7], s36 offen sc1
    buffer_store_dwordx2 v[68:69], v3, s[4:7], s36 offen offset:512 sc1
    buffer_store_dword v70, v4, s[4:7], s36 offen offset:1024 sc1
    v_add_f32 v7, v10, v11
    v_add_f32 v8, v12, v13
    v_add_f32 v7, v7, v14
    v_add_f32 v8, v8, v15
    v_add_f32 v7, v7, v16
    v_add_f32 v8, v8, v17
    v_add_f32 v7, v7, v18
    v_add_f32 v8, v8, v19
    v_add_f32 v7, v7, v8
    s_nop 1
    v_add_f32_dpp v7, v7, v7 row_ror:1 row_mask:0xf bank_mask:0xf
    s_nop 1
    v_add_f32_dpp v7, v7, v7 row_ror:2 row_mask:0xf bank_mask:0xf
    s_nop 1
    v_add_f32_dpp v7, v7, v7 row_ror:4 row_mask:0xf bank_mask:0xf
    s_nop 1
    v_add_f32_dpp v7, v7, v7 row_ror:8 row_mask:0xf bank_mask:0xf
    v_mov_b32 v9, v7
    s_nop 1
    v_permlane16_swap_b32 v7, v9
    v_add_f32 v7, v7, v9
    v_mov_b32 v9, v7
    s_nop 1
    v_permlane32_swap_b32 v7, v9
    v_add_f32 v7, v7, v9
    v_mul_f32 v7, s48, v7
    v_sub_f32 v20, v10, v7
    v_sub_f32 v21, v11, v7
    v_sub_f32 v22, v12, v7
    v_sub_f32 v23, v13, v7
    v_sub_f32 v24, v14, v7
    v_sub_f32 v25, v15, v7
    v_sub_f32 v26, v16, v7
    v_sub_f32 v27, v17, v7
    v_sub_f32 v28, v18, v7
    v_sub_f32 v29, v19, v7
    v_mul_f32 v8, v20, v20
    v_fmac_f32 v8, v21, v21
    v_fmac_f32 v8, v22, v22
    v_fmac_f32 v8, v23, v23
    v_fmac_f32 v8, v24, v24
    v_fmac_f32 v8, v25, v25
    v_fmac_f32 v8, v26, v26
    v_fmac_f32 v8, v27, v27
    v_fmac_f32 v8, v28, v28
    v_fmac_f32 v8, v29, v29
    v_cvt_pk_bf16_f32 v7, v7, v7
    v_lshlrev_b32 v7, 16, v7
    v_add_f32_dpp v8, v8, v8 row_ror:1 row_mask:0xf bank_mask:0xf
    s_nop 1
    v_add_f32_dpp v8, v8, v8 row_ror:2 row_mask:0xf bank_mask:0xf
    s_nop 1
    v_add_f32_dpp v8, v8, v8 row_ror:4 row_mask:0xf bank_mask:0xf
    s_nop 1
    v_add_f32_dpp v8, v8, v8 row_ror:8 row_mask:0xf bank_mask:0xf
    v_mov_b32 v9, v8
    s_nop 1
    v_permlane16_swap_b32 v8, v9
    v_add_f32 v8, v8, v9
    v_mov_b32 v9, v8
    s_nop 1
    v_permlane32_swap_b32 v8, v9
    v_add_f32 v8, v8, v9
    v_sub_f32 v20, v10, v7
    v_sub_f32 v21, v11, v7
    v_sub_f32 v22, v12, v7
    v_sub_f32 v23, v13, v7
    v_sub_f32 v24, v14, v7
    v_sub_f32 v25, v15, v7
    v_sub_f32 v26, v16, v7
    v_sub_f32 v27, v17, v7
    v_sub_f32 v28, v18, v7
    v_sub_f32 v29, v19, v7
    v_mul_f32 v8, s48, v8
    v_cvt_pk_bf16_f32 v8, v8, v8
    v_lshlrev_b32 v8, 16, v8
    v_add_f32 v8, s49, v8
    v_cvt_pk_bf16_f32 v8, v8, v8
    v_lshlrev_b32 v8, 16, v8
    v_sqrt_f32 v8, v8
    v_cvt_pk_bf16_f32 v30, v20, v21
    v_lshlrev_b32 v20, 16, v30
    v_and_b32 v21, 0xffff0000, v30
    v_cvt_pk_bf16_f32 v31, v22, v23
    v_lshlrev_b32 v22, 16, v31
    v_and_b32 v23, 0xffff0000, v31
    v_cvt_pk_bf16_f32 v32, v24, v25
    v_lshlrev_b32 v24, 16, v32
    v_and_b32 v25, 0xffff0000, v32
    v_cvt_pk_bf16_f32 v33, v26, v27
    v_lshlrev_b32 v26, 16, v33
    v_and_b32 v27, 0xffff0000, v33
    v_cvt_pk_bf16_f32 v34, v28, v29
    v_lshlrev_b32 v28, 16, v34
    v_and_b32 v29, 0xffff0000, v34
    v_cvt_pk_bf16_f32 v8, v8, v8
    v_lshlrev_b32 v8, 16, v8
    v_rcp_f32 v8, v8
    s_nop 0
    v_mul_f32 v20, v20, v8
    v_mul_f32 v21, v21, v8
    v_mul_f32 v22, v22, v8
    v_mul_f32 v23, v23, v8
    v_mul_f32 v24, v24, v8
    v_mul_f32 v25, v25, v8
    v_mul_f32 v26, v26, v8
    v_mul_f32 v27, v27, v8
    v_mul_f32 v28, v28, v8
    v_mul_f32 v29, v29, v8
    v_cvt_pk_bf16_f32 v30, v20, v21
    v_lshlrev_b32 v20, 16, v30
    v_and_b32 v21, 0xffff0000, v30
    v_cvt_pk_bf16_f32 v31, v22, v23
    v_lshlrev_b32 v22, 16, v31
    v_and_b32 v23, 0xffff0000, v31
    v_cvt_pk_bf16_f32 v32, v24, v25
    v_lshlrev_b32 v24, 16, v32
    v_and_b32 v25, 0xffff0000, v32
    v_cvt_pk_bf16_f32 v33, v26, v27
    v_lshlrev_b32 v26, 16, v33
    v_and_b32 v27, 0xffff0000, v33
    v_cvt_pk_bf16_f32 v34, v28, v29
    v_lshlrev_b32 v28, 16, v34
    v_and_b32 v29, 0xffff0000, v34
    v_mul_f32 v20, v20, v36
    v_mul_f32 v21, v21, v37
    v_mul_f32 v22, v22, v38
    v_mul_f32 v23, v23, v39
    v_mul_f32 v24, v24, v40
    v_mul_f32 v25, v25, v41
    v_mul_f32 v26, v26, v42
    v_mul_f32 v27, v27, v43
    v_mul_f32 v28, v28, v44
    v_mul_f32 v29, v29, v45
    v_cvt_pk_bf16_f32 v30, v20, v21
    v_lshlrev_b32 v20, 16, v30
    v_and_b32 v21, 0xffff0000, v30
    v_cvt_pk_bf16_f32 v31, v22, v23
    v_lshlrev_b32 v22, 16, v31
    v_and_b32 v23, 0xffff0000, v31
    v_cvt_pk_bf16_f32 v32, v24, v25
    v_lshlrev_b32 v24, 16, v32
    v_and_b32 v25, 0xffff0000, v32
    v_cvt_pk_bf16_f32 v33, v26, v27
    v_lshlrev_b32 v26, 16, v33
    v_and_b32 v27, 0xffff0000, v33
    v_cvt_pk_bf16_f32 v34, v28, v29
    v_lshlrev_b32 v28, 16, v34
    v_and_b32 v29, 0xffff0000, v34
    v_add_f32 v20, v20, v46
    v_add_f32 v21, v21, v47
    v_add_f32 v22, v22, v48
    v_add_f32 v23, v23, v49
    v_add_f32 v24, v24, v50
    v_add_f32 v25, v25, v51
    v_add_f32 v26, v26, v52
    v_add_f32 v27, v27, v53
    v_add_f32 v28, v28, v54
    v_add_f32 v29, v29, v55
    v_cvt_pk_bf16_f32 v72, v20, v21
    v_lshlrev_b32 v20, 16, v72
    v_and_b32 v21, 0xffff0000, v72
    v_cvt_pk_bf16_f32 v73, v22, v23
    v_lshlrev_b32 v22, 16, v73
    v_and_b32 v23, 0xffff0000, v73
    v_cvt_pk_bf16_f32 v74, v24, v25
    v_lshlrev_b32 v24, 16, v74
    v_and_b32 v25, 0xffff0000, v74
    v_cvt_pk_bf16_f32 v75, v26, v27
    v_lshlrev_b32 v26, 16, v75
    v_and_b32 v27, 0xffff0000, v75
    v_cvt_pk_bf16_f32 v76, v28, v29
    v_lshlrev_b32 v28, 16, v76
    v_and_b32 v29, 0xffff0000, v76
    s_add_u32 s36, s35, 92274688
    buffer_store_dwordx2 v[72:73], v3, s[4:7], s36 offen sc1
    buffer_store_dwordx2 v[74:75], v3, s[4:7], s36 offen offset:512 sc1
    buffer_store_dword v76, v4, s[4:7], s36 offen offset:1024 sc1
    v_add_f32 v7, v20, v21
    v_add_f32 v8, v22, v23
    v_add_f32 v7, v7, v24
    v_add_f32 v8, v8, v25
    v_add_f32 v7, v7, v26
    v_add_f32 v8, v8, v27
    v_add_f32 v7, v7, v28
    v_add_f32 v8, v8, v29
    v_add_f32 v7, v7, v8
    s_nop 1
    v_add_f32_dpp v7, v7, v7 row_ror:1 row_mask:0xf bank_mask:0xf
    s_nop 1
    v_add_f32_dpp v7, v7, v7 row_ror:2 row_mask:0xf bank_mask:0xf
    s_nop 1
    v_add_f32_dpp v7, v7, v7 row_ror:4 row_mask:0xf bank_mask:0xf
    s_nop 1
    v_add_f32_dpp v7, v7, v7 row_ror:8 row_mask:0xf bank_mask:0xf
    v_mov_b32 v9, v7
    s_nop 1
    v_permlane16_swap_b32 v7, v9
    v_add_f32 v7, v7, v9
    v_mov_b32 v9, v7
    s_nop 1
    v_permlane32_swap_b32 v7, v9
    v_add_f32 v7, v7, v9
    v_mul_f32 v7, s48, v7
    v_sub_f32 v10, v20, v7
    v_sub_f32 v11, v21, v7
    v_sub_f32 v12, v22, v7
    v_sub_f32 v13, v23, v7
    v_sub_f32 v14, v24, v7
    v_sub_f32 v15, v25, v7
    v_sub_f32 v16, v26, v7
    v_sub_f32 v17, v27, v7
    v_sub_f32 v18, v28, v7
    v_sub_f32 v19, v29, v7
    v_mul_f32 v8, v10, v10
    v_fmac_f32 v8, v11, v11
    v_fmac_f32 v8, v12, v12
    v_fmac_f32 v8, v13, v13
    v_fmac_f32 v8, v14, v14
    v_fmac_f32 v8, v15, v15
    v_fmac_f32 v8, v16, v16
    v_fmac_f32 v8, v17, v17
    v_fmac_f32 v8, v18, v18
    v_fmac_f32 v8, v19, v19
    v_cvt_pk_bf16_f32 v7, v7, v7
    v_lshlrev_b32 v7, 16, v7
    v_add_f32_dpp v8, v8, v8 row_ror:1 row_mask:0xf bank_mask:0xf
    s_nop 1
    v_add_f32_dpp v8, v8, v8 row_ror:2 row_mask:0xf bank_mask:0xf
    s_nop 1
    v_add_f32_dpp v8, v8, v8 row_ror:4 row_mask:0xf bank_mask:0xf
    s_nop 1
    v_add_f32_dpp v8, v8, v8 row_ror:8 row_mask:0xf bank_mask:0xf
    v_mov_b32 v9, v8
    s_nop 1
    v_permlane16_swap_b32 v8, v9
    v_add_f32 v8, v8, v9
    v_mov_b32 v9, v8
    s_nop 1
    v_permlane32_swap_b32 v8, v9
    v_add_f32 v8, v8, v9
    v_sub_f32 v10, v20, v7
    v_sub_f32 v11, v21, v7
    v_sub_f32 v12, v22, v7
    v_sub_f32 v13, v23, v7
    v_sub_f32 v14, v24, v7
    v_sub_f32 v15, v25, v7
    v_sub_f32 v16, v26, v7
    v_sub_f32 v17, v27, v7
    v_sub_f32 v18, v28, v7
    v_sub_f32 v19, v29, v7
    v_mul_f32 v8, s48, v8
    v_cvt_pk_bf16_f32 v8, v8, v8
    v_lshlrev_b32 v8, 16, v8
    v_add_f32 v8, s49, v8
    v_cvt_pk_bf16_f32 v8, v8, v8
    v_lshlrev_b32 v8, 16, v8
    v_sqrt_f32 v8, v8
    v_cvt_pk_bf16_f32 v30, v10, v11
    v_lshlrev_b32 v10, 16, v30
    v_and_b32 v11, 0xffff0000, v30
    v_cvt_pk_bf16_f32 v31, v12, v13
    v_lshlrev_b32 v12, 16, v31
    v_and_b32 v13, 0xffff0000, v31
    v_cvt_pk_bf16_f32 v32, v14, v15
    v_lshlrev_b32 v14, 16, v32
    v_and_b32 v15, 0xffff0000, v32
    v_cvt_pk_bf16_f32 v33, v16, v17
    v_lshlrev_b32 v16, 16, v33
    v_and_b32 v17, 0xffff0000, v33
    v_cvt_pk_bf16_f32 v34, v18, v19
    v_lshlrev_b32 v18, 16, v34
    v_and_b32 v19, 0xffff0000, v34
    v_cvt_pk_bf16_f32 v8, v8, v8
    v_lshlrev_b32 v8, 16, v8
    v_rcp_f32 v8, v8
    s_nop 0
    v_mul_f32 v10, v10, v8
    v_mul_f32 v11, v11, v8
    v_mul_f32 v12, v12, v8
    v_mul_f32 v13, v13, v8
    v_mul_f32 v14, v14, v8
    v_mul_f32 v15, v15, v8
    v_mul_f32 v16, v16, v8
    v_mul_f32 v17, v17, v8
    v_mul_f32 v18, v18, v8
    v_mul_f32 v19, v19, v8
    v_cvt_pk_bf16_f32 v30, v10, v11
    v_cvt_pk_bf16_f32 v31, v12, v13
    v_cvt_pk_bf16_f32 v32, v14, v15
    v_cvt_pk_bf16_f32 v33, v16, v17
    v_cvt_pk_bf16_f32 v34, v18, v19
    ds_write_b64 v5, v[30:31] offset:0
    ds_write_b64 v5, v[32:33] offset:2048
    ds_write_b32 v6, v34 offset:4096
    s_waitcnt lgkmcnt(0)
    s_barrier
    v_lshlrev_b32 v7, 4, v0
    v_lshrrev_b32 v8, 2, v7
    ds_read_b128 v[10:13], v7
    ds_read_b32 v14, v8 offset:4096
    s_lshr_b32 s33, s56, 2
    s_mul_i32 s33, s33, 5120
    s_add_u32 s33, s33, 96468992
    s_add_u32 s34, s33, 4096
    s_waitcnt lgkmcnt(1)
    buffer_store_dwordx4 v[10:13], v7, s[4:7], s33 offen sc1
    s_waitcnt lgkmcnt(0)
    buffer_store_dword v14, v8, s[4:7], s34 offen sc1
    s_add_u32 s34, s30, s31
    s_waitcnt vmcnt(0)
    s_barrier
    s_cmp_lg_u32 s28, 0
    s_cbranch_scc1 L_sig_3169
    s_add_u32 s33, s96, s34
    v_mov_b32 v252, s33
    v_mov_b32 v253, s97
    s_mov_b64 exec, 1
    buffer_store_dwordx2 v[252:253], off, s[4:7], s99 sc1
    s_mov_b64 exec, -1
L_sig_3169:
    s_add_u32 s30, s30, s31
    s_cmp_lt_u32 s30, s32
    s_cbranch_scc1 L_segrow_3165
    s_branch L_fin_3091
L_ln4_3090:
    s_mul_i32 s33, s30, 0
    s_add_u32 s33, s33, s29
    s_lshl_b32 s99, s33, 3
    s_add_u32 s99, s99, 22528
    s_load_dwordx2 s[26:27], s[0:1], 128
    v_lshrrev_b32 v1, 6, v0
    s_nop 0
    v_readfirstlane_b32 s28, v1
    s_waitcnt lgkmcnt(0)
    s_mov_b32 s4, s26
    s_and_b32 s5, s27, 0xffff
    s_mov_b32 s6, 268435456
    s_mov_b32 s7, 0x20000
    v_and_b32 v1, 63, v0
    v_lshlrev_b32 v2, 4, v1
    v_lshlrev_b32 v3, 3, v1
    v_lshlrev_b32 v4, 2, v1
    v_lshrrev_b32 v7, 2, v1
    v_lshlrev_b32 v5, 7, v7
    v_bfe_u32 v7, v1, 0, 1
    v_lshl_add_u32 v5, v7, 6, v5
    v_bfe_u32 v7, v1, 1, 1
    v_lshl_add_u32 v5, v7, 3, v5
    v_lshrrev_b32 v7, 3, v1
    v_lshlrev_b32 v6, 7, v7
    v_bfe_u32 v7, v1, 1, 1
    v_lshl_add_u32 v6, v7, 6, v6
    v_bfe_u32 v7, v1, 2, 1
    v_lshl_add_u32 v6, v7, 3, v6
    v_and_b32 v7, 1, v1
    v_lshl_add_u32 v6, v7, 2, v6
    s_mov_b32 s48, 0x3acccccd
    s_mov_b32 s49, 0x3727c5ac
    s_lshl_b32 s33, s28, 4
    v_add_u32 v5, s33, v5
    v_add_u32 v6, s33, v6
    s_mov_b32 s37, 0
L_segrow_3170:
    s_lshl_b32 s56, s30, 3
    s_add_u32 s56, s56, s29
    s_lshl_b32 s56, s56, 2
    s_add_u32 s56, s56, s28
    s_mul_i32 s57, s56, 1280
    s_add_u32 s57, s57, 104857600
    s_cmp_lg_u32 s37, 0
    s_cbranch_scc1 L_have_3171
    s_mov_b32 s38, 20480
    s_add_u32 s39, s30, 1
    s_cmp_lg_u32 s28, 0
    s_cbranch_scc1 L_wf_3172
    v_and_b32 v254, 63, v0
    v_min_u32 v254, 9, v254
    v_lshlrev_b32 v254, 3, v254
L_poll_3173:
    buffer_load_dwordx2 v[252:253], v254, s[4:7], s38 offen sc1
    s_waitcnt vmcnt(0)
    v_subrev_u32 v252, s96, v252
    v_xor_b32 v253, s97, v253
    v_lshrrev_b32 v255, 8, v252
    v_or_b32 v253, v253, v255
    v_cmp_eq_u32 vcc, 0, v253
    s_nop 1
    v_cndmask_b32 v252, 0, v252, vcc
    v_cmp_gt_u32 vcc, s39, v252
    s_cbranch_vccz L_ok_3174
    s_sleep 2
    s_sub_u32 s98, s98, 1
    s_cbranch_scc0 L_poll_3173
    s_mov_b32 s98, 0
L_ok_3174:
L_wf_3172:
    s_barrier
    buffer_load_dwordx2 v[36:37], v3, s[4:7], s57 offen sc1
    buffer_load_dwordx2 v[38:39], v3, s[4:7], s57 offen offset:512 sc1
    buffer_load_dword v40, v4, s[4:7], s57 offen offset:1024 sc1
L_have_3171:
    s_add_u32 s37, s30, s31
    s_mov_b32 s38, 20480
    s_add_u32 s39, s37, 1
    s_cmp_lt_u32 s37, s32
    s_cselect_b32 s39, s39, 256
    s_cmp_eq_u32 s28, 0
    s_cselect_b64 exec, -1, 0
    buffer_load_dwordx2 v[252:253], v254, s[4:7], s38 offen sc1
    s_mov_b64 exec, -1
    s_add_u32 s57, s57, 40960
    s_waitcnt vmcnt(0)
    v_and_b32 v11, 0xffff0000, v36
    v_lshlrev_b32 v10, 16, v36
    v_and_b32 v13, 0xffff0000, v37
    v_lshlrev_b32 v12, 16, v37
    v_and_b32 v15, 0xffff0000, v38
    v_lshlrev_b32 v14, 16, v38
    v_and_b32 v17, 0xffff0000, v39
    v_lshlrev_b32 v16, 16, v39
    v_and_b32 v19, 0xffff0000, v40
    v_lshlrev_b32 v18, 16, v40
    s_cmp_lg_u32 s28, 0
    s_cbranch_scc1 L_verd_3175
    v_subrev_u32 v252, s96, v252
    v_xor_b32 v253, s97, v253
    v_lshrrev_b32 v255, 8, v252
    v_or_b32 v253, v253, v255
    v_cmp_eq_u32 vcc, 0, v253
    s_nop 1
    v_cndmask_b32 v252, 0, v252, vcc
    v_cmp_gt_u32 vcc, s39, v252
    s_nop 0
    s_cmp_eq_u64 vcc, 0
    s_cselect_b32 s37, 1, 0
    v_mov_b32 v252, s37
    v_mov_b32 v253, 8192
    ds_write_b32 v253, v252
L_verd_3175:
    s_waitcnt lgkmcnt(0)
    s_barrier
    v_mov_b32 v253, 8192
    ds_read_b32 v252, v253
    s_waitcnt lgkmcnt(0)
    v_readfirstlane_b32 s37, v252
    s_nop 0
    s_cmp_eq_u32 s37, 0
    s_cbranch_scc1 L_noah_3176
    buffer_load_dwordx2 v[36:37], v3, s[4:7], s57 offen sc1
    buffer_load_dwordx2 v[38:39], v3, s[4:7], s57 offen offset:512 sc1
    buffer_load_dword v40, v4, s[4:7], s57 offen offset:1024 sc1
L_noah_3176:
    v_add_f32 v7, v10, v11
    v_add_f32 v8, v12, v13
    v_add_f32 v7, v7, v14
    v_add_f32 v8, v8, v15
    v_add_f32 v7, v7, v16
    v_add_f32 v8, v8, v17
    v_add_f32 v7, v7, v18
    v_add_f32 v8, v8, v19
    v_add_f32 v7, v7, v8
    s_nop 1
    v_add_f32_dpp v7, v7, v7 row_ror:1 row_mask:0xf bank_mask:0xf
    s_nop 1
    v_add_f32_dpp v7, v7, v7 row_ror:2 row_mask:0xf bank_mask:0xf
    s_nop 1
    v_add_f32_dpp v7, v7, v7 row_ror:4 row_mask:0xf bank_mask:0xf
    s_nop 1
    v_add_f32_dpp v7, v7, v7 row_ror:8 row_mask:0xf bank_mask:0xf
    v_mov_b32 v9, v7
    s_nop 1
    v_permlane16_swap_b32 v7, v9
    v_add_f32 v7, v7, v9
    v_mov_b32 v9, v7
    s_nop 1
    v_permlane32_swap_b32 v7, v9
    v_add_f32 v7, v7, v9
    v_mul_f32 v7, s48, v7
    v_sub_f32 v20, v10, v7
    v_sub_f32 v21, v11, v7
    v_sub_f32 v22, v12, v7
    v_sub_f32 v23, v13, v7
    v_sub_f32 v24, v14, v7
    v_sub_f32 v25, v15, v7
    v_sub_f32 v26, v16, v7
    v_sub_f32 v27, v17, v7
    v_sub_f32 v28, v18, v7
    v_sub_f32 v29, v19, v7
    v_mul_f32 v8, v20, v20
    v_fmac_f32 v8, v21, v21
    v_fmac_f32 v8, v22, v22
    v_fmac_f32 v8, v23, v23
    v_fmac_f32 v8, v24, v24
    v_fmac_f32 v8, v25, v25
    v_fmac_f32 v8, v26, v26
    v_fmac_f32 v8, v27, v27
    v_fmac_f32 v8, v28, v28
    v_fmac_f32 v8, v29, v29
    v_cvt_pk_bf16_f32 v7, v7, v7
    v_lshlrev_b32 v7, 16, v7
    v_add_f32_dpp v8, v8, v8 row_ror:1 row_mask:0xf bank_mask:0xf
    s_nop 1
    v_add_f32_dpp v8, v8, v8 row_ror:2 row_mask:0xf bank_mask:0xf
    s_nop 1
    v_add_f32_dpp v8, v8, v8 row_ror:4 row_mask:0xf bank_mask:0xf
    s_nop 1
    v_add_f32_dpp v8, v8, v8 row_ror:8 row_mask:0xf bank_mask:0xf
    v_mov_b32 v9, v8
    s_nop 1
    v_permlane16_swap_b32 v8, v9
    v_add_f32 v8, v8, v9
    v_mov_b32 v9, v8
    s_nop 1
    v_permlane32_swap_b32 v8, v9
    v_add_f32 v8, v8, v9
    v_sub_f32 v20, v10, v7
    v_sub_f32 v21, v11, v7
    v_sub_f32 v22, v12, v7
    v_sub_f32 v23, v13, v7
    v_sub_f32 v24, v14, v7
    v_sub_f32 v25, v15, v7
    v_sub_f32 v26, v16, v7
    v_sub_f32 v27, v17, v7
    v_sub_f32 v28, v18, v7
    v_sub_f32 v29, v19, v7
    v_mul_f32 v8, s48, v8
    v_cvt_pk_bf16_f32 v8, v8, v8
    v_lshlrev_b32 v8, 16, v8
    v_add_f32 v8, s49, v8
    v_cvt_pk_bf16_f32 v8, v8, v8
    v_lshlrev_b32 v8, 16, v8
    v_sqrt_f32 v8, v8
    v_cvt_pk_bf16_f32 v30, v20, v21
    v_lshlrev_b32 v20, 16, v30
    v_and_b32 v21, 0xffff0000, v30
    v_cvt_pk_bf16_f32 v31, v22, v23
    v_lshlrev_b32 v22, 16, v31
    v_and_b32 v23, 0xffff0000, v31
    v_cvt_pk_bf16_f32 v32, v24, v25
    v_lshlrev_b32 v24, 16, v32
    v_and_b32 v25, 0xffff0000, v32
    v_cvt_pk_bf16_f32 v33, v26, v27
    v_lshlrev_b32 v26, 16, v33
    v_and_b32 v27, 0xffff0000, v33
    v_cvt_pk_bf16_f32 v34, v28, v29
    v_lshlrev_b32 v28, 16, v34
    v_and_b32 v29, 0xffff0000, v34
    v_cvt_pk_bf16_f32 v8, v8, v8
    v_lshlrev_b32 v8, 16, v8
    v_rcp_f32 v8, v8
    s_nop 0
    v_mul_f32 v20, v20, v8
    v_mul_f32 v21, v21, v8
    v_mul_f32 v22, v22, v8
    v_mul_f32 v23, v23, v8
    v_mul_f32 v24, v24, v8
    v_mul_f32 v25, v25, v8
    v_mul_f32 v26, v26, v8
    v_mul_f32 v27, v27, v8
    v_mul_f32 v28, v28, v8
    v_mul_f32 v29, v29, v8
    v_cvt_pk_bf16_f32 v30, v20, v21
    v_cvt_pk_bf16_f32 v31, v22, v23
    v_cvt_pk_bf16_f32 v32, v24, v25
    v_cvt_pk_bf16_f32 v33, v26, v27
    v_cvt_pk_bf16_f32 v34, v28, v29
    ds_write_b64 v5, v[30:31] offset:0
    ds_write_b64 v5, v[32:33] offset:2048
    ds_write_b32 v6, v34 offset:4096
    s_waitcnt lgkmcnt(0)
    s_barrier
    v_lshlrev_b32 v7, 4, v0
    v_lshrrev_b32 v8, 2, v7
    ds_read_b128 v[10:13], v7
    ds_read_b32 v14, v8 offset:4096
    s_lshr_b32 s33, s56, 2
    s_mul_i32 s33, s33, 5120
    s_add_u32 s33, s33, 109051904
    s_add_u32 s34, s33, 4096
    s_waitcnt lgkmcnt(1)
    buffer_store_dwordx4 v[10:13], v7, s[4:7], s33 offen sc1
    s_waitcnt lgkmcnt(0)
    buffer_store_dword v14, v8, s[4:7], s34 offen sc1
    s_add_u32 s34, s30, s31
    s_waitcnt vmcnt(0)
    s_barrier
    s_cmp_lg_u32 s28, 0
    s_cbranch_scc1 L_sig_3177
    s_add_u32 s33, s96, s34
    v_mov_b32 v252, s33
    v_mov_b32 v253, s97
    s_mov_b64 exec, 1
    buffer_store_dwordx2 v[252:253], off, s[4:7], s99 sc1
    s_mov_b64 exec, -1
L_sig_3177:
    s_add_u32 s30, s30, s31
    s_cmp_lt_u32 s30, s32
    s_cbranch_scc1 L_segrow_3170
L_fin_3091:
L_end_1:
    s_endpgm

.section .rodata,"a"
.p2align 6
.amdhsa_kernel adaLN_cond__memory_aug_recurrent_mem_tr__mixer_s_mlp__prompt_kernel
  .amdhsa_next_free_vgpr 512
  .amdhsa_next_free_sgpr 102
  .amdhsa_accum_offset 256
  .amdhsa_group_segment_fixed_size 0
  .amdhsa_kernarg_size 136
  .amdhsa_user_sgpr_count 2
  .amdhsa_user_sgpr_kernarg_segment_ptr 1
  .amdhsa_system_sgpr_workgroup_id_x 1
  .amdhsa_float_denorm_mode_32 3
.end_amdhsa_kernel
```
